```python
import torch

def _softmax(x, axis=-1):
    return torch.softmax(x, dim=axis)
def _gelu(x):
    return torch.nn.functional.gelu(x, approximate="tanh")
def _silu(x):
    return torch.nn.functional.silu(x)
def _sigmoid(x):
    return torch.sigmoid(x)
def _layernorm(x, axis=-1, eps=1e-5):
    m = x.mean(dim=axis, keepdim=True)
    v = x.var(dim=axis, keepdim=True, unbiased=False)
    return (x - m) / torch.sqrt(v + eps)
def _scatter_add(tgt, idx, src, axis=0):
    return tgt.clone().index_add_(axis, idx, src)
def _segment_sum(src, seg, n):
    out = torch.zeros((n,) + src.shape[1:], dtype=src.dtype)
    return out.index_add_(0, seg, src)
def _pad(x, pw):
    flat = tuple(v for pair in reversed(pw) for v in pair)
    return torch.nn.functional.pad(x, flat)

kernel_name = 'sequential_preLN__sliding_block__glu_gated_bilinear__prompt'

def setup_inputs():

    _w = (lambda a: (lambda t: t.to(torch.bfloat16) if t.is_floating_point() else t)(torch.as_tensor(a)))
    def _A_setup():
        B, S, D = 1, 2048, 1024
        return {
            "x": _w((lambda *s: torch.randn(*s, dtype=torch.bfloat16) * 0.05)(B, S, D)),
            "wqkv": _w((lambda *s: torch.randn(*s, dtype=torch.bfloat16) * 0.05)(D, 3 * D)),
            "wo": _w((lambda *s: torch.randn(*s, dtype=torch.bfloat16) * 0.05)(D, D)),
        }
    _A_in = _A_setup()

    def _B_setup():
        B, S, D, F = 1, 2048, 1024, 3584
        return {
            "x": _w((lambda *s: torch.randn(*s, dtype=torch.bfloat16) * 0.05)(B, S, D)),
            "w_gate": _w((lambda *s: torch.randn(*s, dtype=torch.bfloat16) * 0.8)(D, F) * (D ** -0.5)),
            "w_up": _w((lambda *s: torch.randn(*s, dtype=torch.bfloat16) * 0.8)(D, F) * (D ** -0.5)),
            "w_down": _w((lambda *s: torch.randn(*s, dtype=torch.bfloat16) * 0.8)(F, D) * (F ** -0.5)),
        }
    _B_in = _B_setup()

    return {
        "A_x": _A_in["x"],
        "A_wqkv": _A_in["wqkv"],
        "A_wo": _A_in["wo"],
        "B_x": _B_in["x"],
        "B_w_gate": _B_in["w_gate"],
        "B_w_up": _B_in["w_up"],
        "B_w_down": _B_in["w_down"],
    }

def reference(A_x, A_wqkv, A_wo, B_x, B_w_gate, B_w_up, B_w_down):
    def _A_ref(x, wqkv, wo):
        B, S, D = x.shape
        H = 32; Dh = D // H; W = 256
        qkv = (lambda x, *d: x.permute(*d))((x @ wqkv).reshape(B, S, 3, H, Dh), 2, 0, 3, 1, 4)
        q, k, v = qkv[0], qkv[1], qkv[2]
        scores = torch.einsum("bhqd,bhkd->bhqk", q, k) * (Dh ** -0.5)
        idx = torch.arange(S)
        mask = (idx[:, None] - idx[None, :] >= 0) & (idx[:, None] - idx[None, :] < W)
        scores = torch.where(mask[None, None], scores, -1e9)
        p = _softmax(scores, axis=-1)
        o = torch.einsum("bhqk,bhkd->bhqd", p, v)
        return (lambda x, *d: x.permute(*d))(o, 0, 2, 1, 3).reshape(B, S, D) @ wo

    def _B_ref(x, w_gate, w_up, w_down):
        g = torch.einsum("bsd,df->bsf", x, w_gate)
        u = torch.einsum("bsd,df->bsf", x, w_up)
        h = g * u
        return torch.einsum("bsf,fd->bsd", h, w_down)

    x = A_x
    h = x + _A_ref(_layernorm(x, axis=-1), A_wqkv, A_wo)
    h2 = h + _B_ref(_layernorm(h, axis=-1), B_w_gate, B_w_up, B_w_down)
    return h2
```

```asm
; @launch grid=(256,1,1) block=(256,1,1) lds=163840
.amdgcn_target "amdgcn-amd-amdhsa--gfx950"
.text
.globl sequential_preLN__sliding_block__glu_gated_bilinear__prompt_kernel
.p2align 8
.type sequential_preLN__sliding_block__glu_gated_bilinear__prompt_kernel,@function
sequential_preLN__sliding_block__glu_gated_bilinear__prompt_kernel:

    s_cmp_ge_u32 s2, 256
    s_cbranch_scc1 L_done
    s_load_dwordx16 s[84:99], s[0:1], 0
    s_load_dwordx2 s[100:101], s[0:1], 64
    s_load_dwordx2 s[4:5], s[0:1], 72
    v_and_b32 v1, 63, v0
    v_lshrrev_b32 v23, 6, v0
    s_getpc_b64 s[24:25]
L_pc:
    s_sub_u32 s24, s24, L_pc-sequential_preLN__sliding_block__glu_gated_bilinear__prompt_kernel
    s_subb_u32 s25, s25, 0
    s_lshr_b32 s16, s2, 3
    s_lshl_b32 s16, s16, 11
    v_and_b32 v2, 15, v0
    v_lshlrev_b32 v2, 7, v2
    v_add_u32 v2, s16, v2
    s_mov_b32 s17, L_codeend-sequential_preLN__sliding_block__glu_gated_bilinear__prompt_kernel
    v_cmp_gt_u32 vcc, s17, v2
    v_cmp_gt_u32 s[26:27], 16, v0
    s_nop 1
    s_and_b64 vcc, vcc, s[26:27]
    s_and_saveexec_b64 s[26:27], vcc
    s_cbranch_execz L_nopf
    global_load_dword v29, v2, s[24:25]
L_nopf:
    s_mov_b64 exec, s[26:27]
    s_and_b32 s3, s2, 7
    s_lshr_b32 s16, s2, 3
    s_and_b32 s17, s3, 1
    s_lshl_b32 s17, s17, 2
    s_and_b32 s18, s16, 3
    s_add_u32 s17, s17, s18
    s_lshr_b32 s18, s2, 7
    s_lshl_b32 s18, s18, 3
    s_add_u32 s21, s17, s18
    v_readfirstlane_b32 s20, v23
    s_lshr_b32 s17, s3, 1
    s_lshl_b32 s17, s17, 2
    s_bfe_u32 s18, s16, 0x20002
    s_add_u32 s22, s17, s18
    v_lshrrev_b32 v23, 3, v1
    v_lshrrev_b32 v24, 4, v1
    v_and_b32 v25, 7, v1
    s_lshl_b32 s16, s20, 16
    v_add_u32 v26, 0, v24
    v_and_b32 v26, 7, v26
    v_xor_b32 v26, v26, v25
    v_lshlrev_b32 v26, 4, v26
    v_add_u32 v27, 0, v23
    v_lshlrev_b32 v27, 11, v27
    v_add3_u32 v26, v26, v27, s16
    v_mov_b32 v2, v26
    v_add_u32 v26, 4, v24
    v_and_b32 v26, 7, v26
    v_xor_b32 v26, v26, v25
    v_lshlrev_b32 v26, 4, v26
    v_add_u32 v27, 8, v23
    v_lshlrev_b32 v27, 11, v27
    v_add3_u32 v26, v26, v27, s16
    v_subrev_u32 v3, 1024, v26
    v_add_u32 v26, 8, v24
    v_and_b32 v26, 7, v26
    v_xor_b32 v26, v26, v25
    v_lshlrev_b32 v26, 4, v26
    v_add_u32 v27, 16, v23
    v_lshlrev_b32 v27, 11, v27
    v_add3_u32 v26, v26, v27, s16
    v_subrev_u32 v4, 2048, v26
    v_add_u32 v26, 12, v24
    v_and_b32 v26, 7, v26
    v_xor_b32 v26, v26, v25
    v_lshlrev_b32 v26, 4, v26
    v_add_u32 v27, 24, v23
    v_lshlrev_b32 v27, 11, v27
    v_add3_u32 v26, v26, v27, s16
    v_subrev_u32 v5, 3072, v26
    v_bfe_u32 v25, v1, 1, 2
    v_and_b32 v26, 1, v1
    v_lshlrev_b32 v26, 4, v26
    s_mul_i32 s16, s20, 98304
    v_add_u32 v27, 0, v23
    v_mul_u32_u24 v28, 43, v27
    v_lshrrev_b32 v28, 7, v28
    v_bfe_u32 v24, v28, 1, 1
    v_bfe_u32 v28, v28, 3, 1
    v_lshl_or_b32 v24, v28, 1, v24
    v_xor_b32 v24, v24, v25
    v_lshl_add_u32 v24, v24, 5, v26
    v_lshl_add_u32 v24, v27, 11, v24
    v_add_u32 v24, s16, v24
    v_xor_b32 v28, 64, v24
    v_add_u32 v9, 46080, v28
    v_mov_b32 v6, v24
    v_add_u32 v27, 8, v23
    v_mul_u32_u24 v28, 43, v27
    v_lshrrev_b32 v28, 7, v28
    v_bfe_u32 v24, v28, 1, 1
    v_bfe_u32 v28, v28, 3, 1
    v_lshl_or_b32 v24, v28, 1, v24
    v_xor_b32 v24, v24, v25
    v_lshl_add_u32 v24, v24, 5, v26
    v_lshl_add_u32 v24, v27, 11, v24
    v_add_u32 v24, s16, v24
    v_xor_b32 v28, 64, v24
    v_add_u32 v10, 49152, v28
    v_subrev_u32 v7, 1024, v24
    v_add_u32 v27, 16, v23
    v_mul_u32_u24 v28, 43, v27
    v_lshrrev_b32 v28, 7, v28
    v_bfe_u32 v24, v28, 1, 1
    v_bfe_u32 v28, v28, 3, 1
    v_lshl_or_b32 v24, v28, 1, v24
    v_xor_b32 v24, v24, v25
    v_lshl_add_u32 v24, v24, 5, v26
    v_lshl_add_u32 v24, v27, 11, v24
    v_add_u32 v24, s16, v24
    v_xor_b32 v28, 64, v24
    v_add_u32 v11, 48128, v28
    v_subrev_u32 v8, 2048, v24
    s_waitcnt lgkmcnt(0)
    s_lshl_b32 s16, s21, 18
    s_add_u32 s12, s84, s16
    s_addc_u32 s13, s85, 0
    s_sub_u32 s14, 0x400000, s16
    s_mov_b32 s15, 0x20000
    s_lshl_b32 s16, s22, 7
    s_add_u32 s8, s86, s16
    s_addc_u32 s9, s87, 0
    s_sub_u32 s10, 6291456, s16
    s_mov_b32 s11, 0x20000
    s_lshl_b32 s26, s20, 12
    s_add_u32 s29, s26, 163840
    s_lshl_b32 s31, s20, 11
    s_add_u32 s30, s26, s31
    s_mov_b32 s24, 0
    s_mov_b32 s25, 0
    s_mov_b32 s27, 0
    s_mov_b32 m0, s26
    s_nop 0
    buffer_load_dwordx4 v2, s[12:15], s24 offen offset:0 lds
    buffer_load_dwordx4 v3, s[12:15], s24 offen offset:1024 lds
    buffer_load_dwordx4 v4, s[12:15], s24 offen offset:2048 lds
    buffer_load_dwordx4 v5, s[12:15], s24 offen offset:3072 lds
    s_add_u32 m0, s30, 16384
    s_nop 0
    buffer_load_dwordx4 v6, s[8:11], s25 offen offset:0 lds
    buffer_load_dwordx4 v7, s[8:11], s25 offen offset:1024 lds
    buffer_load_dwordx4 v8, s[8:11], s25 offen offset:2048 lds
    buffer_load_dwordx4 v9, s[8:11], s25 offen offset:3072 lds
    s_add_u32 m0, s30, 20480
    s_nop 0
    buffer_load_dwordx4 v10, s[8:11], s25 offen offset:0 lds
    buffer_load_dwordx4 v11, s[8:11], s25 offen offset:1024 lds
    s_and_b32 s3, s2, 7
    s_lshr_b32 s16, s2, 3
    s_lshr_b32 s17, s16, 4
    s_lshl_b32 s18, s3, 1
    s_add_u32 s72, s17, s18
    s_and_b32 s73, s16, 15
    v_mov_b32 v30, 0x10000000
    v_cmp_eq_u32 vcc, 0, v1
    s_nop 1
    v_cndmask_b32 v30, v30, 0, vcc
    s_lshl_b32 s16, s2, 3
    s_lshl_b32 s17, s20, 2
    s_add_u32 s16, s16, s17
    s_lshl_b32 s16, s16, 11
    v_lshrrev_b32 v24, 3, v1
    v_lshlrev_b32 v24, 11, v24
    v_and_b32 v25, 7, v1
    v_lshlrev_b32 v25, 7, v25
    v_add3_u32 v24, v24, v25, s16
    s_lshl_b32 s17, s2, 1
    s_add_u32 s17, s17, s20
    s_sub_u32 s17, s17, 2
    s_mul_i32 s17, s17, 6144
    v_lshlrev_b32 v25, 7, v1
    v_add_u32 v25, s17, v25
    s_cmp_ge_u32 s20, 2
    s_cselect_b32 s18, 48, 32
    s_cselect_b64 vcc, -1, 0
    s_nop 1
    v_cndmask_b32 v24, v24, v25, vcc
    v_mov_b32 v25, 0x10000000
    v_cmp_gt_u32 vcc, s18, v1
    s_nop 1
    v_cndmask_b32 v21, v25, v24, vcc
    s_mov_b32 s6, 0x10000000
    s_mov_b32 s7, 0x20000
    s_mov_b32 s40, s100
    s_mov_b32 s41, s101
    s_mov_b32 s42, 256
    s_mov_b32 s43, 0x20000
    s_cmp_ge_u32 s20, 2
    s_cselect_b32 s80, s86, s84
    s_cselect_b32 s81, s87, s85
    s_mov_b32 s82, 0x400000
    s_cselect_b32 s82, 6291456, s82
    s_mov_b32 s83, 0x20000
    s_movk_i32 s76, 1024
    s_cselect_b32 s76, 3145728, s76
    s_mov_b32 s77, 0
    buffer_load_dword v29, v21, s[80:83], s77 offen
    s_add_u32 s77, s77, s76

    s_add_u32 s24, s24, 128
    s_add_u32 s25, s25, 393216
    s_add_u32 s26, s26, 40960
    s_add_u32 s30, s26, s31
    s_mov_b32 m0, s26
    s_nop 0
    buffer_load_dwordx4 v2, s[12:15], s24 offen offset:0 lds
    s_lshr_b32 s16, s20, 1
    s_lshl_b32 s16, s16, 13
    v_and_b32 v23, 15, v1
    v_lshrrev_b32 v24, 4, v1
    v_lshrrev_b32 v25, 1, v23
    v_lshlrev_b32 v26, 7, v23
    v_or_b32 v27, 0, v24
    v_xor_b32 v27, v27, v25
    buffer_load_dwordx4 v3, s[12:15], s24 offen offset:1024 lds
    v_lshlrev_b32 v27, 4, v27
    v_add3_u32 v12, v27, v26, s16
    v_or_b32 v27, 4, v24
    v_xor_b32 v27, v27, v25
    v_lshlrev_b32 v27, 4, v27
    v_add3_u32 v13, v27, v26, s16
    v_bfe_u32 v23, v1, 2, 2
    v_lshlrev_b32 v25, 3, v24
    buffer_load_dwordx4 v4, s[12:15], s24 offen offset:2048 lds
    v_add_u32 v25, v25, v23
    v_mul_u32_u24 v25, 384, v25
    v_and_b32 v26, 3, v1
    v_lshlrev_b32 v26, 3, v26
    v_add_u32 v25, v25, v26
    v_lshrrev_b32 v23, 1, v23
    v_and_b32 v26, 1, v24
    v_lshlrev_b32 v26, 1, v26
    buffer_load_dwordx4 v5, s[12:15], s24 offen offset:3072 lds
    v_or_b32 v23, v23, v26
    s_and_b32 s16, s20, 1
    s_lshl_b32 s16, s16, 1
    s_or_b32 s17, s16, 0
    v_xor_b32 v26, s17, v23
    v_lshlrev_b32 v26, 5, v26
    v_add_u32 v14, v25, v26
    s_or_b32 s17, s16, 1
    s_add_u32 m0, s30, 16384
    s_nop 0
    buffer_load_dwordx4 v6, s[8:11], s25 offen offset:0 lds
    v_xor_b32 v26, s17, v23
    v_lshlrev_b32 v26, 5, v26
    v_add_u32 v15, v25, v26
    v_mov_b32 v16, v12
    v_mov_b32 v18, v14
    v_mov_b32 v17, v13
    v_mov_b32 v19, v15
    v_mov_b32 v32, 0
    buffer_load_dwordx4 v7, s[8:11], s25 offen offset:1024 lds
    v_mov_b32 v33, 0
    v_mov_b32 v34, 0
    v_mov_b32 v35, 0
    v_mov_b32 v36, 0
    v_mov_b32 v37, 0
    v_mov_b32 v38, 0
    v_mov_b32 v39, 0
    v_mov_b32 v40, 0
    buffer_load_dwordx4 v8, s[8:11], s25 offen offset:2048 lds
    v_mov_b32 v41, 0
    v_mov_b32 v42, 0
    v_mov_b32 v43, 0
    v_mov_b32 v44, 0
    v_mov_b32 v45, 0
    v_mov_b32 v46, 0
    v_mov_b32 v47, 0
    v_mov_b32 v48, 0
    buffer_load_dwordx4 v9, s[8:11], s25 offen offset:3072 lds
    v_mov_b32 v49, 0
    v_mov_b32 v50, 0
    v_mov_b32 v51, 0
    v_mov_b32 v52, 0
    v_mov_b32 v53, 0
    v_mov_b32 v54, 0
    v_mov_b32 v55, 0
    v_mov_b32 v56, 0
    s_add_u32 m0, s30, 20480
    s_nop 0
    buffer_load_dwordx4 v10, s[8:11], s25 offen offset:0 lds
    v_mov_b32 v57, 0
    v_mov_b32 v58, 0
    v_mov_b32 v59, 0
    v_mov_b32 v60, 0
    v_mov_b32 v61, 0
    v_mov_b32 v62, 0
    v_mov_b32 v63, 0
    v_mov_b32 v64, 0
    buffer_load_dwordx4 v11, s[8:11], s25 offen offset:1024 lds
    v_mov_b32 v65, 0
    v_mov_b32 v66, 0
    v_mov_b32 v67, 0
    v_mov_b32 v68, 0
    v_mov_b32 v69, 0
    v_mov_b32 v70, 0
    v_mov_b32 v71, 0
    v_mov_b32 v72, 0
    s_add_u32 s24, s24, 128
    s_add_u32 s25, s25, 393216
    s_add_u32 s26, s26, 40960
    s_add_u32 s30, s26, s31
    s_mov_b32 m0, s26
    s_nop 0
    buffer_load_dwordx4 v2, s[12:15], s24 offen offset:0 lds
    v_mov_b32 v73, 0
    v_mov_b32 v74, 0
    v_mov_b32 v75, 0
    v_mov_b32 v76, 0
    v_mov_b32 v77, 0
    v_mov_b32 v78, 0
    v_mov_b32 v79, 0
    v_mov_b32 v80, 0
    buffer_load_dwordx4 v3, s[12:15], s24 offen offset:1024 lds
    v_mov_b32 v81, 0
    v_mov_b32 v82, 0
    v_mov_b32 v83, 0
    v_mov_b32 v84, 0
    v_mov_b32 v85, 0
    v_mov_b32 v86, 0
    v_mov_b32 v87, 0
    v_mov_b32 v88, 0
    buffer_load_dwordx4 v4, s[12:15], s24 offen offset:2048 lds
    v_mov_b32 v89, 0
    v_mov_b32 v90, 0
    v_mov_b32 v91, 0
    v_mov_b32 v92, 0
    v_mov_b32 v93, 0
    v_mov_b32 v94, 0
    v_mov_b32 v95, 0
    v_mov_b32 v96, 0
    buffer_load_dwordx4 v5, s[12:15], s24 offen offset:3072 lds
    v_mov_b32 v97, 0
    v_mov_b32 v98, 0
    v_mov_b32 v99, 0
    v_mov_b32 v100, 0
    v_mov_b32 v101, 0
    v_mov_b32 v102, 0
    v_mov_b32 v103, 0
    v_mov_b32 v104, 0
    s_add_u32 m0, s30, 16384
    s_nop 0
    buffer_load_dwordx4 v6, s[8:11], s25 offen offset:0 lds
    v_mov_b32 v105, 0
    v_mov_b32 v106, 0
    v_mov_b32 v107, 0
    v_mov_b32 v108, 0
    v_mov_b32 v109, 0
    v_mov_b32 v110, 0
    v_mov_b32 v111, 0
    v_mov_b32 v112, 0
    buffer_load_dwordx4 v7, s[8:11], s25 offen offset:1024 lds
    v_mov_b32 v113, 0
    v_mov_b32 v114, 0
    v_mov_b32 v115, 0
    v_mov_b32 v116, 0
    v_mov_b32 v117, 0
    v_mov_b32 v118, 0
    v_mov_b32 v119, 0
    v_mov_b32 v120, 0
    buffer_load_dwordx4 v8, s[8:11], s25 offen offset:2048 lds
    v_mov_b32 v121, 0
    v_mov_b32 v122, 0
    v_mov_b32 v123, 0
    v_mov_b32 v124, 0
    v_mov_b32 v125, 0
    v_mov_b32 v126, 0
    v_mov_b32 v127, 0
    v_mov_b32 v168, 0
    buffer_load_dwordx4 v9, s[8:11], s25 offen offset:3072 lds
    v_mov_b32 v169, 0
    v_mov_b32 v170, 0
    v_mov_b32 v171, 0
    v_mov_b32 v172, 0
    v_mov_b32 v173, 0
    v_mov_b32 v174, 0
    v_mov_b32 v175, 0
    v_mov_b32 v176, 0
    s_add_u32 m0, s30, 20480
    s_nop 0
    buffer_load_dwordx4 v10, s[8:11], s25 offen offset:0 lds
    v_mov_b32 v177, 0
    v_mov_b32 v178, 0
    v_mov_b32 v179, 0
    v_mov_b32 v180, 0
    v_mov_b32 v181, 0
    v_mov_b32 v182, 0
    v_mov_b32 v183, 0
    v_mov_b32 v184, 0
    buffer_load_dwordx4 v11, s[8:11], s25 offen offset:1024 lds
    v_mov_b32 v185, 0
    v_mov_b32 v186, 0
    v_mov_b32 v187, 0
    v_mov_b32 v188, 0
    v_mov_b32 v189, 0
    v_mov_b32 v190, 0
    v_mov_b32 v191, 0
    v_mov_b32 v192, 0x3f803f80
    s_add_u32 s24, s24, 128
    s_add_u32 s25, s25, 393216
    s_add_u32 s26, s26, 40960
    s_add_u32 s30, s26, s31
    s_mov_b32 m0, s26
    s_nop 0
    buffer_load_dwordx4 v2, s[12:15], s24 offen offset:0 lds
    v_mov_b32 v193, 0x3f803f80
    v_mov_b32 v194, 0x3f803f80
    v_mov_b32 v195, 0x3f803f80
    v_lshrrev_b32 v23, 3, v1
    v_lshlrev_b32 v23, 11, v23
    v_bfe_u32 v24, v1, 1, 2
    v_lshrrev_b32 v25, 4, v1
    v_xor_b32 v24, v24, v25
    buffer_load_dwordx4 v3, s[12:15], s24 offen offset:1024 lds
    v_lshlrev_b32 v24, 5, v24
    v_and_b32 v25, 1, v1
    v_lshlrev_b32 v25, 4, v25
    v_add3_u32 v23, v23, v24, v25
    s_lshl_b32 s16, s20, 17
    v_add_u32 v196, s16, v23
    v_add_u32 v197, 15360, v196
    v_add_u32 v198, 30720, v196
    buffer_load_dwordx4 v4, s[12:15], s24 offen offset:2048 lds
    v_add_u32 v199, 46080, v196
    v_add_u32 v200, 65536, v196
    v_add_u32 v201, 80896, v196
    v_add_u32 v202, 96256, v196
    v_add_u32 v203, 111616, v196
    buffer_load_dwordx4 v5, s[12:15], s24 offen offset:3072 lds
    s_add_u32 m0, s30, 16384
    s_nop 0
    buffer_load_dwordx4 v6, s[8:11], s25 offen offset:0 lds

    s_lshr_b32 s23, s20, 1
    s_lshl_b32 s78, s20, 12

    s_waitcnt vmcnt(25)
    s_barrier
    ds_read_b128 a[0:3], v16 offset:0
    ds_read_b128 a[4:7], v16 offset:2048
    ds_read_b128 a[8:11], v16 offset:4096
    ds_read_b128 a[12:15], v16 offset:6144
    ds_read_b64_tr_b16 a[32:33], v18 offset:16384
    ds_read_b64_tr_b16 a[34:35], v18 offset:17920
    ds_read_b64_tr_b16 a[36:37], v19 offset:16384
    ds_read_b64_tr_b16 a[38:39], v19 offset:17920
    ds_read_b64_tr_b16 a[40:41], v18 offset:16512
    ds_read_b64_tr_b16 a[42:43], v18 offset:18048
    ds_read_b64_tr_b16 a[44:45], v19 offset:16512
    ds_read_b64_tr_b16 a[46:47], v19 offset:18048
    ds_read_b64_tr_b16 a[48:49], v18 offset:16640
    ds_read_b64_tr_b16 a[50:51], v18 offset:18176
    ds_read_b64_tr_b16 a[52:53], v19 offset:16640
    ds_read_b64_tr_b16 a[54:55], v19 offset:18176
    s_mov_b32 s28, 1
    s_mov_b32 s32, 99
    s_mov_b32 s33, 0

L1_disp:
    s_cmp_eq_u32 s23, 1
    s_cbranch_scc1 L1_loop1
.p2align 6
L1_loop0:
    s_waitcnt lgkmcnt(8)
    v_mfma_f32_16x16x32_bf16 v[32:35], a[32:35], a[0:3], v[32:35]
    ds_read_b128 a[16:19], v17 offset:0
    s_add_u32 s27, s27, 40960
    v_mfma_f32_16x16x32_bf16 v[36:39], a[32:35], a[4:7], v[36:39]
    ds_read_b128 a[20:23], v17 offset:2048
    s_cmp_ge_u32 s27, 163840
    v_mfma_f32_16x16x32_bf16 v[40:43], a[32:35], a[8:11], v[40:43]
    ds_read_b128 a[24:27], v17 offset:4096
    s_cselect_b32 s27, 0, s27
    v_mfma_f32_16x16x32_bf16 v[44:47], a[32:35], a[12:15], v[44:47]
    buffer_load_dwordx4 v7, s[8:11], s25 offen offset:1024 lds
    v_mfma_f32_16x16x32_bf16 v[60:63], a[36:39], a[12:15], v[60:63]
    ds_read_b128 a[28:31], v17 offset:6144
    v_mfma_f32_16x16x32_bf16 v[56:59], a[36:39], a[8:11], v[56:59]
    ds_read_b64_tr_b16 a[56:57], v18 offset:28672
    v_mfma_f32_16x16x32_bf16 v[52:55], a[36:39], a[4:7], v[52:55]
    ds_read_b64_tr_b16 a[58:59], v18 offset:30208
    v_mfma_f32_16x16x32_bf16 v[48:51], a[36:39], a[0:3], v[48:51]
    s_waitcnt lgkmcnt(10)
    buffer_load_dwordx4 v8, s[8:11], s25 offen offset:2048 lds
    v_mfma_f32_16x16x32_bf16 v[64:67], a[40:43], a[0:3], v[64:67]
    ds_read_b64_tr_b16 a[60:61], v19 offset:28672
    v_mfma_f32_16x16x32_bf16 v[68:71], a[40:43], a[4:7], v[68:71]
    ds_read_b64_tr_b16 a[62:63], v19 offset:30208
    v_mfma_f32_16x16x32_bf16 v[72:75], a[40:43], a[8:11], v[72:75]
    ds_read_b64_tr_b16 a[64:65], v18 offset:28800
    v_mfma_f32_16x16x32_bf16 v[76:79], a[40:43], a[12:15], v[76:79]
    buffer_load_dwordx4 v9, s[8:11], s25 offen offset:3072 lds
    v_mfma_f32_16x16x32_bf16 v[92:95], a[44:47], a[12:15], v[92:95]
    ds_read_b64_tr_b16 a[66:67], v18 offset:30336
    v_mfma_f32_16x16x32_bf16 v[88:91], a[44:47], a[8:11], v[88:91]
    ds_read_b64_tr_b16 a[68:69], v19 offset:28800
    v_mfma_f32_16x16x32_bf16 v[84:87], a[44:47], a[4:7], v[84:87]
    ds_read_b64_tr_b16 a[70:71], v19 offset:30336
    s_add_u32 m0, s30, 20480
    v_mfma_f32_16x16x32_bf16 v[80:83], a[44:47], a[0:3], v[80:83]
    s_waitcnt lgkmcnt(12)
    buffer_load_dwordx4 v10, s[8:11], s25 offen offset:0 lds
    v_mfma_f32_16x16x32_bf16 v[96:99], a[0:3], a[48:51], v[96:99]
    ds_read_b64_tr_b16 a[72:73], v18 offset:28928
    v_mfma_f32_16x16x32_bf16 v[100:103], a[4:7], a[48:51], v[100:103]
    ds_read_b64_tr_b16 a[74:75], v18 offset:30464
    v_mfma_f32_16x16x32_bf16 v[104:107], a[8:11], a[48:51], v[104:107]
    ds_read_b64_tr_b16 a[76:77], v19 offset:28928
    v_mfma_f32_16x16x32_bf16 v[108:111], a[12:15], a[48:51], v[108:111]
    buffer_load_dwordx4 v11, s[8:11], s25 offen offset:1024 lds
    v_mfma_f32_16x16x32_bf16 v[124:127], a[12:15], a[52:55], v[124:127]
    ds_read_b64_tr_b16 a[78:79], v19 offset:30464
    s_add_u32 s24, s24, 128
    v_mfma_f32_16x16x32_bf16 v[120:123], a[8:11], a[52:55], v[120:123]
    s_add_u32 s25, s25, 393216
    v_mfma_f32_16x16x32_bf16 v[116:119], a[4:7], a[52:55], v[116:119]
    s_add_u32 s3, s26, 40960
    s_cmp_eq_u32 s3, s29
    v_mfma_f32_16x16x32_bf16 v[112:115], a[0:3], a[52:55], v[112:115]
    s_cselect_b32 s26, s78, s3
    s_add_u32 s30, s26, s31
    v_mfma_f32_16x16x32_bf16 v[168:171], a[32:35], v[192:195], v[168:171]
    v_mfma_f32_16x16x32_bf16 v[172:175], a[36:39], v[192:195], v[172:175]
    v_mfma_f32_16x16x32_bf16 v[176:179], a[40:43], v[192:195], v[176:179]
    v_mfma_f32_16x16x32_bf16 v[180:183], a[44:47], v[192:195], v[180:183]
    v_mfma_f32_16x16x32_bf16 v[184:187], v[192:195], a[48:51], v[184:187]
    v_mfma_f32_16x16x32_bf16 v[188:191], v[192:195], a[52:55], v[188:191]
    s_waitcnt lgkmcnt(8)
    v_mfma_f32_16x16x32_bf16 v[32:35], a[56:59], a[16:19], v[32:35]
    s_waitcnt vmcnt(20)
    s_waitcnt lgkmcnt(0)
    s_barrier
    s_cmp_eq_u32 s28, s32
    s_cbranch_scc1 L1_pub0
L1_pubr0:
    v_mfma_f32_16x16x32_bf16 v[36:39], a[56:59], a[20:23], v[36:39]
    v_add_u32 v16, s27, v12
    v_add_u32 v18, s27, v14
    v_mfma_f32_16x16x32_bf16 v[40:43], a[56:59], a[24:27], v[40:43]
    v_add_u32 v19, s27, v15
    v_add_u32 v17, s27, v13
    v_mfma_f32_16x16x32_bf16 v[44:47], a[56:59], a[28:31], v[44:47]
    ds_read_b128 a[0:3], v16 offset:0
    v_mfma_f32_16x16x32_bf16 v[60:63], a[60:63], a[28:31], v[60:63]
    ds_read_b128 a[4:7], v16 offset:2048
    v_mfma_f32_16x16x32_bf16 v[56:59], a[60:63], a[24:27], v[56:59]
    ds_read_b128 a[8:11], v16 offset:4096
    s_mov_b32 m0, s26
    v_mfma_f32_16x16x32_bf16 v[52:55], a[60:63], a[20:23], v[52:55]
    buffer_load_dwordx4 v2, s[12:15], s24 offen offset:0 lds
    v_mfma_f32_16x16x32_bf16 v[48:51], a[60:63], a[16:19], v[48:51]
    ds_read_b128 a[12:15], v16 offset:6144
    v_mfma_f32_16x16x32_bf16 v[64:67], a[64:67], a[16:19], v[64:67]
    ds_read_b64_tr_b16 a[32:33], v18 offset:16384
    v_mfma_f32_16x16x32_bf16 v[68:71], a[64:67], a[20:23], v[68:71]
    ds_read_b64_tr_b16 a[34:35], v18 offset:17920
    v_mfma_f32_16x16x32_bf16 v[72:75], a[64:67], a[24:27], v[72:75]
    buffer_load_dwordx4 v3, s[12:15], s24 offen offset:1024 lds
    v_mfma_f32_16x16x32_bf16 v[76:79], a[64:67], a[28:31], v[76:79]
    ds_read_b64_tr_b16 a[36:37], v19 offset:16384
    v_mfma_f32_16x16x32_bf16 v[92:95], a[68:71], a[28:31], v[92:95]
    ds_read_b64_tr_b16 a[38:39], v19 offset:17920
    v_mfma_f32_16x16x32_bf16 v[88:91], a[68:71], a[24:27], v[88:91]
    ds_read_b64_tr_b16 a[40:41], v18 offset:16512
    v_mfma_f32_16x16x32_bf16 v[84:87], a[68:71], a[20:23], v[84:87]
    buffer_load_dwordx4 v4, s[12:15], s24 offen offset:2048 lds
    v_mfma_f32_16x16x32_bf16 v[80:83], a[68:71], a[16:19], v[80:83]
    ds_read_b64_tr_b16 a[42:43], v18 offset:18048
    v_mfma_f32_16x16x32_bf16 v[96:99], a[16:19], a[72:75], v[96:99]
    ds_read_b64_tr_b16 a[44:45], v19 offset:16512
    v_mfma_f32_16x16x32_bf16 v[100:103], a[20:23], a[72:75], v[100:103]
    ds_read_b64_tr_b16 a[46:47], v19 offset:18048
    v_mfma_f32_16x16x32_bf16 v[104:107], a[24:27], a[72:75], v[104:107]
    buffer_load_dwordx4 v5, s[12:15], s24 offen offset:3072 lds
    v_mfma_f32_16x16x32_bf16 v[108:111], a[28:31], a[72:75], v[108:111]
    ds_read_b64_tr_b16 a[48:49], v18 offset:16640
    v_mfma_f32_16x16x32_bf16 v[124:127], a[28:31], a[76:79], v[124:127]
    ds_read_b64_tr_b16 a[50:51], v18 offset:18176
    v_mfma_f32_16x16x32_bf16 v[120:123], a[24:27], a[76:79], v[120:123]
    ds_read_b64_tr_b16 a[52:53], v19 offset:16640
    s_add_u32 m0, s30, 16384
    v_mfma_f32_16x16x32_bf16 v[116:119], a[20:23], a[76:79], v[116:119]
    buffer_load_dwordx4 v6, s[8:11], s25 offen offset:0 lds
    v_mfma_f32_16x16x32_bf16 v[112:115], a[16:19], a[76:79], v[112:115]
    ds_read_b64_tr_b16 a[54:55], v19 offset:18176
    s_sub_u32 s28, s28, 1
    s_cmp_lg_u32 s28, 0
    s_cbranch_scc1 L1_loop0
    s_branch L1_after
.p2align 6
L1_loop1:
    s_waitcnt lgkmcnt(8)
    v_mfma_f32_16x16x32_bf16 v[32:35], a[32:35], a[0:3], v[32:35]
    ds_read_b128 a[16:19], v17 offset:0
    s_add_u32 s27, s27, 40960
    v_mfma_f32_16x16x32_bf16 v[36:39], a[32:35], a[4:7], v[36:39]
    ds_read_b128 a[20:23], v17 offset:2048
    s_cmp_ge_u32 s27, 163840
    v_mfma_f32_16x16x32_bf16 v[40:43], a[32:35], a[8:11], v[40:43]
    ds_read_b128 a[24:27], v17 offset:4096
    s_cselect_b32 s27, 0, s27
    v_mfma_f32_16x16x32_bf16 v[44:47], a[32:35], a[12:15], v[44:47]
    buffer_load_dwordx4 v7, s[8:11], s25 offen offset:1024 lds
    v_mfma_f32_16x16x32_bf16 v[60:63], a[36:39], a[12:15], v[60:63]
    ds_read_b128 a[28:31], v17 offset:6144
    v_mfma_f32_16x16x32_bf16 v[56:59], a[36:39], a[8:11], v[56:59]
    ds_read_b64_tr_b16 a[56:57], v18 offset:28672
    v_mfma_f32_16x16x32_bf16 v[52:55], a[36:39], a[4:7], v[52:55]
    ds_read_b64_tr_b16 a[58:59], v18 offset:30208
    v_mfma_f32_16x16x32_bf16 v[48:51], a[36:39], a[0:3], v[48:51]
    s_waitcnt lgkmcnt(10)
    buffer_load_dwordx4 v8, s[8:11], s25 offen offset:2048 lds
    v_mfma_f32_16x16x32_bf16 v[64:67], a[40:43], a[0:3], v[64:67]
    ds_read_b64_tr_b16 a[60:61], v19 offset:28672
    v_mfma_f32_16x16x32_bf16 v[68:71], a[40:43], a[4:7], v[68:71]
    ds_read_b64_tr_b16 a[62:63], v19 offset:30208
    v_mfma_f32_16x16x32_bf16 v[72:75], a[40:43], a[8:11], v[72:75]
    ds_read_b64_tr_b16 a[64:65], v18 offset:28800
    v_mfma_f32_16x16x32_bf16 v[76:79], a[40:43], a[12:15], v[76:79]
    buffer_load_dwordx4 v9, s[8:11], s25 offen offset:3072 lds
    v_mfma_f32_16x16x32_bf16 v[92:95], a[44:47], a[12:15], v[92:95]
    ds_read_b64_tr_b16 a[66:67], v18 offset:30336
    v_mfma_f32_16x16x32_bf16 v[88:91], a[44:47], a[8:11], v[88:91]
    ds_read_b64_tr_b16 a[68:69], v19 offset:28800
    v_mfma_f32_16x16x32_bf16 v[84:87], a[44:47], a[4:7], v[84:87]
    ds_read_b64_tr_b16 a[70:71], v19 offset:30336
    s_add_u32 m0, s30, 20480
    v_mfma_f32_16x16x32_bf16 v[80:83], a[44:47], a[0:3], v[80:83]
    s_waitcnt lgkmcnt(12)
    buffer_load_dwordx4 v10, s[8:11], s25 offen offset:0 lds
    v_mfma_f32_16x16x32_bf16 v[96:99], a[0:3], a[48:51], v[96:99]
    ds_read_b64_tr_b16 a[72:73], v18 offset:28928
    v_mfma_f32_16x16x32_bf16 v[100:103], a[4:7], a[48:51], v[100:103]
    ds_read_b64_tr_b16 a[74:75], v18 offset:30464
    v_mfma_f32_16x16x32_bf16 v[104:107], a[8:11], a[48:51], v[104:107]
    ds_read_b64_tr_b16 a[76:77], v19 offset:28928
    v_mfma_f32_16x16x32_bf16 v[108:111], a[12:15], a[48:51], v[108:111]
    buffer_load_dwordx4 v11, s[8:11], s25 offen offset:1024 lds
    v_mfma_f32_16x16x32_bf16 v[124:127], a[12:15], a[52:55], v[124:127]
    ds_read_b64_tr_b16 a[78:79], v19 offset:30464
    s_add_u32 s24, s24, 128
    v_mfma_f32_16x16x32_bf16 v[120:123], a[8:11], a[52:55], v[120:123]
    s_add_u32 s25, s25, 393216
    v_mfma_f32_16x16x32_bf16 v[116:119], a[4:7], a[52:55], v[116:119]
    s_add_u32 s3, s26, 40960
    s_cmp_eq_u32 s3, s29
    v_mfma_f32_16x16x32_bf16 v[112:115], a[0:3], a[52:55], v[112:115]
    s_cselect_b32 s26, s78, s3
    s_add_u32 s30, s26, s31
    s_waitcnt lgkmcnt(8)
    v_mfma_f32_16x16x32_bf16 v[32:35], a[56:59], a[16:19], v[32:35]
    s_waitcnt vmcnt(20)
    s_waitcnt lgkmcnt(0)
    s_barrier
    s_cmp_eq_u32 s28, s32
    s_cbranch_scc1 L1_pub1
L1_pubr1:
    v_mfma_f32_16x16x32_bf16 v[36:39], a[56:59], a[20:23], v[36:39]
    v_add_u32 v16, s27, v12
    v_add_u32 v18, s27, v14
    v_mfma_f32_16x16x32_bf16 v[40:43], a[56:59], a[24:27], v[40:43]
    v_add_u32 v19, s27, v15
    v_add_u32 v17, s27, v13
    v_mfma_f32_16x16x32_bf16 v[44:47], a[56:59], a[28:31], v[44:47]
    ds_read_b128 a[0:3], v16 offset:0
    v_mfma_f32_16x16x32_bf16 v[60:63], a[60:63], a[28:31], v[60:63]
    ds_read_b128 a[4:7], v16 offset:2048
    v_mfma_f32_16x16x32_bf16 v[56:59], a[60:63], a[24:27], v[56:59]
    ds_read_b128 a[8:11], v16 offset:4096
    s_mov_b32 m0, s26
    v_mfma_f32_16x16x32_bf16 v[52:55], a[60:63], a[20:23], v[52:55]
    buffer_load_dwordx4 v2, s[12:15], s24 offen offset:0 lds
    v_mfma_f32_16x16x32_bf16 v[48:51], a[60:63], a[16:19], v[48:51]
    ds_read_b128 a[12:15], v16 offset:6144
    v_mfma_f32_16x16x32_bf16 v[64:67], a[64:67], a[16:19], v[64:67]
    ds_read_b64_tr_b16 a[32:33], v18 offset:16384
    v_mfma_f32_16x16x32_bf16 v[68:71], a[64:67], a[20:23], v[68:71]
    ds_read_b64_tr_b16 a[34:35], v18 offset:17920
    v_mfma_f32_16x16x32_bf16 v[72:75], a[64:67], a[24:27], v[72:75]
    buffer_load_dwordx4 v3, s[12:15], s24 offen offset:1024 lds
    v_mfma_f32_16x16x32_bf16 v[76:79], a[64:67], a[28:31], v[76:79]
    ds_read_b64_tr_b16 a[36:37], v19 offset:16384
    v_mfma_f32_16x16x32_bf16 v[92:95], a[68:71], a[28:31], v[92:95]
    ds_read_b64_tr_b16 a[38:39], v19 offset:17920
    v_mfma_f32_16x16x32_bf16 v[88:91], a[68:71], a[24:27], v[88:91]
    ds_read_b64_tr_b16 a[40:41], v18 offset:16512
    v_mfma_f32_16x16x32_bf16 v[84:87], a[68:71], a[20:23], v[84:87]
    buffer_load_dwordx4 v4, s[12:15], s24 offen offset:2048 lds
    v_mfma_f32_16x16x32_bf16 v[80:83], a[68:71], a[16:19], v[80:83]
    ds_read_b64_tr_b16 a[42:43], v18 offset:18048
    v_mfma_f32_16x16x32_bf16 v[96:99], a[16:19], a[72:75], v[96:99]
    ds_read_b64_tr_b16 a[44:45], v19 offset:16512
    v_mfma_f32_16x16x32_bf16 v[100:103], a[20:23], a[72:75], v[100:103]
    ds_read_b64_tr_b16 a[46:47], v19 offset:18048
    v_mfma_f32_16x16x32_bf16 v[104:107], a[24:27], a[72:75], v[104:107]
    buffer_load_dwordx4 v5, s[12:15], s24 offen offset:3072 lds
    v_mfma_f32_16x16x32_bf16 v[108:111], a[28:31], a[72:75], v[108:111]
    ds_read_b64_tr_b16 a[48:49], v18 offset:16640
    v_mfma_f32_16x16x32_bf16 v[124:127], a[28:31], a[76:79], v[124:127]
    ds_read_b64_tr_b16 a[50:51], v18 offset:18176
    v_mfma_f32_16x16x32_bf16 v[120:123], a[24:27], a[76:79], v[120:123]
    ds_read_b64_tr_b16 a[52:53], v19 offset:16640
    s_add_u32 m0, s30, 16384
    v_mfma_f32_16x16x32_bf16 v[116:119], a[20:23], a[76:79], v[116:119]
    buffer_load_dwordx4 v6, s[8:11], s25 offen offset:0 lds
    v_mfma_f32_16x16x32_bf16 v[112:115], a[16:19], a[76:79], v[112:115]
    ds_read_b64_tr_b16 a[54:55], v19 offset:18176
    v_mfma_f32_16x16x32_bf16 v[168:171], a[56:59], v[192:195], v[168:171]
    v_mfma_f32_16x16x32_bf16 v[172:175], a[60:63], v[192:195], v[172:175]
    v_mfma_f32_16x16x32_bf16 v[176:179], a[64:67], v[192:195], v[176:179]
    v_mfma_f32_16x16x32_bf16 v[180:183], a[68:71], v[192:195], v[180:183]
    v_mfma_f32_16x16x32_bf16 v[184:187], v[192:195], a[72:75], v[184:187]
    v_mfma_f32_16x16x32_bf16 v[188:191], v[192:195], a[76:79], v[188:191]
    s_sub_u32 s28, s28, 1
    s_cmp_lg_u32 s28, 0
    s_cbranch_scc1 L1_loop1
    s_branch L1_after
L1_pub0:
    v_mov_b32 v24, 1
    s_and_b32 s16, s2, 1
    s_lshl_b32 s16, s16, 7
    buffer_atomic_add v24, v30, s[40:43], s16 offen sc1
    s_branch L1_pubr0
L1_pub1:
    v_mov_b32 v24, 1
    s_and_b32 s16, s2, 1
    s_lshl_b32 s16, s16, 7
    buffer_atomic_add v24, v30, s[40:43], s16 offen sc1
    s_branch L1_pubr1
L1_after:
    s_cmp_eq_u32 s33, 0
    s_cbranch_scc1 L1_mid0
    s_cmp_eq_u32 s33, 1
    s_cbranch_scc1 L1_mid1
    s_cmp_eq_u32 s33, 2
    s_cbranch_scc1 L1_mid2
    s_cmp_eq_u32 s33, 3
    s_cbranch_scc1 L1_mid3
    s_cmp_eq_u32 s33, 4
    s_cbranch_scc1 L1_mid4
    s_branch L1_end
L1_mid0:
    s_lshl_b32 s16, s2, 3
    s_lshl_b32 s17, s20, 2
    s_add_u32 s16, s16, s17
    s_lshl_b32 s16, s16, 11
    v_lshrrev_b32 v24, 2, v1
    v_lshlrev_b32 v24, 11, v24
    v_and_b32 v25, 3, v1
    v_lshlrev_b32 v25, 7, v25
    v_add3_u32 v24, v24, v25, s16
    s_lshl_b32 s17, s2, 1
    s_add_u32 s17, s17, s20
    s_sub_u32 s17, s17, 2
    s_mul_i32 s17, s17, 3072
    v_lshlrev_b32 v25, 7, v1
    v_add_u32 v25, s17, v25
    s_cmp_ge_u32 s20, 2
    s_cselect_b32 s18, 24, 16
    s_cselect_b64 vcc, -1, 0
    s_nop 1
    v_cndmask_b32 v24, v24, v25, vcc
    v_mov_b32 v25, 0x10000000
    v_cmp_gt_u32 vcc, s18, v1
    s_nop 1
    v_cndmask_b32 v21, v25, v24, vcc
    s_lshr_b32 s76, s76, 1
    buffer_load_dword v29, v21, s[80:83], s77 offen
    s_add_u32 s77, s77, s76
    s_lshl_b32 s16, s21, 4
    s_add_u32 s16, s16, s22
    s_lshl_b32 s16, s16, 8
    s_add_u32 s16, s16, 41943040
    s_lshl_b32 s17, s2, 8
    s_add_u32 s18, s17, 42074112
    s_add_u32 s17, s17, 42008576
    s_add_u32 s19, s18, 65536
    s_cmp_lt_u32 s2, 64
    s_cselect_b32 s19, s19, 0x10000000
    v_mov_b32 v24, 0x10000000
    v_mov_b32 v25, s16
    v_cmp_eq_u32 vcc, 0, v0
    s_nop 1
    v_cndmask_b32 v24, v24, v25, vcc
    v_mov_b32 v25, s17
    v_cmp_eq_u32 vcc, 1, v0
    s_nop 1
    v_cndmask_b32 v24, v24, v25, vcc
    v_mov_b32 v25, s18
    v_cmp_eq_u32 vcc, 2, v0
    s_nop 1
    v_cndmask_b32 v24, v24, v25, vcc
    v_mov_b32 v25, s19
    v_cmp_eq_u32 vcc, 3, v0
    s_nop 1
    v_cndmask_b32 v24, v24, v25, vcc
    v_mov_b32 v25, 0
    buffer_store_dword v25, v24, s[4:7], 0 offen sc1
    s_lshl_b32 s16, s22, 14
    s_lshl_b32 s17, s20, 12
    s_add_u32 s16, s16, s17
    v_lshlrev_b32 v23, 4, v1
    buffer_load_dwordx4 v[128:131], v23, s[12:15], s16 offen offset:0
    buffer_load_dwordx4 v[132:135], v23, s[12:15], s16 offen offset:1024
    buffer_load_dwordx4 v[136:139], v23, s[12:15], s16 offen offset:2048
    buffer_load_dwordx4 v[140:143], v23, s[12:15], s16 offen offset:3072
    s_mov_b32 s36, s88
    s_mov_b32 s37, s89
    s_mov_b32 s38, 2097152
    s_mov_b32 s39, 0x20000
    s_lshl_b32 s16, s2, 2
    s_add_u32 s16, s16, s20
    s_lshl_b32 s16, s16, 11
    buffer_load_dwordx4 v[152:155], v23, s[36:39], s16 offen offset:0
    buffer_load_dwordx4 v[156:159], v23, s[36:39], s16 offen offset:1024
    s_mov_b32 s33, 1
    s_mov_b32 s28, 3
    s_branch L1_disp
L1_mid1:
    v_mov_b32 v24, 0x3f803f80
    v_dot2_f32_bf16 v144, v128, v24, 0
    v_dot2_f32_bf16 v145, v128, v128, 0
    v_dot2_f32_bf16 v144, v129, v24, v144
    v_dot2_f32_bf16 v145, v129, v129, v145
    v_dot2_f32_bf16 v144, v130, v24, v144
    v_dot2_f32_bf16 v145, v130, v130, v145
    v_dot2_f32_bf16 v144, v131, v24, v144
    v_dot2_f32_bf16 v145, v131, v131, v145
    v_dot2_f32_bf16 v144, v132, v24, v144
    v_dot2_f32_bf16 v145, v132, v132, v145
    v_dot2_f32_bf16 v144, v133, v24, v144
    v_dot2_f32_bf16 v145, v133, v133, v145
    v_dot2_f32_bf16 v144, v134, v24, v144
    v_dot2_f32_bf16 v145, v134, v134, v145
    v_dot2_f32_bf16 v144, v135, v24, v144
    v_dot2_f32_bf16 v145, v135, v135, v145
    v_dot2_f32_bf16 v146, v136, v24, 0
    v_dot2_f32_bf16 v147, v136, v136, 0
    v_dot2_f32_bf16 v146, v137, v24, v146
    v_dot2_f32_bf16 v147, v137, v137, v147
    v_dot2_f32_bf16 v146, v138, v24, v146
    v_dot2_f32_bf16 v147, v138, v138, v147
    v_dot2_f32_bf16 v146, v139, v24, v146
    v_dot2_f32_bf16 v147, v139, v139, v147
    v_dot2_f32_bf16 v146, v140, v24, v146
    v_dot2_f32_bf16 v147, v140, v140, v147
    v_dot2_f32_bf16 v146, v141, v24, v146
    v_dot2_f32_bf16 v147, v141, v141, v147
    v_dot2_f32_bf16 v146, v142, v24, v146
    v_dot2_f32_bf16 v147, v142, v142, v147
    v_dot2_f32_bf16 v146, v143, v24, v146
    v_dot2_f32_bf16 v147, v143, v143, v147
    v_dot2_f32_bf16 v148, v152, v24, 0
    v_dot2_f32_bf16 v148, v153, v24, v148
    v_dot2_f32_bf16 v148, v154, v24, v148
    v_dot2_f32_bf16 v148, v155, v24, v148
    v_dot2_f32_bf16 v148, v156, v24, v148
    v_dot2_f32_bf16 v148, v157, v24, v148
    v_dot2_f32_bf16 v148, v158, v24, v148
    v_dot2_f32_bf16 v148, v159, v24, v148
    s_nop 2
    s_nop 1
    v_add_f32_dpp v144, v144, v144 row_ror:8 row_mask:0xf bank_mask:0xf
    v_add_f32_dpp v145, v145, v145 row_ror:8 row_mask:0xf bank_mask:0xf
    v_add_f32_dpp v146, v146, v146 row_ror:8 row_mask:0xf bank_mask:0xf
    v_add_f32_dpp v147, v147, v147 row_ror:8 row_mask:0xf bank_mask:0xf
    v_add_f32_dpp v148, v148, v148 row_ror:8 row_mask:0xf bank_mask:0xf
    s_nop 1
    v_add_f32_dpp v144, v144, v144 row_ror:4 row_mask:0xf bank_mask:0xf
    v_add_f32_dpp v145, v145, v145 row_ror:4 row_mask:0xf bank_mask:0xf
    v_add_f32_dpp v146, v146, v146 row_ror:4 row_mask:0xf bank_mask:0xf
    v_add_f32_dpp v147, v147, v147 row_ror:4 row_mask:0xf bank_mask:0xf
    v_add_f32_dpp v148, v148, v148 row_ror:4 row_mask:0xf bank_mask:0xf
    s_nop 1
    v_add_f32_dpp v144, v144, v144 row_ror:2 row_mask:0xf bank_mask:0xf
    v_add_f32_dpp v145, v145, v145 row_ror:2 row_mask:0xf bank_mask:0xf
    v_add_f32_dpp v146, v146, v146 row_ror:2 row_mask:0xf bank_mask:0xf
    v_add_f32_dpp v147, v147, v147 row_ror:2 row_mask:0xf bank_mask:0xf
    v_add_f32_dpp v148, v148, v148 row_ror:2 row_mask:0xf bank_mask:0xf
    s_nop 1
    v_add_f32_dpp v144, v144, v144 row_ror:1 row_mask:0xf bank_mask:0xf
    v_add_f32_dpp v145, v145, v145 row_ror:1 row_mask:0xf bank_mask:0xf
    v_add_f32_dpp v146, v146, v146 row_ror:1 row_mask:0xf bank_mask:0xf
    v_add_f32_dpp v147, v147, v147 row_ror:1 row_mask:0xf bank_mask:0xf
    v_add_f32_dpp v148, v148, v148 row_ror:1 row_mask:0xf bank_mask:0xf
    v_mov_b32 v128, v144
    v_mov_b32 v129, v145
    v_mov_b32 v130, v146
    v_mov_b32 v131, v147
    v_mov_b32 v132, v148
    s_nop 1
    v_permlane16_swap_b32 v144, v128
    v_permlane16_swap_b32 v145, v129
    v_permlane16_swap_b32 v146, v130
    v_permlane16_swap_b32 v147, v131
    v_permlane16_swap_b32 v148, v132
    s_nop 1
    v_add_f32 v144, v144, v128
    v_add_f32 v145, v145, v129
    v_add_f32 v146, v146, v130
    v_add_f32 v147, v147, v131
    v_add_f32 v148, v148, v132
    v_mov_b32 v128, v144
    v_mov_b32 v129, v145
    v_mov_b32 v130, v146
    v_mov_b32 v131, v147
    v_mov_b32 v132, v148
    s_nop 1
    v_permlane32_swap_b32 v144, v128
    v_permlane32_swap_b32 v145, v129
    v_permlane32_swap_b32 v146, v130
    v_permlane32_swap_b32 v147, v131
    v_permlane32_swap_b32 v148, v132
    s_nop 1
    v_add_f32 v144, v144, v128
    v_add_f32 v145, v145, v129
    v_add_f32 v146, v146, v130
    v_add_f32 v147, v147, v131
    v_add_f32 v148, v148, v132
    s_mov_b32 s16, 0x3a800000
    v_mul_f32 v25, s16, v148
    v_cvt_pk_bf16_f32 v26, v25, v25
    v_lshlrev_b32 v27, 16, v26
    v_sub_f32 v27, v25, v27
    v_cvt_pk_bf16_f32 v27, v27, v27
    v_cmp_eq_u32 vcc, 1, v1
    s_nop 1
    v_cndmask_b32 v26, v26, v27, vcc
    s_lshl_b32 s16, s2, 2
    s_add_u32 s16, s16, s20
    s_lshr_b32 s17, s16, 5
    s_lshl_b32 s17, s17, 7
    s_bfe_u32 s18, s16, 0x20002
    s_lshl_b32 s18, s18, 5
    s_add_u32 s17, s17, s18
    s_bfe_u32 s18, s16, 0x10004
    s_lshl_b32 s18, s18, 3
    s_add_u32 s17, s17, s18
    s_and_b32 s18, s16, 3
    s_lshl_b32 s18, s18, 1
    s_add_u32 s17, s17, s18
    s_add_u32 s17, s17, 40108032
    v_lshlrev_b32 v23, 4, v1
    v_mov_b32 v25, 0x10000000
    v_cmp_gt_u32 vcc, 2, v1
    s_nop 1
    v_cndmask_b32 v23, v25, v23, vcc
    buffer_store_short v26, v23, s[4:7], s17 offen sc1
    v_cmp_eq_u32 vcc, 1, v1
    s_nop 1
    v_cndmask_b32 v26, v144, v146, vcc
    v_cndmask_b32 v27, v145, v147, vcc
    s_mov_b32 s16, 0x3a800000
    s_mov_b32 s17, 0x3727c5ac
    v_mul_f32 v26, s16, v26
    v_mul_f32 v27, s16, v27
    v_fma_f32 v27, -v26, v26, v27
    v_add_f32 v27, s17, v27
    v_rsq_f32 v27, v27
    s_lshl_b32 s16, s21, 10
    s_lshl_b32 s17, s22, 6
    s_add_u32 s16, s16, s17
    s_lshl_b32 s17, s20, 4
    s_add_u32 s16, s16, s17
    s_add_u32 s16, s16, 39845888
    v_lshlrev_b32 v23, 3, v1
    v_mov_b32 v24, 0x10000000
    v_cmp_gt_u32 vcc, 2, v1
    s_nop 1
    v_cndmask_b32 v23, v24, v23, vcc
    buffer_store_dwordx2 v[26:27], v23, s[4:7], s16 offen sc1
    s_cmp_eq_u32 s20, 0
    s_cselect_b32 s32, 1, 99
    s_mov_b32 s33, 2
    s_mov_b32 s28, 3
    s_branch L1_disp
L1_mid2:
    s_mov_b32 s32, 99
    buffer_load_dword v29, v21, s[80:83], s77 offen
    s_add_u32 s77, s77, s76
    s_mov_b32 s33, 3
    s_mov_b32 s28, 3
    s_branch L1_disp
L1_mid3:
    v_lshlrev_b32 v28, 7, v1
    v_cmp_gt_u32 vcc, 2, v1
    v_mov_b32 v31, 0x10000000
    s_nop 0
    v_cndmask_b32 v28, v31, v28, vcc
    buffer_load_dword v31, v28, s[40:43], 0 offen sc1
    s_mov_b32 s33, 4
    s_mov_b32 s28, 3
    s_branch L1_disp
L1_mid4:
    v_readlane_b32 s17, v31, 0
    v_readlane_b32 s18, v31, 1
    s_min_u32 s17, s17, s18
    s_cmp_ge_u32 s17, 128
    s_cbranch_scc1 Lm_1
    s_mov_b32 s19, 0
Lmp_2:
    s_add_u32 s19, s19, 1
    s_cmp_gt_u32 s19, 300000
    s_cbranch_scc1 Lm_1
    buffer_load_dword v31, v28, s[40:43], 0 offen sc1
    s_waitcnt vmcnt(0)
    v_readlane_b32 s17, v31, 0
    v_readlane_b32 s18, v31, 1
    s_min_u32 s17, s17, s18
    s_cmp_ge_u32 s17, 128
    s_cbranch_scc0 Lmp_2
Lm_1:
    s_lshl_b32 s16, s21, 10
    s_lshr_b32 s17, s20, 1
    s_lshl_b32 s17, s17, 9
    s_add_u32 s16, s16, s17
    s_add_u32 s16, s16, 39845888
    v_and_b32 v23, 15, v1
    v_lshlrev_b32 v23, 3, v23
    buffer_load_dwordx2 v[128:129], v23, s[4:7], s16 offen offset:0 sc1
    buffer_load_dwordx2 v[130:131], v23, s[4:7], s16 offen offset:128 sc1
    buffer_load_dwordx2 v[132:133], v23, s[4:7], s16 offen offset:256 sc1
    buffer_load_dwordx2 v[134:135], v23, s[4:7], s16 offen offset:384 sc1
    v_lshrrev_b32 v23, 4, v1
    v_lshlrev_b32 v23, 5, v23
    buffer_load_dwordx4 v[136:139], v23, s[4:7], s16 offen offset:0 sc1
    buffer_load_dwordx4 v[140:143], v23, s[4:7], s16 offen offset:16 sc1
    buffer_load_dwordx4 v[144:147], v23, s[4:7], s16 offen offset:128 sc1
    buffer_load_dwordx4 v[148:151], v23, s[4:7], s16 offen offset:144 sc1
    buffer_load_dwordx4 v[152:155], v23, s[4:7], s16 offen offset:256 sc1
    buffer_load_dwordx4 v[156:159], v23, s[4:7], s16 offen offset:272 sc1
    buffer_load_dwordx4 v[160:163], v23, s[4:7], s16 offen offset:384 sc1
    buffer_load_dwordx4 v[164:167], v23, s[4:7], s16 offen offset:400 sc1
    s_mov_b32 s33, 5
    s_mov_b32 s28, 3
    s_branch L1_disp
L1_end:

    s_waitcnt vmcnt(0) lgkmcnt(0)
    s_barrier
    s_lshl_b32 s16, s73, 7
    s_add_u32 s8, s88, s16
    s_addc_u32 s9, s89, 0
    s_sub_u32 s10, 2097152, s16
    s_mov_b32 s11, 0x20000
    s_lshl_b32 s16, s72, 18
    s_add_u32 s12, s84, s16
    s_addc_u32 s13, s85, 0
    s_sub_u32 s14, 0x400000, s16
    s_mov_b32 s15, 0x20000
    v_mov_b32 v185, v188
    s_mul_i32 s16, s20, 5120
    s_add_u32 s16, s16, 133120
    s_xor_b32 s17, s20, 2
    s_mul_i32 s17, s17, 5120
    s_add_u32 s17, s17, 133120
    v_lshlrev_b32 v23, 4, v1
    v_add_u32 v24, s17, v23
    v_add_u32 v23, s16, v23
    ds_write_b128 v23, v[168:171] offset:0
    ds_write_b128 v23, v[172:175] offset:1024
    ds_write_b128 v23, v[176:179] offset:2048
    ds_write_b128 v23, v[180:183] offset:3072
    ds_write_b128 v23, v[184:187] offset:4096
    s_waitcnt lgkmcnt(0)
    s_barrier
    ds_read_b128 v[2:5], v24 offset:0
    ds_read_b128 v[6:9], v24 offset:1024
    ds_read_b128 v[10:13], v24 offset:2048
    ds_read_b128 v[14:17], v24 offset:3072
    ds_read_b128 v[18:21], v24 offset:4096
    s_waitcnt lgkmcnt(0)
    v_add_f32 v168, v168, v2
    v_add_f32 v169, v169, v3
    v_add_f32 v170, v170, v4
    v_add_f32 v171, v171, v5
    v_add_f32 v172, v172, v6
    v_add_f32 v173, v173, v7
    v_add_f32 v174, v174, v8
    v_add_f32 v175, v175, v9
    v_add_f32 v176, v176, v10
    v_add_f32 v177, v177, v11
    v_add_f32 v178, v178, v12
    v_add_f32 v179, v179, v13
    v_add_f32 v180, v180, v14
    v_add_f32 v181, v181, v15
    v_add_f32 v182, v182, v16
    v_add_f32 v183, v183, v17
    v_add_f32 v184, v184, v18
    v_add_f32 v185, v185, v19
    s_and_b32 s16, s20, 1
    s_lshl_b32 s17, s22, 1
    s_add_u32 s16, s16, s17
    s_lshr_b32 s17, s20, 1
    s_lshl_b32 s17, s17, 2
    s_lshl_b32 s18, s21, 3
    s_add_u32 s17, s17, s18
    s_lshl_b32 s16, s16, 7
    s_add_u32 s16, s16, s17
    s_lshl_b32 s16, s16, 10
    v_lshlrev_b32 v23, 4, v1
    v_add_u32 v23, s16, v23
    s_mov_b32 s17, 4194304
    s_mov_b32 s18, 8388608
    s_mov_b32 s19, 0x3e8293ee
    v_pk_fma_f32 v[64:65], v[176:177], v[128:129], v[64:65] op_sel:[0,0,0] op_sel_hi:[1,0,1] neg_lo:[0,1,0] neg_hi:[0,1,0]
    v_pk_fma_f32 v[66:67], v[178:179], v[128:129], v[66:67] op_sel:[0,0,0] op_sel_hi:[1,0,1] neg_lo:[0,1,0] neg_hi:[0,1,0]
    v_pk_mul_f32 v[64:65], v[64:65], v[128:129] op_sel:[0,1] op_sel_hi:[1,1]
    v_pk_mul_f32 v[66:67], v[66:67], v[128:129] op_sel:[0,1] op_sel_hi:[1,1]
    v_cvt_pk_bf16_f32 v220, v64, v65
    v_cvt_pk_bf16_f32 v221, v66, v67
    v_pk_fma_f32 v[80:81], v[180:181], v[128:129], v[80:81] op_sel:[0,0,0] op_sel_hi:[1,0,1] neg_lo:[0,1,0] neg_hi:[0,1,0]
    v_pk_fma_f32 v[82:83], v[182:183], v[128:129], v[82:83] op_sel:[0,0,0] op_sel_hi:[1,0,1] neg_lo:[0,1,0] neg_hi:[0,1,0]
    v_pk_mul_f32 v[80:81], v[80:81], v[128:129] op_sel:[0,1] op_sel_hi:[1,1]
    v_pk_mul_f32 v[82:83], v[82:83], v[128:129] op_sel:[0,1] op_sel_hi:[1,1]
    v_cvt_pk_bf16_f32 v222, v80, v81
    v_cvt_pk_bf16_f32 v223, v82, v83
    buffer_store_dwordx4 v[220:223], v23, s[4:7], s17 offen offset:0 sc1
    v_pk_fma_f32 v[68:69], v[176:177], v[130:131], v[68:69] op_sel:[0,0,0] op_sel_hi:[1,0,1] neg_lo:[0,1,0] neg_hi:[0,1,0]
    v_pk_fma_f32 v[70:71], v[178:179], v[130:131], v[70:71] op_sel:[0,0,0] op_sel_hi:[1,0,1] neg_lo:[0,1,0] neg_hi:[0,1,0]
    v_pk_mul_f32 v[68:69], v[68:69], v[130:131] op_sel:[0,1] op_sel_hi:[1,1]
    v_pk_mul_f32 v[70:71], v[70:71], v[130:131] op_sel:[0,1] op_sel_hi:[1,1]
    v_cvt_pk_bf16_f32 v224, v68, v69
    v_cvt_pk_bf16_f32 v225, v70, v71
    v_pk_fma_f32 v[84:85], v[180:181], v[130:131], v[84:85] op_sel:[0,0,0] op_sel_hi:[1,0,1] neg_lo:[0,1,0] neg_hi:[0,1,0]
    v_pk_fma_f32 v[86:87], v[182:183], v[130:131], v[86:87] op_sel:[0,0,0] op_sel_hi:[1,0,1] neg_lo:[0,1,0] neg_hi:[0,1,0]
    v_pk_mul_f32 v[84:85], v[84:85], v[130:131] op_sel:[0,1] op_sel_hi:[1,1]
    v_pk_mul_f32 v[86:87], v[86:87], v[130:131] op_sel:[0,1] op_sel_hi:[1,1]
    v_cvt_pk_bf16_f32 v226, v84, v85
    v_cvt_pk_bf16_f32 v227, v86, v87
    buffer_store_dwordx4 v[224:227], v23, s[4:7], s17 offen offset:1024 sc1
    v_pk_fma_f32 v[72:73], v[176:177], v[132:133], v[72:73] op_sel:[0,0,0] op_sel_hi:[1,0,1] neg_lo:[0,1,0] neg_hi:[0,1,0]
    v_pk_fma_f32 v[74:75], v[178:179], v[132:133], v[74:75] op_sel:[0,0,0] op_sel_hi:[1,0,1] neg_lo:[0,1,0] neg_hi:[0,1,0]
    v_pk_mul_f32 v[72:73], v[72:73], v[132:133] op_sel:[0,1] op_sel_hi:[1,1]
    v_pk_mul_f32 v[74:75], v[74:75], v[132:133] op_sel:[0,1] op_sel_hi:[1,1]
    v_cvt_pk_bf16_f32 v228, v72, v73
    v_cvt_pk_bf16_f32 v229, v74, v75
    v_pk_fma_f32 v[88:89], v[180:181], v[132:133], v[88:89] op_sel:[0,0,0] op_sel_hi:[1,0,1] neg_lo:[0,1,0] neg_hi:[0,1,0]
    v_pk_fma_f32 v[90:91], v[182:183], v[132:133], v[90:91] op_sel:[0,0,0] op_sel_hi:[1,0,1] neg_lo:[0,1,0] neg_hi:[0,1,0]
    v_pk_mul_f32 v[88:89], v[88:89], v[132:133] op_sel:[0,1] op_sel_hi:[1,1]
    v_pk_mul_f32 v[90:91], v[90:91], v[132:133] op_sel:[0,1] op_sel_hi:[1,1]
    v_cvt_pk_bf16_f32 v230, v88, v89
    v_cvt_pk_bf16_f32 v231, v90, v91
    buffer_store_dwordx4 v[228:231], v23, s[4:7], s17 offen offset:2048 sc1
    v_pk_fma_f32 v[76:77], v[176:177], v[134:135], v[76:77] op_sel:[0,0,0] op_sel_hi:[1,0,1] neg_lo:[0,1,0] neg_hi:[0,1,0]
    v_pk_fma_f32 v[78:79], v[178:179], v[134:135], v[78:79] op_sel:[0,0,0] op_sel_hi:[1,0,1] neg_lo:[0,1,0] neg_hi:[0,1,0]
    v_pk_mul_f32 v[76:77], v[76:77], v[134:135] op_sel:[0,1] op_sel_hi:[1,1]
    v_pk_mul_f32 v[78:79], v[78:79], v[134:135] op_sel:[0,1] op_sel_hi:[1,1]
    v_cvt_pk_bf16_f32 v232, v76, v77
    v_cvt_pk_bf16_f32 v233, v78, v79
    v_pk_fma_f32 v[92:93], v[180:181], v[134:135], v[92:93] op_sel:[0,0,0] op_sel_hi:[1,0,1] neg_lo:[0,1,0] neg_hi:[0,1,0]
    v_pk_fma_f32 v[94:95], v[182:183], v[134:135], v[94:95] op_sel:[0,0,0] op_sel_hi:[1,0,1] neg_lo:[0,1,0] neg_hi:[0,1,0]
    v_pk_mul_f32 v[92:93], v[92:93], v[134:135] op_sel:[0,1] op_sel_hi:[1,1]
    v_pk_mul_f32 v[94:95], v[94:95], v[134:135] op_sel:[0,1] op_sel_hi:[1,1]
    v_cvt_pk_bf16_f32 v234, v92, v93
    v_cvt_pk_bf16_f32 v235, v94, v95
    buffer_store_dwordx4 v[232:235], v23, s[4:7], s17 offen offset:3072 sc1
    v_fma_f32 v96, -v136, v184, v96
    v_mul_f32 v96, v96, v137
    v_fma_f32 v97, -v138, v184, v97
    v_mul_f32 v97, v97, v139
    v_fma_f32 v98, -v140, v184, v98
    v_mul_f32 v98, v98, v141
    v_fma_f32 v99, -v142, v184, v99
    v_mul_f32 v99, v99, v143
    v_cvt_pk_bf16_f32 v236, v96, v97
    v_cvt_pk_bf16_f32 v237, v98, v99
    v_fma_f32 v100, -v144, v184, v100
    v_mul_f32 v100, v100, v145
    v_fma_f32 v101, -v146, v184, v101
    v_mul_f32 v101, v101, v147
    v_fma_f32 v102, -v148, v184, v102
    v_mul_f32 v102, v102, v149
    v_fma_f32 v103, -v150, v184, v103
    v_mul_f32 v103, v103, v151
    v_cvt_pk_bf16_f32 v238, v100, v101
    v_cvt_pk_bf16_f32 v239, v102, v103
    buffer_store_dwordx4 v[236:239], v23, s[4:7], s18 offen offset:0 sc1
    v_fma_f32 v112, -v136, v185, v112
    v_mul_f32 v112, v112, v137
    v_fma_f32 v113, -v138, v185, v113
    v_mul_f32 v113, v113, v139
    v_fma_f32 v114, -v140, v185, v114
    v_mul_f32 v114, v114, v141
    v_fma_f32 v115, -v142, v185, v115
    v_mul_f32 v115, v115, v143
    v_cvt_pk_bf16_f32 v240, v112, v113
    v_cvt_pk_bf16_f32 v241, v114, v115
    v_fma_f32 v116, -v144, v185, v116
    v_mul_f32 v116, v116, v145
    v_fma_f32 v117, -v146, v185, v117
    v_mul_f32 v117, v117, v147
    v_fma_f32 v118, -v148, v185, v118
    v_mul_f32 v118, v118, v149
    v_fma_f32 v119, -v150, v185, v119
    v_mul_f32 v119, v119, v151
    v_cvt_pk_bf16_f32 v242, v116, v117
    v_cvt_pk_bf16_f32 v243, v118, v119
    buffer_store_dwordx4 v[240:243], v23, s[4:7], s18 offen offset:1024 sc1
    v_fma_f32 v104, -v152, v184, v104
    v_mul_f32 v104, v104, v153
    v_fma_f32 v105, -v154, v184, v105
    v_mul_f32 v105, v105, v155
    v_fma_f32 v106, -v156, v184, v106
    v_mul_f32 v106, v106, v157
    v_fma_f32 v107, -v158, v184, v107
    v_mul_f32 v107, v107, v159
    v_cvt_pk_bf16_f32 v244, v104, v105
    v_cvt_pk_bf16_f32 v245, v106, v107
    v_fma_f32 v108, -v160, v184, v108
    v_mul_f32 v108, v108, v161
    v_fma_f32 v109, -v162, v184, v109
    v_mul_f32 v109, v109, v163
    v_fma_f32 v110, -v164, v184, v110
    v_mul_f32 v110, v110, v165
    v_fma_f32 v111, -v166, v184, v111
    v_mul_f32 v111, v111, v167
    v_cvt_pk_bf16_f32 v246, v108, v109
    v_cvt_pk_bf16_f32 v247, v110, v111
    buffer_store_dwordx4 v[244:247], v23, s[4:7], s18 offen offset:2048 sc1
    v_fma_f32 v120, -v152, v185, v120
    v_mul_f32 v120, v120, v153
    v_fma_f32 v121, -v154, v185, v121
    v_mul_f32 v121, v121, v155
    v_fma_f32 v122, -v156, v185, v122
    v_mul_f32 v122, v122, v157
    v_fma_f32 v123, -v158, v185, v123
    v_mul_f32 v123, v123, v159
    v_cvt_pk_bf16_f32 v248, v120, v121
    v_cvt_pk_bf16_f32 v249, v122, v123
    v_fma_f32 v124, -v160, v185, v124
    v_mul_f32 v124, v124, v161
    v_fma_f32 v125, -v162, v185, v125
    v_mul_f32 v125, v125, v163
    v_fma_f32 v126, -v164, v185, v126
    v_mul_f32 v126, v126, v165
    v_fma_f32 v127, -v166, v185, v127
    v_mul_f32 v127, v127, v167
    v_cvt_pk_bf16_f32 v250, v124, v125
    v_cvt_pk_bf16_f32 v251, v126, v127
    buffer_store_dwordx4 v[248:251], v23, s[4:7], s18 offen offset:3072 sc1
    v_mul_f32 v25, s19, v129
    v_pk_fma_f32 v[32:33], v[168:169], v[128:129], v[32:33] op_sel:[0,0,0] op_sel_hi:[1,0,1] neg_lo:[0,1,0] neg_hi:[0,1,0]
    v_pk_fma_f32 v[34:35], v[170:171], v[128:129], v[34:35] op_sel:[0,0,0] op_sel_hi:[1,0,1] neg_lo:[0,1,0] neg_hi:[0,1,0]
    v_pk_mul_f32 v[32:33], v[32:33], v[24:25] op_sel:[0,1] op_sel_hi:[1,1]
    v_pk_mul_f32 v[34:35], v[34:35], v[24:25] op_sel:[0,1] op_sel_hi:[1,1]
    v_cvt_pk_bf16_f32 v204, v32, v33
    v_cvt_pk_bf16_f32 v205, v34, v35
    v_pk_fma_f32 v[48:49], v[172:173], v[128:129], v[48:49] op_sel:[0,0,0] op_sel_hi:[1,0,1] neg_lo:[0,1,0] neg_hi:[0,1,0]
    v_pk_fma_f32 v[50:51], v[174:175], v[128:129], v[50:51] op_sel:[0,0,0] op_sel_hi:[1,0,1] neg_lo:[0,1,0] neg_hi:[0,1,0]
    v_pk_mul_f32 v[48:49], v[48:49], v[24:25] op_sel:[0,1] op_sel_hi:[1,1]
    v_pk_mul_f32 v[50:51], v[50:51], v[24:25] op_sel:[0,1] op_sel_hi:[1,1]
    v_cvt_pk_bf16_f32 v206, v48, v49
    v_cvt_pk_bf16_f32 v207, v50, v51
    v_mul_f32 v25, s19, v131
    v_pk_fma_f32 v[36:37], v[168:169], v[130:131], v[36:37] op_sel:[0,0,0] op_sel_hi:[1,0,1] neg_lo:[0,1,0] neg_hi:[0,1,0]
    v_pk_fma_f32 v[38:39], v[170:171], v[130:131], v[38:39] op_sel:[0,0,0] op_sel_hi:[1,0,1] neg_lo:[0,1,0] neg_hi:[0,1,0]
    v_pk_mul_f32 v[36:37], v[36:37], v[24:25] op_sel:[0,1] op_sel_hi:[1,1]
    v_pk_mul_f32 v[38:39], v[38:39], v[24:25] op_sel:[0,1] op_sel_hi:[1,1]
    v_cvt_pk_bf16_f32 v208, v36, v37
    v_cvt_pk_bf16_f32 v209, v38, v39
    v_pk_fma_f32 v[52:53], v[172:173], v[130:131], v[52:53] op_sel:[0,0,0] op_sel_hi:[1,0,1] neg_lo:[0,1,0] neg_hi:[0,1,0]
    v_pk_fma_f32 v[54:55], v[174:175], v[130:131], v[54:55] op_sel:[0,0,0] op_sel_hi:[1,0,1] neg_lo:[0,1,0] neg_hi:[0,1,0]
    v_pk_mul_f32 v[52:53], v[52:53], v[24:25] op_sel:[0,1] op_sel_hi:[1,1]
    v_pk_mul_f32 v[54:55], v[54:55], v[24:25] op_sel:[0,1] op_sel_hi:[1,1]
    v_cvt_pk_bf16_f32 v210, v52, v53
    v_cvt_pk_bf16_f32 v211, v54, v55
    v_mul_f32 v25, s19, v133
    v_pk_fma_f32 v[40:41], v[168:169], v[132:133], v[40:41] op_sel:[0,0,0] op_sel_hi:[1,0,1] neg_lo:[0,1,0] neg_hi:[0,1,0]
    v_pk_fma_f32 v[42:43], v[170:171], v[132:133], v[42:43] op_sel:[0,0,0] op_sel_hi:[1,0,1] neg_lo:[0,1,0] neg_hi:[0,1,0]
    v_pk_mul_f32 v[40:41], v[40:41], v[24:25] op_sel:[0,1] op_sel_hi:[1,1]
    v_pk_mul_f32 v[42:43], v[42:43], v[24:25] op_sel:[0,1] op_sel_hi:[1,1]
    v_cvt_pk_bf16_f32 v212, v40, v41
    v_cvt_pk_bf16_f32 v213, v42, v43
    v_pk_fma_f32 v[56:57], v[172:173], v[132:133], v[56:57] op_sel:[0,0,0] op_sel_hi:[1,0,1] neg_lo:[0,1,0] neg_hi:[0,1,0]
    v_pk_fma_f32 v[58:59], v[174:175], v[132:133], v[58:59] op_sel:[0,0,0] op_sel_hi:[1,0,1] neg_lo:[0,1,0] neg_hi:[0,1,0]
    v_pk_mul_f32 v[56:57], v[56:57], v[24:25] op_sel:[0,1] op_sel_hi:[1,1]
    v_pk_mul_f32 v[58:59], v[58:59], v[24:25] op_sel:[0,1] op_sel_hi:[1,1]
    v_cvt_pk_bf16_f32 v214, v56, v57
    v_cvt_pk_bf16_f32 v215, v58, v59
    v_mul_f32 v25, s19, v135
    v_pk_fma_f32 v[44:45], v[168:169], v[134:135], v[44:45] op_sel:[0,0,0] op_sel_hi:[1,0,1] neg_lo:[0,1,0] neg_hi:[0,1,0]
    v_pk_fma_f32 v[46:47], v[170:171], v[134:135], v[46:47] op_sel:[0,0,0] op_sel_hi:[1,0,1] neg_lo:[0,1,0] neg_hi:[0,1,0]
    v_pk_mul_f32 v[44:45], v[44:45], v[24:25] op_sel:[0,1] op_sel_hi:[1,1]
    v_pk_mul_f32 v[46:47], v[46:47], v[24:25] op_sel:[0,1] op_sel_hi:[1,1]
    v_cvt_pk_bf16_f32 v216, v44, v45
    v_cvt_pk_bf16_f32 v217, v46, v47
    v_pk_fma_f32 v[60:61], v[172:173], v[134:135], v[60:61] op_sel:[0,0,0] op_sel_hi:[1,0,1] neg_lo:[0,1,0] neg_hi:[0,1,0]
    v_pk_fma_f32 v[62:63], v[174:175], v[134:135], v[62:63] op_sel:[0,0,0] op_sel_hi:[1,0,1] neg_lo:[0,1,0] neg_hi:[0,1,0]
    v_pk_mul_f32 v[60:61], v[60:61], v[24:25] op_sel:[0,1] op_sel_hi:[1,1]
    v_pk_mul_f32 v[62:63], v[62:63], v[24:25] op_sel:[0,1] op_sel_hi:[1,1]
    v_cvt_pk_bf16_f32 v218, v60, v61
    v_cvt_pk_bf16_f32 v219, v62, v63
    s_and_b32 s16, s20, 1
    s_lshl_b32 s17, s22, 1
    s_add_u32 s34, s16, s17
    s_lshr_b32 s17, s20, 1
    s_lshl_b32 s17, s17, 2
    s_lshl_b32 s18, s21, 3
    s_add_u32 s23, s17, s18
    s_lshl_b32 s35, s23, 5
    s_add_u32 s35, s35, s34
    s_lshl_b32 s35, s35, 10
    s_add_u32 s35, s35, 12582912
    v_lshlrev_b32 v16, 4, v1
    s_cmp_ge_i32 s23, 16
    s_cselect_b32 s17, 0, 0xf149f2ca
    v_mov_b32 v80, s17
    v_mov_b32 v81, s17
    v_mov_b32 v82, s17
    v_mov_b32 v83, s17
    s_cmp_ge_i32 s23, 12
    s_cselect_b32 s17, 0, 0xf149f2ca
    v_mov_b32 v84, s17
    v_mov_b32 v85, s17
    v_mov_b32 v86, s17
    v_mov_b32 v87, s17
    s_cmp_ge_i32 s23, 8
    s_cselect_b32 s17, 0, 0xf149f2ca
    v_mov_b32 v88, s17
    v_mov_b32 v89, s17
    v_mov_b32 v90, s17
    v_mov_b32 v91, s17
    s_cmp_ge_i32 s23, 4
    s_cselect_b32 s17, 0, 0xf149f2ca
    v_mov_b32 v92, s17
    v_mov_b32 v93, s17
    v_mov_b32 v94, s17
    v_mov_b32 v95, s17
    v_and_b32 v17, 15, v1
    v_lshrrev_b32 v18, 4, v1
    v_lshlrev_b32 v18, 2, v18
    v_mov_b32 v19, 0xf149f2ca
    v_add_u32 v20, 0, v18
    v_cmp_gt_u32 vcc, v20, v17
    s_nop 1
    v_cndmask_b32 v96, v19, v80, vcc
    v_cndmask_b32 v100, 0, v19, vcc
    v_add_u32 v20, 1, v18
    v_cmp_gt_u32 vcc, v20, v17
    s_nop 1
    v_cndmask_b32 v97, v19, v81, vcc
    v_cndmask_b32 v101, 0, v19, vcc
    v_add_u32 v20, 2, v18
    v_cmp_gt_u32 vcc, v20, v17
    s_nop 1
    v_cndmask_b32 v98, v19, v82, vcc
    v_cndmask_b32 v102, 0, v19, vcc
    v_add_u32 v20, 3, v18
    v_cmp_gt_u32 vcc, v20, v17
    s_nop 1
    v_cndmask_b32 v99, v19, v83, vcc
    v_cndmask_b32 v103, 0, v19, vcc
    v_mov_b32 v132, 0x3f803f80
    v_mov_b32 v133, 0x3f803f80
    v_mov_b32 v134, 0x3f803f80
    v_mov_b32 v135, 0x3f803f80
    v_lshrrev_b32 v23, 2, v1
    v_lshlrev_b32 v24, 7, v23
    v_and_b32 v25, 3, v1
    v_lshlrev_b32 v25, 3, v25
    v_add_u32 v24, v24, v25
    v_bfe_u32 v23, v1, 3, 2
    v_xor_b32 v25, 0, v23
    v_lshlrev_b32 v25, 5, v25
    v_add_u32 v2, v24, v25
    v_xor_b32 v25, 1, v23
    v_lshlrev_b32 v25, 5, v25
    v_add_u32 v3, v24, v25
    v_xor_b32 v25, 2, v23
    v_lshlrev_b32 v25, 5, v25
    v_add_u32 v4, v24, v25
    v_xor_b32 v25, 3, v23
    v_lshlrev_b32 v25, 5, v25
    v_add_u32 v5, v24, v25
    s_lshl_b32 s16, s72, 2
    s_add_u32 s16, s16, s20
    s_mul_i32 s16, s16, 65536
    s_add_u32 s16, s16, 12582912
    v_lshlrev_b32 v23, 4, v1
    v_add_u32 v14, s16, v23
    v_add_u32 v15, 32768, v14
    s_waitcnt vmcnt(0)
    s_barrier
    s_lshl_b32 s16, s21, 4
    s_add_u32 s16, s16, s22
    s_lshl_b32 s16, s16, 8
    s_add_u32 s16, s16, 41943040
    s_cmp_eq_u32 s20, 1
    s_cbranch_scc0 Lkv_3
    v_add_u32 v24, 1, v1
    v_lshlrev_b32 v24, 12, v24
    s_sub_u32 s17, 15, s21
    s_min_u32 s17, s17, 2
    v_mov_b32 v25, 0x10000000
    v_cmp_gt_u32 vcc, s17, v1
    s_nop 1
    v_cndmask_b32 v24, v25, v24, vcc
    v_mov_b32 v25, 1
    buffer_atomic_add v25, v24, s[4:7], s16 offen sc1
Lkv_3:
    s_cmp_eq_u32 s20, 0
    s_cbranch_scc0 Lkv_4
    s_min_u32 s18, s21, 2
    s_mov_b32 s19, 0
Lkvp_5:
    s_add_u32 s19, s19, 1
    s_cmp_gt_u32 s19, 300000
    s_cbranch_scc1 Lkv_4
    buffer_load_dword v24, v30, s[4:7], s16 offen sc1
    s_waitcnt vmcnt(0)
    v_readfirstlane_b32 s17, v24
    s_cmp_ge_u32 s17, s18
    s_cbranch_scc0 Lkvp_5
Lkv_4:
    s_barrier
    s_lshl_b32 s30, s34, 7
    s_add_u32 s30, s30, s23
    s_lshl_b32 s30, s30, 10
    s_add_u32 s31, s30, 4194304
    s_add_i32 s31, s31, -16384
    s_cmp_ge_i32 s23, 16
    s_cselect_b32 s31, s31, 0x10000000
    buffer_load_dwordx4 a[0:3], v16, s[4:7], s31 offen offset:0 sc1
    buffer_load_dwordx4 a[4:7], v16, s[4:7], s31 offen offset:1024 sc1
    buffer_load_dwordx4 a[8:11], v16, s[4:7], s31 offen offset:2048 sc1
    buffer_load_dwordx4 a[12:15], v16, s[4:7], s31 offen offset:3072 sc1
    s_add_u32 s31, s30, 4194304
    s_add_i32 s31, s31, -12288
    s_cmp_ge_i32 s23, 12
    s_cselect_b32 s31, s31, 0x10000000
    buffer_load_dwordx4 a[16:19], v16, s[4:7], s31 offen offset:0 sc1
    buffer_load_dwordx4 a[20:23], v16, s[4:7], s31 offen offset:1024 sc1
    buffer_load_dwordx4 a[24:27], v16, s[4:7], s31 offen offset:2048 sc1
    buffer_load_dwordx4 a[28:31], v16, s[4:7], s31 offen offset:3072 sc1
    v_mov_b32 v164, 0xf149f2ca
    v_mov_b32 v165, 0xf149f2ca
    v_mov_b32 v166, 0xf149f2ca
    v_mov_b32 v167, 0xf149f2ca
    v_mfma_f32_16x16x32_bf16 v[140:143], v[220:223], v[204:207], v[100:103]
    s_add_u32 s31, s30, 4194304
    s_add_i32 s31, s31, -8192
    s_cmp_ge_i32 s23, 8
    s_cselect_b32 s31, s31, 0x10000000
    buffer_load_dwordx4 a[32:35], v16, s[4:7], s31 offen offset:0 sc1
    s_nop 1
    v_mfma_f32_16x16x32_bf16 v[144:147], v[220:223], v[208:211], 0
    buffer_load_dwordx4 a[36:39], v16, s[4:7], s31 offen offset:1024 sc1
    s_nop 1
    v_mfma_f32_16x16x32_bf16 v[148:151], v[220:223], v[212:215], 0
    s_nop 1
    v_mfma_f32_16x16x32_bf16 v[152:155], v[220:223], v[216:219], 0
    buffer_load_dwordx4 a[40:43], v16, s[4:7], s31 offen offset:2048 sc1
    s_nop 1
    v_mfma_f32_16x16x32_bf16 v[156:159], v[224:227], v[208:211], v[100:103]
    buffer_load_dwordx4 a[44:47], v16, s[4:7], s31 offen offset:3072 sc1
    v_max3_f32 v164, v164, v140, v141
    v_max3_f32 v164, v164, v142, v143
    v_mfma_f32_16x16x32_bf16 v[160:163], v[224:227], v[212:215], 0
    v_max3_f32 v165, v165, v144, v145
    v_max3_f32 v165, v165, v146, v147
    v_mfma_f32_16x16x32_bf16 v[140:143], v[224:227], v[216:219], 0
    s_add_u32 s31, s30, 4194304
    s_add_i32 s31, s31, -4096
    s_cmp_ge_i32 s23, 4
    s_cselect_b32 s31, s31, 0x10000000
    buffer_load_dwordx4 a[48:51], v16, s[4:7], s31 offen offset:0 sc1
    v_max3_f32 v166, v166, v148, v149
    v_max3_f32 v166, v166, v150, v151
    v_mfma_f32_16x16x32_bf16 v[144:147], v[228:231], v[212:215], v[100:103]
    buffer_load_dwordx4 a[52:55], v16, s[4:7], s31 offen offset:1024 sc1
    v_max3_f32 v167, v167, v152, v153
    v_max3_f32 v167, v167, v154, v155
    v_mfma_f32_16x16x32_bf16 v[148:151], v[228:231], v[216:219], 0
    v_max3_f32 v165, v165, v156, v157
    v_max3_f32 v165, v165, v158, v159
    v_mfma_f32_16x16x32_bf16 v[152:155], v[232:235], v[216:219], v[100:103]
    buffer_load_dwordx4 a[56:59], v16, s[4:7], s31 offen offset:2048 sc1
    v_max3_f32 v166, v166, v160, v161
    v_max3_f32 v166, v166, v162, v163
    s_waitcnt vmcnt(11)
    v_mfma_f32_16x16x32_bf16 v[156:159], a[0:3], v[204:207], v[96:99]
    buffer_load_dwordx4 a[60:63], v16, s[4:7], s31 offen offset:3072 sc1
    v_max3_f32 v167, v167, v140, v141
    v_max3_f32 v167, v167, v142, v143
    v_mfma_f32_16x16x32_bf16 v[160:163], a[4:7], v[204:207], v[80:83]
    v_max3_f32 v166, v166, v144, v145
    v_max3_f32 v166, v166, v146, v147
    v_mfma_f32_16x16x32_bf16 v[140:143], a[4:7], v[208:211], v[96:99]
    s_add_u32 s31, s30, 8388608
    s_add_i32 s31, s31, -16384
    s_cmp_ge_i32 s23, 16
    s_cselect_b32 s31, s31, 0x10000000
    buffer_load_dwordx4 a[80:83], v16, s[4:7], s31 offen offset:0 sc1
    v_max3_f32 v167, v167, v148, v149
    v_max3_f32 v167, v167, v150, v151
    v_mfma_f32_16x16x32_bf16 v[144:147], a[8:11], v[204:207], v[80:83]
    buffer_load_dwordx4 a[84:87], v16, s[4:7], s31 offen offset:1024 sc1
    v_max3_f32 v167, v167, v152, v153
    v_max3_f32 v167, v167, v154, v155
    v_mfma_f32_16x16x32_bf16 v[148:151], a[8:11], v[208:211], v[80:83]
    v_max3_f32 v164, v164, v156, v157
    v_max3_f32 v164, v164, v158, v159
    v_mfma_f32_16x16x32_bf16 v[152:155], a[8:11], v[212:215], v[96:99]
    buffer_load_dwordx4 a[88:91], v16, s[4:7], s31 offen offset:2048 sc1
    v_max3_f32 v164, v164, v160, v161
    v_max3_f32 v164, v164, v162, v163
    v_mfma_f32_16x16x32_bf16 v[156:159], a[12:15], v[204:207], v[80:83]
    buffer_load_dwordx4 a[92:95], v16, s[4:7], s31 offen offset:3072 sc1
    v_max3_f32 v165, v165, v140, v141
    v_max3_f32 v165, v165, v142, v143
    v_mfma_f32_16x16x32_bf16 v[160:163], a[12:15], v[208:211], v[80:83]
    v_max3_f32 v164, v164, v144, v145
    v_max3_f32 v164, v164, v146, v147
    v_mfma_f32_16x16x32_bf16 v[140:143], a[12:15], v[212:215], v[80:83]
    s_add_u32 s31, s30, 8388608
    s_add_i32 s31, s31, -12288
    s_cmp_ge_i32 s23, 12
    s_cselect_b32 s31, s31, 0x10000000
    buffer_load_dwordx4 a[96:99], v16, s[4:7], s31 offen offset:0 sc1
    v_max3_f32 v165, v165, v148, v149
    v_max3_f32 v165, v165, v150, v151
    v_mfma_f32_16x16x32_bf16 v[144:147], a[12:15], v[216:219], v[96:99]
    buffer_load_dwordx4 a[100:103], v16, s[4:7], s31 offen offset:1024 sc1
    v_max3_f32 v166, v166, v152, v153
    v_max3_f32 v166, v166, v154, v155
    s_waitcnt vmcnt(14)
    v_mfma_f32_16x16x32_bf16 v[148:151], a[16:19], v[204:207], v[84:87]
    v_max3_f32 v164, v164, v156, v157
    v_max3_f32 v164, v164, v158, v159
    v_mfma_f32_16x16x32_bf16 v[152:155], a[16:19], v[208:211], v[84:87]
    buffer_load_dwordx4 a[104:107], v16, s[4:7], s31 offen offset:2048 sc1
    v_max3_f32 v165, v165, v160, v161
    v_max3_f32 v165, v165, v162, v163
    v_mfma_f32_16x16x32_bf16 v[156:159], a[16:19], v[212:215], v[84:87]
    buffer_load_dwordx4 a[108:111], v16, s[4:7], s31 offen offset:3072 sc1
    v_max3_f32 v166, v166, v140, v141
    v_max3_f32 v166, v166, v142, v143
    v_mfma_f32_16x16x32_bf16 v[160:163], a[16:19], v[216:219], v[84:87]
    v_max3_f32 v167, v167, v144, v145
    v_max3_f32 v167, v167, v146, v147
    v_mfma_f32_16x16x32_bf16 v[140:143], a[20:23], v[204:207], v[84:87]
    s_add_u32 s31, s30, 8388608
    s_add_i32 s31, s31, -8192
    s_cmp_ge_i32 s23, 8
    s_cselect_b32 s31, s31, 0x10000000
    buffer_load_dwordx4 a[112:115], v16, s[4:7], s31 offen offset:0 sc1
    v_max3_f32 v164, v164, v148, v149
    v_max3_f32 v164, v164, v150, v151
    v_mfma_f32_16x16x32_bf16 v[144:147], a[20:23], v[208:211], v[84:87]
    buffer_load_dwordx4 a[116:119], v16, s[4:7], s31 offen offset:1024 sc1
    v_max3_f32 v165, v165, v152, v153
    v_max3_f32 v165, v165, v154, v155
    v_mfma_f32_16x16x32_bf16 v[148:151], a[20:23], v[212:215], v[84:87]
    v_max3_f32 v166, v166, v156, v157
    v_max3_f32 v166, v166, v158, v159
    v_mfma_f32_16x16x32_bf16 v[152:155], a[20:23], v[216:219], v[84:87]
    buffer_load_dwordx4 a[120:123], v16, s[4:7], s31 offen offset:2048 sc1
    v_max3_f32 v167, v167, v160, v161
    v_max3_f32 v167, v167, v162, v163
    v_mfma_f32_16x16x32_bf16 v[156:159], a[24:27], v[204:207], v[84:87]
    buffer_load_dwordx4 a[124:127], v16, s[4:7], s31 offen offset:3072 sc1
    v_max3_f32 v164, v164, v140, v141
    v_max3_f32 v164, v164, v142, v143
    v_mfma_f32_16x16x32_bf16 v[160:163], a[24:27], v[208:211], v[84:87]
    v_max3_f32 v165, v165, v144, v145
    v_max3_f32 v165, v165, v146, v147
    v_mfma_f32_16x16x32_bf16 v[140:143], a[24:27], v[212:215], v[84:87]
    s_add_u32 s31, s30, 8388608
    s_add_i32 s31, s31, -4096
    s_cmp_ge_i32 s23, 4
    s_cselect_b32 s31, s31, 0x10000000
    buffer_load_dwordx4 a[128:131], v16, s[4:7], s31 offen offset:0 sc1
    v_max3_f32 v166, v166, v148, v149
    v_max3_f32 v166, v166, v150, v151
    v_mfma_f32_16x16x32_bf16 v[144:147], a[24:27], v[216:219], v[84:87]
    buffer_load_dwordx4 a[132:135], v16, s[4:7], s31 offen offset:1024 sc1
    v_max3_f32 v167, v167, v152, v153
    v_max3_f32 v167, v167, v154, v155
    v_mfma_f32_16x16x32_bf16 v[148:151], a[28:31], v[204:207], v[84:87]
    v_max3_f32 v164, v164, v156, v157
    v_max3_f32 v164, v164, v158, v159
    v_mfma_f32_16x16x32_bf16 v[152:155], a[28:31], v[208:211], v[84:87]
    buffer_load_dwordx4 a[136:139], v16, s[4:7], s31 offen offset:2048 sc1
    v_max3_f32 v165, v165, v160, v161
    v_max3_f32 v165, v165, v162, v163
    v_mfma_f32_16x16x32_bf16 v[156:159], a[28:31], v[212:215], v[84:87]
    buffer_load_dwordx4 a[140:143], v16, s[4:7], s31 offen offset:3072 sc1
    v_max3_f32 v166, v166, v140, v141
    v_max3_f32 v166, v166, v142, v143
    v_mfma_f32_16x16x32_bf16 v[160:163], a[28:31], v[216:219], v[84:87]
    v_max3_f32 v167, v167, v144, v145
    v_max3_f32 v167, v167, v146, v147
    s_waitcnt vmcnt(20)
    v_mfma_f32_16x16x32_bf16 v[140:143], a[32:35], v[204:207], v[88:91]
    v_max3_f32 v164, v164, v148, v149
    v_max3_f32 v164, v164, v150, v151
    v_mfma_f32_16x16x32_bf16 v[144:147], a[32:35], v[208:211], v[88:91]
    v_max3_f32 v165, v165, v152, v153
    v_max3_f32 v165, v165, v154, v155
    v_mfma_f32_16x16x32_bf16 v[148:151], a[32:35], v[212:215], v[88:91]
    v_max3_f32 v166, v166, v156, v157
    v_max3_f32 v166, v166, v158, v159
    v_mfma_f32_16x16x32_bf16 v[152:155], a[32:35], v[216:219], v[88:91]
    v_max3_f32 v167, v167, v160, v161
    v_max3_f32 v167, v167, v162, v163
    v_mfma_f32_16x16x32_bf16 v[156:159], a[36:39], v[204:207], v[88:91]
    v_max3_f32 v164, v164, v140, v141
    v_max3_f32 v164, v164, v142, v143
    v_mfma_f32_16x16x32_bf16 v[160:163], a[36:39], v[208:211], v[88:91]
    v_max3_f32 v165, v165, v144, v145
    v_max3_f32 v165, v165, v146, v147
    v_mfma_f32_16x16x32_bf16 v[140:143], a[36:39], v[212:215], v[88:91]
    v_max3_f32 v166, v166, v148, v149
    v_max3_f32 v166, v166, v150, v151
    v_mfma_f32_16x16x32_bf16 v[144:147], a[36:39], v[216:219], v[88:91]
    v_max3_f32 v167, v167, v152, v153
    v_max3_f32 v167, v167, v154, v155
    v_mfma_f32_16x16x32_bf16 v[148:151], a[40:43], v[204:207], v[88:91]
    v_max3_f32 v164, v164, v156, v157
    v_max3_f32 v164, v164, v158, v159
    v_mfma_f32_16x16x32_bf16 v[152:155], a[40:43], v[208:211], v[88:91]
    v_max3_f32 v165, v165, v160, v161
    v_max3_f32 v165, v165, v162, v163
    v_mfma_f32_16x16x32_bf16 v[156:159], a[40:43], v[212:215], v[88:91]
    v_max3_f32 v166, v166, v140, v141
    v_max3_f32 v166, v166, v142, v143
    v_mfma_f32_16x16x32_bf16 v[160:163], a[40:43], v[216:219], v[88:91]
    v_max3_f32 v167, v167, v144, v145
    v_max3_f32 v167, v167, v146, v147
    v_mfma_f32_16x16x32_bf16 v[140:143], a[44:47], v[204:207], v[88:91]
    v_max3_f32 v164, v164, v148, v149
    v_max3_f32 v164, v164, v150, v151
    v_mfma_f32_16x16x32_bf16 v[144:147], a[44:47], v[208:211], v[88:91]
    v_max3_f32 v165, v165, v152, v153
    v_max3_f32 v165, v165, v154, v155
    v_mfma_f32_16x16x32_bf16 v[148:151], a[44:47], v[212:215], v[88:91]
    v_max3_f32 v166, v166, v156, v157
    v_max3_f32 v166, v166, v158, v159
    v_mfma_f32_16x16x32_bf16 v[152:155], a[44:47], v[216:219], v[88:91]
    v_max3_f32 v167, v167, v160, v161
    v_max3_f32 v167, v167, v162, v163
    s_waitcnt vmcnt(16)
    v_mfma_f32_16x16x32_bf16 v[156:159], a[48:51], v[204:207], v[92:95]
    v_max3_f32 v164, v164, v140, v141
    v_max3_f32 v164, v164, v142, v143
    v_mfma_f32_16x16x32_bf16 v[160:163], a[48:51], v[208:211], v[92:95]
    v_max3_f32 v165, v165, v144, v145
    v_max3_f32 v165, v165, v146, v147
    v_mfma_f32_16x16x32_bf16 v[140:143], a[48:51], v[212:215], v[92:95]
    v_max3_f32 v166, v166, v148, v149
    v_max3_f32 v166, v166, v150, v151
    v_mfma_f32_16x16x32_bf16 v[144:147], a[48:51], v[216:219], v[92:95]
    v_max3_f32 v167, v167, v152, v153
    v_max3_f32 v167, v167, v154, v155
    v_mfma_f32_16x16x32_bf16 v[148:151], a[52:55], v[204:207], v[92:95]
    v_max3_f32 v164, v164, v156, v157
    v_max3_f32 v164, v164, v158, v159
    v_mfma_f32_16x16x32_bf16 v[152:155], a[52:55], v[208:211], v[92:95]
    v_max3_f32 v165, v165, v160, v161
    v_max3_f32 v165, v165, v162, v163
    v_mfma_f32_16x16x32_bf16 v[156:159], a[52:55], v[212:215], v[92:95]
    v_max3_f32 v166, v166, v140, v141
    v_max3_f32 v166, v166, v142, v143
    v_mfma_f32_16x16x32_bf16 v[160:163], a[52:55], v[216:219], v[92:95]
    v_max3_f32 v167, v167, v144, v145
    v_max3_f32 v167, v167, v146, v147
    v_mfma_f32_16x16x32_bf16 v[140:143], a[56:59], v[204:207], v[92:95]
    v_max3_f32 v164, v164, v148, v149
    v_max3_f32 v164, v164, v150, v151
    v_mfma_f32_16x16x32_bf16 v[144:147], a[56:59], v[208:211], v[92:95]
    v_max3_f32 v165, v165, v152, v153
    v_max3_f32 v165, v165, v154, v155
    v_mfma_f32_16x16x32_bf16 v[148:151], a[56:59], v[212:215], v[92:95]
    v_max3_f32 v166, v166, v156, v157
    v_max3_f32 v166, v166, v158, v159
    v_mfma_f32_16x16x32_bf16 v[152:155], a[56:59], v[216:219], v[92:95]
    v_max3_f32 v167, v167, v160, v161
    v_max3_f32 v167, v167, v162, v163
    v_mfma_f32_16x16x32_bf16 v[156:159], a[60:63], v[204:207], v[92:95]
    v_max3_f32 v164, v164, v140, v141
    v_max3_f32 v164, v164, v142, v143
    v_mfma_f32_16x16x32_bf16 v[160:163], a[60:63], v[208:211], v[92:95]
    v_max3_f32 v165, v165, v144, v145
    v_max3_f32 v165, v165, v146, v147
    v_mfma_f32_16x16x32_bf16 v[140:143], a[60:63], v[212:215], v[92:95]
    v_max3_f32 v166, v166, v148, v149
    v_max3_f32 v166, v166, v150, v151
    v_mfma_f32_16x16x32_bf16 v[144:147], a[60:63], v[216:219], v[92:95]
    v_max3_f32 v167, v167, v152, v153
    v_max3_f32 v167, v167, v154, v155
    s_nop 1
    v_max3_f32 v164, v164, v156, v157
    v_max3_f32 v164, v164, v158, v159
    v_max3_f32 v165, v165, v160, v161
    v_max3_f32 v165, v165, v162, v163
    v_max3_f32 v166, v166, v140, v141
    v_max3_f32 v166, v166, v142, v143
    s_nop 1
    v_max3_f32 v167, v167, v144, v145
    v_max3_f32 v167, v167, v146, v147
    v_mov_b32 v168, v164
    v_mov_b32 v169, v165
    v_mov_b32 v170, v166
    v_mov_b32 v171, v167
    s_nop 0
    v_permlane16_swap_b32 v164, v168
    v_permlane16_swap_b32 v165, v169
    v_permlane16_swap_b32 v166, v170
    v_permlane16_swap_b32 v167, v171
    s_nop 0
    v_max_f32 v164, v164, v168
    v_max_f32 v165, v165, v169
    v_max_f32 v166, v166, v170
    v_max_f32 v167, v167, v171
    v_mov_b32 v168, v164
    v_mov_b32 v169, v165
    v_mov_b32 v170, v166
    v_mov_b32 v171, v167
    s_nop 0
    v_permlane32_swap_b32 v164, v168
    v_permlane32_swap_b32 v165, v169
    v_permlane32_swap_b32 v166, v170
    v_permlane32_swap_b32 v167, v171
    s_nop 0
    v_max_f32 v164, v164, v168
    v_max_f32 v165, v165, v169
    v_max_f32 v166, v166, v170
    v_max_f32 v167, v167, v171
    v_sub_f32 v124, v96, v164
    v_sub_f32 v125, v97, v164
    v_sub_f32 v126, v98, v164
    v_sub_f32 v127, v99, v164
    v_sub_f32 v104, v80, v164
    v_sub_f32 v105, v81, v164
    v_sub_f32 v106, v82, v164
    v_sub_f32 v107, v83, v164
    v_sub_f32 v108, v84, v164
    v_sub_f32 v109, v85, v164
    v_sub_f32 v110, v86, v164
    v_sub_f32 v111, v87, v164
    v_sub_f32 v112, v88, v164
    v_sub_f32 v113, v89, v164
    v_sub_f32 v114, v90, v164
    v_sub_f32 v115, v91, v164
    v_sub_f32 v116, v92, v164
    v_sub_f32 v117, v93, v164
    v_sub_f32 v118, v94, v164
    v_sub_f32 v119, v95, v164
    v_sub_f32 v120, 0, v164
    v_sub_f32 v121, 0, v164
    v_sub_f32 v122, 0, v164
    v_sub_f32 v123, 0, v164
    v_sub_f32 v128, v100, v164
    v_sub_f32 v129, v101, v164
    v_sub_f32 v130, v102, v164
    v_sub_f32 v131, v103, v164
    v_mfma_f32_16x16x32_bf16 v[32:35], a[0:3], v[204:207], v[124:127]
    v_mfma_f32_16x16x32_bf16 v[36:39], a[4:7], v[204:207], v[104:107]
    s_nop 6
    v_mfma_f32_16x16x32_bf16 v[40:43], a[8:11], v[204:207], v[104:107]
    v_exp_f32 v32, v32
    v_exp_f32 v33, v33
    v_exp_f32 v34, v34
    v_exp_f32 v35, v35
    s_lshl_b32 s26, s20, 13
    s_mov_b32 s25, 0
    v_cvt_pk_bf16_f32 v48, v32, v33
    v_cvt_pk_bf16_f32 v49, v34, v35
    v_mfma_f32_16x16x32_bf16 v[44:47], a[12:15], v[204:207], v[104:107]
    v_exp_f32 v36, v36
    v_exp_f32 v37, v37
    v_exp_f32 v38, v38
    v_exp_f32 v39, v39
    s_add_u32 m0, s26, 0
    s_nop 0
    buffer_load_dwordx4 v196, s[8:11], s25 offen offset:0 lds
    v_cvt_pk_bf16_f32 v50, v36, v37
    v_cvt_pk_bf16_f32 v51, v38, v39
    v_mfma_f32_16x16x32_bf16 v[32:35], a[16:19], v[204:207], v[108:111]
    v_exp_f32 v40, v40
    v_exp_f32 v41, v41
    s_waitcnt vmcnt(13)
    v_mfma_f32_16x16x32_bf16 v[64:67], a[80:83], v[48:51], 0
    v_mfma_f32_16x16x32_bf16 v[68:71], a[84:87], v[48:51], 0
    v_mfma_f32_16x16x32_bf16 v[72:75], v[132:135], v[48:51], 0
    v_exp_f32 v42, v42
    v_exp_f32 v43, v43
    buffer_load_dwordx4 v197, s[8:11], s25 offen offset:1024 lds
    v_cvt_pk_bf16_f32 v52, v40, v41
    v_cvt_pk_bf16_f32 v53, v42, v43
    v_mfma_f32_16x16x32_bf16 v[36:39], a[20:23], v[204:207], v[108:111]
    v_exp_f32 v44, v44
    v_exp_f32 v45, v45
    v_exp_f32 v46, v46
    v_exp_f32 v47, v47
    buffer_load_dwordx4 v198, s[8:11], s25 offen offset:2048 lds
    v_cvt_pk_bf16_f32 v54, v44, v45
    v_cvt_pk_bf16_f32 v55, v46, v47
    v_mfma_f32_16x16x32_bf16 v[40:43], a[24:27], v[204:207], v[108:111]
    v_exp_f32 v32, v32
    v_exp_f32 v33, v33
    v_mfma_f32_16x16x32_bf16 v[64:67], a[88:91], v[52:55], v[64:67]
    v_mfma_f32_16x16x32_bf16 v[68:71], a[92:95], v[52:55], v[68:71]
    v_mfma_f32_16x16x32_bf16 v[72:75], v[132:135], v[52:55], v[72:75]
    v_exp_f32 v34, v34
    v_exp_f32 v35, v35
    buffer_load_dwordx4 v199, s[8:11], s25 offen offset:3072 lds
    v_cvt_pk_bf16_f32 v48, v32, v33
    v_cvt_pk_bf16_f32 v49, v34, v35
    v_mfma_f32_16x16x32_bf16 v[44:47], a[28:31], v[204:207], v[108:111]
    v_exp_f32 v36, v36
    v_exp_f32 v37, v37
    v_exp_f32 v38, v38
    v_exp_f32 v39, v39
    s_add_u32 m0, s26, 4096
    s_nop 0
    buffer_load_dwordx4 v200, s[8:11], s25 offen offset:0 lds
    v_cvt_pk_bf16_f32 v50, v36, v37
    v_cvt_pk_bf16_f32 v51, v38, v39
    v_mfma_f32_16x16x32_bf16 v[32:35], a[32:35], v[204:207], v[112:115]
    v_exp_f32 v40, v40
    v_exp_f32 v41, v41
    s_waitcnt vmcnt(13)
    v_mfma_f32_16x16x32_bf16 v[64:67], a[96:99], v[48:51], v[64:67]
    v_mfma_f32_16x16x32_bf16 v[68:71], a[100:103], v[48:51], v[68:71]
    v_mfma_f32_16x16x32_bf16 v[72:75], v[132:135], v[48:51], v[72:75]
    v_exp_f32 v42, v42
    v_exp_f32 v43, v43
    buffer_load_dwordx4 v201, s[8:11], s25 offen offset:1024 lds
    v_cvt_pk_bf16_f32 v52, v40, v41
    v_cvt_pk_bf16_f32 v53, v42, v43
    v_mfma_f32_16x16x32_bf16 v[36:39], a[36:39], v[204:207], v[112:115]
    v_exp_f32 v44, v44
    v_exp_f32 v45, v45
    v_exp_f32 v46, v46
    v_exp_f32 v47, v47
    buffer_load_dwordx4 v202, s[8:11], s25 offen offset:2048 lds
    v_cvt_pk_bf16_f32 v54, v44, v45
    v_cvt_pk_bf16_f32 v55, v46, v47
    v_mfma_f32_16x16x32_bf16 v[40:43], a[40:43], v[204:207], v[112:115]
    v_exp_f32 v32, v32
    v_exp_f32 v33, v33
    v_mfma_f32_16x16x32_bf16 v[64:67], a[104:107], v[52:55], v[64:67]
    v_mfma_f32_16x16x32_bf16 v[68:71], a[108:111], v[52:55], v[68:71]
    v_mfma_f32_16x16x32_bf16 v[72:75], v[132:135], v[52:55], v[72:75]
    v_exp_f32 v34, v34
    v_exp_f32 v35, v35
    buffer_load_dwordx4 v203, s[8:11], s25 offen offset:3072 lds
    v_cvt_pk_bf16_f32 v48, v32, v33
    v_cvt_pk_bf16_f32 v49, v34, v35
    v_mfma_f32_16x16x32_bf16 v[44:47], a[44:47], v[204:207], v[112:115]
    v_exp_f32 v36, v36
    v_exp_f32 v37, v37
    v_exp_f32 v38, v38
    v_exp_f32 v39, v39
    s_add_u32 s25, s25, 524288
    s_add_u32 s26, s26, 32768
    v_cvt_pk_bf16_f32 v50, v36, v37
    v_cvt_pk_bf16_f32 v51, v38, v39
    v_mfma_f32_16x16x32_bf16 v[32:35], a[48:51], v[204:207], v[116:119]
    v_exp_f32 v40, v40
    v_exp_f32 v41, v41
    s_waitcnt vmcnt(12)
    v_mfma_f32_16x16x32_bf16 v[64:67], a[112:115], v[48:51], v[64:67]
    v_mfma_f32_16x16x32_bf16 v[68:71], a[116:119], v[48:51], v[68:71]
    v_mfma_f32_16x16x32_bf16 v[72:75], v[132:135], v[48:51], v[72:75]
    v_exp_f32 v42, v42
    v_exp_f32 v43, v43
    s_add_u32 m0, s26, 0
    s_nop 0
    buffer_load_dwordx4 v196, s[8:11], s25 offen offset:0 lds
    v_cvt_pk_bf16_f32 v52, v40, v41
    v_cvt_pk_bf16_f32 v53, v42, v43
    v_mfma_f32_16x16x32_bf16 v[36:39], a[52:55], v[204:207], v[116:119]
    v_exp_f32 v44, v44
    v_exp_f32 v45, v45
    v_exp_f32 v46, v46
    v_exp_f32 v47, v47
    buffer_load_dwordx4 v197, s[8:11], s25 offen offset:1024 lds
    v_cvt_pk_bf16_f32 v54, v44, v45
    v_cvt_pk_bf16_f32 v55, v46, v47
    v_mfma_f32_16x16x32_bf16 v[40:43], a[56:59], v[204:207], v[116:119]
    v_exp_f32 v32, v32
    v_exp_f32 v33, v33
    v_mfma_f32_16x16x32_bf16 v[64:67], a[120:123], v[52:55], v[64:67]
    v_mfma_f32_16x16x32_bf16 v[68:71], a[124:127], v[52:55], v[68:71]
    v_mfma_f32_16x16x32_bf16 v[72:75], v[132:135], v[52:55], v[72:75]
    v_exp_f32 v34, v34
    v_exp_f32 v35, v35
    buffer_load_dwordx4 v198, s[8:11], s25 offen offset:2048 lds
    v_cvt_pk_bf16_f32 v48, v32, v33
    v_cvt_pk_bf16_f32 v49, v34, v35
    v_mfma_f32_16x16x32_bf16 v[44:47], a[60:63], v[204:207], v[116:119]
    v_exp_f32 v36, v36
    v_exp_f32 v37, v37
    v_exp_f32 v38, v38
    v_exp_f32 v39, v39
    buffer_load_dwordx4 v199, s[8:11], s25 offen offset:3072 lds
    v_cvt_pk_bf16_f32 v50, v36, v37
    v_cvt_pk_bf16_f32 v51, v38, v39
    v_mfma_f32_16x16x32_bf16 v[32:35], v[220:223], v[204:207], v[128:131]
    v_exp_f32 v40, v40
    v_exp_f32 v41, v41
    s_waitcnt vmcnt(12)
    v_mfma_f32_16x16x32_bf16 v[64:67], a[128:131], v[48:51], v[64:67]
    v_mfma_f32_16x16x32_bf16 v[68:71], a[132:135], v[48:51], v[68:71]
    v_mfma_f32_16x16x32_bf16 v[72:75], v[132:135], v[48:51], v[72:75]
    v_exp_f32 v42, v42
    v_exp_f32 v43, v43
    s_add_u32 m0, s26, 4096
    s_nop 0
    buffer_load_dwordx4 v200, s[8:11], s25 offen offset:0 lds
    v_cvt_pk_bf16_f32 v52, v40, v41
    v_cvt_pk_bf16_f32 v53, v42, v43
    s_nop 0
    v_exp_f32 v44, v44
    v_exp_f32 v45, v45
    v_exp_f32 v46, v46
    v_exp_f32 v47, v47
    buffer_load_dwordx4 v201, s[8:11], s25 offen offset:1024 lds
    v_cvt_pk_bf16_f32 v54, v44, v45
    v_cvt_pk_bf16_f32 v55, v46, v47
    s_nop 0
    v_exp_f32 v32, v32
    v_exp_f32 v33, v33
    v_mfma_f32_16x16x32_bf16 v[64:67], a[136:139], v[52:55], v[64:67]
    v_mfma_f32_16x16x32_bf16 v[68:71], a[140:143], v[52:55], v[68:71]
    v_mfma_f32_16x16x32_bf16 v[72:75], v[132:135], v[52:55], v[72:75]
    v_exp_f32 v34, v34
    v_exp_f32 v35, v35
    buffer_load_dwordx4 v202, s[8:11], s25 offen offset:2048 lds
    v_cvt_pk_bf16_f32 v48, v32, v33
    v_cvt_pk_bf16_f32 v49, v34, v35
    v_mov_b32 v50, 0
    v_mov_b32 v51, 0
    s_nop 1
    v_mfma_f32_16x16x32_bf16 v[64:67], v[236:239], v[48:51], v[64:67]
    v_mfma_f32_16x16x32_bf16 v[68:71], v[240:243], v[48:51], v[68:71]
    v_mfma_f32_16x16x32_bf16 v[72:75], v[132:135], v[48:51], v[72:75]
    v_sub_f32 v124, v96, v165
    v_sub_f32 v125, v97, v165
    v_sub_f32 v126, v98, v165
    v_sub_f32 v127, v99, v165
    v_sub_f32 v104, v80, v165
    v_sub_f32 v105, v81, v165
    v_sub_f32 v106, v82, v165
    v_sub_f32 v107, v83, v165
    v_sub_f32 v108, v84, v165
    v_sub_f32 v109, v85, v165
    v_sub_f32 v110, v86, v165
    v_sub_f32 v111, v87, v165
    v_sub_f32 v112, v88, v165
    v_sub_f32 v113, v89, v165
    v_sub_f32 v114, v90, v165
    v_sub_f32 v115, v91, v165
    v_sub_f32 v116, v92, v165
    v_sub_f32 v117, v93, v165
    v_sub_f32 v118, v94, v165
    v_sub_f32 v119, v95, v165
    v_sub_f32 v120, 0, v165
    v_sub_f32 v121, 0, v165
    v_sub_f32 v122, 0, v165
    v_sub_f32 v123, 0, v165
    v_sub_f32 v128, v100, v165
    v_sub_f32 v129, v101, v165
    v_sub_f32 v130, v102, v165
    v_sub_f32 v131, v103, v165
    v_mfma_f32_16x16x32_bf16 v[32:35], a[4:7], v[208:211], v[124:127]
    v_mfma_f32_16x16x32_bf16 v[36:39], a[8:11], v[208:211], v[104:107]
    v_mov_b32 v48, 0
    v_mov_b32 v49, 0
    v_rcp_f32 v168, v72
    s_nop 0
    v_mul_f32 v64, v64, v168
    v_mul_f32 v65, v65, v168
    v_mul_f32 v66, v66, v168
    v_mul_f32 v67, v67, v168
    v_mul_f32 v68, v68, v168
    v_mul_f32 v69, v69, v168
    v_mul_f32 v70, v70, v168
    v_mul_f32 v71, v71, v168
    v_cvt_pk_bf16_f32 v76, v64, v65
    v_cvt_pk_bf16_f32 v77, v66, v67
    v_cvt_pk_bf16_f32 v78, v68, v69
    v_cvt_pk_bf16_f32 v79, v70, v71
    buffer_store_dwordx4 v[76:79], v16, s[4:7], s35 offen sc1
    s_add_u32 s35, s35, 32768
    v_mfma_f32_16x16x32_bf16 v[40:43], a[12:15], v[208:211], v[104:107]
    v_exp_f32 v32, v32
    v_exp_f32 v33, v33
    v_exp_f32 v34, v34
    v_exp_f32 v35, v35
    buffer_load_dwordx4 v203, s[8:11], s25 offen offset:3072 lds
    v_cvt_pk_bf16_f32 v50, v32, v33
    v_cvt_pk_bf16_f32 v51, v34, v35
    v_mfma_f32_16x16x32_bf16 v[44:47], a[16:19], v[208:211], v[108:111]
    v_exp_f32 v36, v36
    v_exp_f32 v37, v37
    v_mfma_f32_16x16x32_bf16 v[64:67], a[80:83], v[48:51], 0
    v_mfma_f32_16x16x32_bf16 v[68:71], a[84:87], v[48:51], 0
    v_mfma_f32_16x16x32_bf16 v[72:75], v[132:135], v[48:51], 0
    v_exp_f32 v38, v38
    v_exp_f32 v39, v39
    s_add_u32 s25, s25, 524288
    s_add_u32 s26, s26, 32768
    v_cvt_pk_bf16_f32 v52, v36, v37
    v_cvt_pk_bf16_f32 v53, v38, v39
    v_mfma_f32_16x16x32_bf16 v[32:35], a[20:23], v[208:211], v[108:111]
    v_exp_f32 v40, v40
    v_exp_f32 v41, v41
    v_exp_f32 v42, v42
    v_exp_f32 v43, v43
    s_add_u32 m0, s26, 0
    s_nop 0
    buffer_load_dwordx4 v196, s[8:11], s25 offen offset:0 lds
    v_cvt_pk_bf16_f32 v54, v40, v41
    v_cvt_pk_bf16_f32 v55, v42, v43
    v_mfma_f32_16x16x32_bf16 v[36:39], a[24:27], v[208:211], v[108:111]
    v_exp_f32 v44, v44
    v_exp_f32 v45, v45
    v_mfma_f32_16x16x32_bf16 v[64:67], a[88:91], v[52:55], v[64:67]
    v_mfma_f32_16x16x32_bf16 v[68:71], a[92:95], v[52:55], v[68:71]
    v_mfma_f32_16x16x32_bf16 v[72:75], v[132:135], v[52:55], v[72:75]
    v_exp_f32 v46, v46
    v_exp_f32 v47, v47
    buffer_load_dwordx4 v197, s[8:11], s25 offen offset:1024 lds
    v_cvt_pk_bf16_f32 v48, v44, v45
    v_cvt_pk_bf16_f32 v49, v46, v47
    v_mfma_f32_16x16x32_bf16 v[40:43], a[28:31], v[208:211], v[108:111]
    v_exp_f32 v32, v32
    v_exp_f32 v33, v33
    v_exp_f32 v34, v34
    v_exp_f32 v35, v35
    buffer_load_dwordx4 v198, s[8:11], s25 offen offset:2048 lds
    v_cvt_pk_bf16_f32 v50, v32, v33
    v_cvt_pk_bf16_f32 v51, v34, v35
    v_mfma_f32_16x16x32_bf16 v[44:47], a[32:35], v[208:211], v[112:115]
    v_exp_f32 v36, v36
    v_exp_f32 v37, v37
    v_mfma_f32_16x16x32_bf16 v[64:67], a[96:99], v[48:51], v[64:67]
    v_mfma_f32_16x16x32_bf16 v[68:71], a[100:103], v[48:51], v[68:71]
    v_mfma_f32_16x16x32_bf16 v[72:75], v[132:135], v[48:51], v[72:75]
    v_exp_f32 v38, v38
    v_exp_f32 v39, v39
    buffer_load_dwordx4 v199, s[8:11], s25 offen offset:3072 lds
    v_cvt_pk_bf16_f32 v52, v36, v37
    v_cvt_pk_bf16_f32 v53, v38, v39
    v_mfma_f32_16x16x32_bf16 v[32:35], a[36:39], v[208:211], v[112:115]
    v_exp_f32 v40, v40
    v_exp_f32 v41, v41
    v_exp_f32 v42, v42
    v_exp_f32 v43, v43
    s_add_u32 m0, s26, 4096
    s_nop 0
    buffer_load_dwordx4 v200, s[8:11], s25 offen offset:0 lds
    v_cvt_pk_bf16_f32 v54, v40, v41
    v_cvt_pk_bf16_f32 v55, v42, v43
    v_mfma_f32_16x16x32_bf16 v[36:39], a[40:43], v[208:211], v[112:115]
    v_exp_f32 v44, v44
    v_exp_f32 v45, v45
    v_mfma_f32_16x16x32_bf16 v[64:67], a[104:107], v[52:55], v[64:67]
    v_mfma_f32_16x16x32_bf16 v[68:71], a[108:111], v[52:55], v[68:71]
    v_mfma_f32_16x16x32_bf16 v[72:75], v[132:135], v[52:55], v[72:75]
    v_exp_f32 v46, v46
    v_exp_f32 v47, v47
    buffer_load_dwordx4 v201, s[8:11], s25 offen offset:1024 lds
    v_cvt_pk_bf16_f32 v48, v44, v45
    v_cvt_pk_bf16_f32 v49, v46, v47
    v_mfma_f32_16x16x32_bf16 v[40:43], a[44:47], v[208:211], v[112:115]
    v_exp_f32 v32, v32
    v_exp_f32 v33, v33
    v_exp_f32 v34, v34
    v_exp_f32 v35, v35
    buffer_load_dwordx4 v202, s[8:11], s25 offen offset:2048 lds
    v_cvt_pk_bf16_f32 v50, v32, v33
    v_cvt_pk_bf16_f32 v51, v34, v35
    v_mfma_f32_16x16x32_bf16 v[44:47], a[48:51], v[208:211], v[116:119]
    v_exp_f32 v36, v36
    v_exp_f32 v37, v37
    v_mfma_f32_16x16x32_bf16 v[64:67], a[112:115], v[48:51], v[64:67]
    v_mfma_f32_16x16x32_bf16 v[68:71], a[116:119], v[48:51], v[68:71]
    v_mfma_f32_16x16x32_bf16 v[72:75], v[132:135], v[48:51], v[72:75]
    v_exp_f32 v38, v38
    v_exp_f32 v39, v39
    buffer_load_dwordx4 v203, s[8:11], s25 offen offset:3072 lds
    v_cvt_pk_bf16_f32 v52, v36, v37
    v_cvt_pk_bf16_f32 v53, v38, v39
    v_mfma_f32_16x16x32_bf16 v[32:35], a[52:55], v[208:211], v[116:119]
    v_exp_f32 v40, v40
    v_exp_f32 v41, v41
    v_exp_f32 v42, v42
    v_exp_f32 v43, v43
    s_add_u32 s25, s25, 524288
    s_add_u32 s26, s26, 32768
    v_cvt_pk_bf16_f32 v54, v40, v41
    v_cvt_pk_bf16_f32 v55, v42, v43
    v_mfma_f32_16x16x32_bf16 v[36:39], a[56:59], v[208:211], v[116:119]
    v_exp_f32 v44, v44
    v_exp_f32 v45, v45
    v_mfma_f32_16x16x32_bf16 v[64:67], a[120:123], v[52:55], v[64:67]
    v_mfma_f32_16x16x32_bf16 v[68:71], a[124:127], v[52:55], v[68:71]
    v_mfma_f32_16x16x32_bf16 v[72:75], v[132:135], v[52:55], v[72:75]
    v_exp_f32 v46, v46
    v_exp_f32 v47, v47
    s_add_u32 m0, s26, 0
    s_nop 0
    buffer_load_dwordx4 v196, s[8:11], s25 offen offset:0 lds
    v_cvt_pk_bf16_f32 v48, v44, v45
    v_cvt_pk_bf16_f32 v49, v46, v47
    v_mfma_f32_16x16x32_bf16 v[40:43], a[60:63], v[208:211], v[116:119]
    v_exp_f32 v32, v32
    v_exp_f32 v33, v33
    v_exp_f32 v34, v34
    v_exp_f32 v35, v35
    buffer_load_dwordx4 v197, s[8:11], s25 offen offset:1024 lds
    v_cvt_pk_bf16_f32 v50, v32, v33
    v_cvt_pk_bf16_f32 v51, v34, v35
    v_mfma_f32_16x16x32_bf16 v[44:47], v[220:223], v[208:211], v[120:123]
    v_exp_f32 v36, v36
    v_exp_f32 v37, v37
    v_mfma_f32_16x16x32_bf16 v[64:67], a[128:131], v[48:51], v[64:67]
    v_mfma_f32_16x16x32_bf16 v[68:71], a[132:135], v[48:51], v[68:71]
    v_mfma_f32_16x16x32_bf16 v[72:75], v[132:135], v[48:51], v[72:75]
    v_exp_f32 v38, v38
    v_exp_f32 v39, v39
    buffer_load_dwordx4 v198, s[8:11], s25 offen offset:2048 lds
    v_cvt_pk_bf16_f32 v52, v36, v37
    v_cvt_pk_bf16_f32 v53, v38, v39
    v_mfma_f32_16x16x32_bf16 v[32:35], v[224:227], v[208:211], v[128:131]
    v_exp_f32 v40, v40
    v_exp_f32 v41, v41
    v_exp_f32 v42, v42
    v_exp_f32 v43, v43
    buffer_load_dwordx4 v199, s[8:11], s25 offen offset:3072 lds
    v_cvt_pk_bf16_f32 v54, v40, v41
    v_cvt_pk_bf16_f32 v55, v42, v43
    s_nop 0
    v_exp_f32 v44, v44
    v_exp_f32 v45, v45
    v_mfma_f32_16x16x32_bf16 v[64:67], a[136:139], v[52:55], v[64:67]
    v_mfma_f32_16x16x32_bf16 v[68:71], a[140:143], v[52:55], v[68:71]
    v_mfma_f32_16x16x32_bf16 v[72:75], v[132:135], v[52:55], v[72:75]
    v_exp_f32 v46, v46
    v_exp_f32 v47, v47
    s_add_u32 m0, s26, 4096
    s_nop 0
    buffer_load_dwordx4 v200, s[8:11], s25 offen offset:0 lds
    v_cvt_pk_bf16_f32 v48, v44, v45
    v_cvt_pk_bf16_f32 v49, v46, v47
    s_nop 0
    v_exp_f32 v32, v32
    v_exp_f32 v33, v33
    v_exp_f32 v34, v34
    v_exp_f32 v35, v35
    buffer_load_dwordx4 v201, s[8:11], s25 offen offset:1024 lds
    v_cvt_pk_bf16_f32 v50, v32, v33
    v_cvt_pk_bf16_f32 v51, v34, v35
    s_nop 1
    v_mfma_f32_16x16x32_bf16 v[64:67], v[236:239], v[48:51], v[64:67]
    v_mfma_f32_16x16x32_bf16 v[68:71], v[240:243], v[48:51], v[68:71]
    v_mfma_f32_16x16x32_bf16 v[72:75], v[132:135], v[48:51], v[72:75]
    v_sub_f32 v124, v96, v166
    v_sub_f32 v125, v97, v166
    v_sub_f32 v126, v98, v166
    v_sub_f32 v127, v99, v166
    v_sub_f32 v104, v80, v166
    v_sub_f32 v105, v81, v166
    v_sub_f32 v106, v82, v166
    v_sub_f32 v107, v83, v166
    v_sub_f32 v108, v84, v166
    v_sub_f32 v109, v85, v166
    v_sub_f32 v110, v86, v166
    v_sub_f32 v111, v87, v166
    v_sub_f32 v112, v88, v166
    v_sub_f32 v113, v89, v166
    v_sub_f32 v114, v90, v166
    v_sub_f32 v115, v91, v166
    v_sub_f32 v116, v92, v166
    v_sub_f32 v117, v93, v166
    v_sub_f32 v118, v94, v166
    v_sub_f32 v119, v95, v166
    v_sub_f32 v120, 0, v166
    v_sub_f32 v121, 0, v166
    v_sub_f32 v122, 0, v166
    v_sub_f32 v123, 0, v166
    v_sub_f32 v128, v100, v166
    v_sub_f32 v129, v101, v166
    v_sub_f32 v130, v102, v166
    v_sub_f32 v131, v103, v166
    v_mfma_f32_16x16x32_bf16 v[32:35], a[8:11], v[212:215], v[124:127]
    v_mfma_f32_16x16x32_bf16 v[36:39], a[12:15], v[212:215], v[104:107]
    v_rcp_f32 v168, v72
    s_nop 0
    v_mul_f32 v64, v64, v168
    v_mul_f32 v65, v65, v168
    v_mul_f32 v66, v66, v168
    v_mul_f32 v67, v67, v168
    v_mul_f32 v68, v68, v168
    v_mul_f32 v69, v69, v168
    v_mul_f32 v70, v70, v168
    v_mul_f32 v71, v71, v168
    v_cvt_pk_bf16_f32 v76, v64, v65
    v_cvt_pk_bf16_f32 v77, v66, v67
    v_cvt_pk_bf16_f32 v78, v68, v69
    v_cvt_pk_bf16_f32 v79, v70, v71
    buffer_store_dwordx4 v[76:79], v16, s[4:7], s35 offen sc1
    s_add_u32 s35, s35, 32768
    v_mfma_f32_16x16x32_bf16 v[40:43], a[16:19], v[212:215], v[108:111]
    v_exp_f32 v32, v32
    v_exp_f32 v33, v33
    v_exp_f32 v34, v34
    v_exp_f32 v35, v35
    buffer_load_dwordx4 v202, s[8:11], s25 offen offset:2048 lds
    v_cvt_pk_bf16_f32 v48, v32, v33
    v_cvt_pk_bf16_f32 v49, v34, v35
    v_mfma_f32_16x16x32_bf16 v[44:47], a[20:23], v[212:215], v[108:111]
    v_exp_f32 v36, v36
    v_exp_f32 v37, v37
    v_exp_f32 v38, v38
    v_exp_f32 v39, v39
    buffer_load_dwordx4 v203, s[8:11], s25 offen offset:3072 lds
    v_cvt_pk_bf16_f32 v50, v36, v37
    v_cvt_pk_bf16_f32 v51, v38, v39
    v_mfma_f32_16x16x32_bf16 v[32:35], a[24:27], v[212:215], v[108:111]
    v_exp_f32 v40, v40
    v_exp_f32 v41, v41
    v_mfma_f32_16x16x32_bf16 v[64:67], a[88:91], v[48:51], 0
    v_mfma_f32_16x16x32_bf16 v[68:71], a[92:95], v[48:51], 0
    v_mfma_f32_16x16x32_bf16 v[72:75], v[132:135], v[48:51], 0
    v_exp_f32 v42, v42
    v_exp_f32 v43, v43
    s_add_u32 s25, s25, 524288
    s_add_u32 s26, s26, 32768
    v_cvt_pk_bf16_f32 v52, v40, v41
    v_cvt_pk_bf16_f32 v53, v42, v43
    v_mfma_f32_16x16x32_bf16 v[36:39], a[28:31], v[212:215], v[108:111]
    v_exp_f32 v44, v44
    v_exp_f32 v45, v45
    v_exp_f32 v46, v46
    v_exp_f32 v47, v47
    s_lshl_b32 s27, s20, 16
    s_lshl_b32 s17, s73, 7
    s_add_u32 s27, s27, s17
    v_lshrrev_b32 v23, 3, v1
    v_mul_u32_u24 v23, 1920, v23
    v_lshlrev_b32 v24, 4, v1
    v_add_u32 v23, v23, v24
    s_lshl_b32 s28, s20, 12
    s_add_u32 s28, s28, 131072
    v_cvt_pk_bf16_f32 v54, v44, v45
    v_cvt_pk_bf16_f32 v55, v46, v47
    v_mfma_f32_16x16x32_bf16 v[40:43], a[32:35], v[212:215], v[112:115]
    v_exp_f32 v32, v32
    v_exp_f32 v33, v33
    v_mfma_f32_16x16x32_bf16 v[64:67], a[96:99], v[52:55], v[64:67]
    v_mfma_f32_16x16x32_bf16 v[68:71], a[100:103], v[52:55], v[68:71]
    v_mfma_f32_16x16x32_bf16 v[72:75], v[132:135], v[52:55], v[72:75]
    v_exp_f32 v34, v34
    v_exp_f32 v35, v35
    s_add_u32 m0, s28, 0
    s_add_u32 s18, s27, 0
    buffer_load_dwordx4 v23, s[12:15], s18 offen lds
    v_cvt_pk_bf16_f32 v48, v32, v33
    v_cvt_pk_bf16_f32 v49, v34, v35
    v_mfma_f32_16x16x32_bf16 v[44:47], a[36:39], v[212:215], v[112:115]
    v_exp_f32 v36, v36
    v_exp_f32 v37, v37
    v_exp_f32 v38, v38
    v_exp_f32 v39, v39
    s_add_u32 m0, s28, 1024
    s_add_u32 s18, s27, 16384
    buffer_load_dwordx4 v23, s[12:15], s18 offen lds
    v_cvt_pk_bf16_f32 v50, v36, v37
    v_cvt_pk_bf16_f32 v51, v38, v39
    v_mfma_f32_16x16x32_bf16 v[32:35], a[40:43], v[212:215], v[112:115]
    v_exp_f32 v40, v40
    v_exp_f32 v41, v41
    v_mfma_f32_16x16x32_bf16 v[64:67], a[104:107], v[48:51], v[64:67]
    v_mfma_f32_16x16x32_bf16 v[68:71], a[108:111], v[48:51], v[68:71]
    v_mfma_f32_16x16x32_bf16 v[72:75], v[132:135], v[48:51], v[72:75]
    v_exp_f32 v42, v42
    v_exp_f32 v43, v43
    s_add_u32 m0, s28, 2048
    s_add_u32 s18, s27, 32768
    buffer_load_dwordx4 v23, s[12:15], s18 offen lds
    v_cvt_pk_bf16_f32 v52, v40, v41
    v_cvt_pk_bf16_f32 v53, v42, v43
    v_mfma_f32_16x16x32_bf16 v[36:39], a[44:47], v[212:215], v[112:115]
    v_exp_f32 v44, v44
    v_exp_f32 v45, v45
    v_exp_f32 v46, v46
    v_exp_f32 v47, v47
    s_add_u32 m0, s28, 3072
    s_add_u32 s18, s27, 49152
    buffer_load_dwordx4 v23, s[12:15], s18 offen lds
    v_cvt_pk_bf16_f32 v54, v44, v45
    v_cvt_pk_bf16_f32 v55, v46, v47
    v_mfma_f32_16x16x32_bf16 v[40:43], a[48:51], v[212:215], v[116:119]
    v_exp_f32 v32, v32
    v_exp_f32 v33, v33
    v_mfma_f32_16x16x32_bf16 v[64:67], a[112:115], v[52:55], v[64:67]
    v_mfma_f32_16x16x32_bf16 v[68:71], a[116:119], v[52:55], v[68:71]
    v_mfma_f32_16x16x32_bf16 v[72:75], v[132:135], v[52:55], v[72:75]
    v_exp_f32 v34, v34
    v_exp_f32 v35, v35
    s_mov_b32 s29, 40108032
    v_lshlrev_b32 v21, 4, v0
    buffer_load_dwordx4 v[140:143], v21, s[4:7], s29 offen sc1
    v_cvt_pk_bf16_f32 v48, v32, v33
    v_cvt_pk_bf16_f32 v49, v34, v35
    v_mfma_f32_16x16x32_bf16 v[44:47], a[52:55], v[212:215], v[116:119]
    v_exp_f32 v36, v36
    v_exp_f32 v37, v37
    v_exp_f32 v38, v38
    v_exp_f32 v39, v39
    s_lshl_b32 s29, s72, 10
    s_lshl_b32 s17, s20, 8
    s_add_u32 s29, s29, s17
    s_add_u32 s29, s29, 39845888
    v_and_b32 v22, 15, v1
    v_lshlrev_b32 v22, 3, v22
    buffer_load_dword v144, v22, s[4:7], s29 offen sc1
    buffer_load_dword v145, v22, s[4:7], s29 offen offset:128 sc1
    v_cvt_pk_bf16_f32 v50, v36, v37
    v_cvt_pk_bf16_f32 v51, v38, v39
    v_mfma_f32_16x16x32_bf16 v[32:35], a[56:59], v[212:215], v[116:119]
    v_exp_f32 v40, v40
    v_exp_f32 v41, v41
    v_mfma_f32_16x16x32_bf16 v[64:67], a[120:123], v[48:51], v[64:67]
    v_mfma_f32_16x16x32_bf16 v[68:71], a[124:127], v[48:51], v[68:71]
    v_mfma_f32_16x16x32_bf16 v[72:75], v[132:135], v[48:51], v[72:75]
    v_exp_f32 v42, v42
    v_exp_f32 v43, v43
    s_cmp_ge_u32 s20, 2
    s_cselect_b32 s80, s94, s92
    s_cselect_b32 s81, s95, s93
    s_mov_b32 s82, 7340032
    s_mov_b32 s83, 0x20000
    s_mov_b32 s36, s96
    s_mov_b32 s37, s97
    s_mov_b32 s38, 7340032
    s_mov_b32 s39, 0x20000
    s_lshl_b32 s16, s2, 1
    s_and_b32 s17, s20, 1
    s_add_u32 s16, s16, s17
    s_mul_i32 s16, s16, 8064
    s_add_u32 s16, s16, 0
    v_lshlrev_b32 v28, 7, v1
    v_mov_b32 v29, 0x10000000
    v_cmp_gt_u32 vcc, 63, v1
    s_nop 1
    v_cndmask_b32 v28, v29, v28, vcc
    buffer_load_dword v29, v28, s[80:83], s16 offen
    v_cvt_pk_bf16_f32 v52, v40, v41
    v_cvt_pk_bf16_f32 v53, v42, v43
    v_mfma_f32_16x16x32_bf16 v[36:39], a[60:63], v[212:215], v[116:119]
    v_exp_f32 v44, v44
    v_exp_f32 v45, v45
    v_exp_f32 v46, v46
    v_exp_f32 v47, v47
    v_cvt_pk_bf16_f32 v54, v44, v45
    v_cvt_pk_bf16_f32 v55, v46, v47
    v_mfma_f32_16x16x32_bf16 v[40:43], v[220:223], v[212:215], v[120:123]
    v_exp_f32 v32, v32
    v_exp_f32 v33, v33
    v_mfma_f32_16x16x32_bf16 v[64:67], a[128:131], v[52:55], v[64:67]
    v_mfma_f32_16x16x32_bf16 v[68:71], a[132:135], v[52:55], v[68:71]
    v_mfma_f32_16x16x32_bf16 v[72:75], v[132:135], v[52:55], v[72:75]
    v_exp_f32 v34, v34
    v_exp_f32 v35, v35
    v_cvt_pk_bf16_f32 v48, v32, v33
    v_cvt_pk_bf16_f32 v49, v34, v35
    v_mfma_f32_16x16x32_bf16 v[44:47], v[224:227], v[212:215], v[120:123]
    v_exp_f32 v36, v36
    v_exp_f32 v37, v37
    v_exp_f32 v38, v38
    v_exp_f32 v39, v39
    v_cvt_pk_bf16_f32 v50, v36, v37
    v_cvt_pk_bf16_f32 v51, v38, v39
    v_mfma_f32_16x16x32_bf16 v[32:35], v[228:231], v[212:215], v[128:131]
    v_exp_f32 v40, v40
    v_exp_f32 v41, v41
    v_mfma_f32_16x16x32_bf16 v[64:67], a[136:139], v[48:51], v[64:67]
    v_mfma_f32_16x16x32_bf16 v[68:71], a[140:143], v[48:51], v[68:71]
    v_mfma_f32_16x16x32_bf16 v[72:75], v[132:135], v[48:51], v[72:75]
    v_exp_f32 v42, v42
    v_exp_f32 v43, v43
    v_cvt_pk_bf16_f32 v52, v40, v41
    v_cvt_pk_bf16_f32 v53, v42, v43
    s_nop 0
    v_exp_f32 v44, v44
    v_exp_f32 v45, v45
    v_exp_f32 v46, v46
    v_exp_f32 v47, v47
    v_cvt_pk_bf16_f32 v54, v44, v45
    v_cvt_pk_bf16_f32 v55, v46, v47
    s_nop 0
    v_exp_f32 v32, v32
    v_exp_f32 v33, v33
    v_mfma_f32_16x16x32_bf16 v[64:67], v[236:239], v[52:55], v[64:67]
    v_mfma_f32_16x16x32_bf16 v[68:71], v[240:243], v[52:55], v[68:71]
    v_mfma_f32_16x16x32_bf16 v[72:75], v[132:135], v[52:55], v[72:75]
    v_exp_f32 v34, v34
    v_exp_f32 v35, v35
    v_cvt_pk_bf16_f32 v48, v32, v33
    v_cvt_pk_bf16_f32 v49, v34, v35
    v_mov_b32 v50, 0
    v_mov_b32 v51, 0
    s_nop 1
    v_mfma_f32_16x16x32_bf16 v[64:67], v[244:247], v[48:51], v[64:67]
    v_mfma_f32_16x16x32_bf16 v[68:71], v[248:251], v[48:51], v[68:71]
    v_mfma_f32_16x16x32_bf16 v[72:75], v[132:135], v[48:51], v[72:75]
    v_sub_f32 v124, v96, v167
    v_sub_f32 v125, v97, v167
    v_sub_f32 v126, v98, v167
    v_sub_f32 v127, v99, v167
    v_sub_f32 v104, v80, v167
    v_sub_f32 v105, v81, v167
    v_sub_f32 v106, v82, v167
    v_sub_f32 v107, v83, v167
    v_sub_f32 v108, v84, v167
    v_sub_f32 v109, v85, v167
    v_sub_f32 v110, v86, v167
    v_sub_f32 v111, v87, v167
    v_sub_f32 v112, v88, v167
    v_sub_f32 v113, v89, v167
    v_sub_f32 v114, v90, v167
    v_sub_f32 v115, v91, v167
    v_sub_f32 v116, v92, v167
    v_sub_f32 v117, v93, v167
    v_sub_f32 v118, v94, v167
    v_sub_f32 v119, v95, v167
    v_sub_f32 v120, 0, v167
    v_sub_f32 v121, 0, v167
    v_sub_f32 v122, 0, v167
    v_sub_f32 v123, 0, v167
    v_sub_f32 v128, v100, v167
    v_sub_f32 v129, v101, v167
    v_sub_f32 v130, v102, v167
    v_sub_f32 v131, v103, v167
    v_mfma_f32_16x16x32_bf16 v[32:35], a[12:15], v[216:219], v[124:127]
    v_mfma_f32_16x16x32_bf16 v[36:39], a[16:19], v[216:219], v[108:111]
    v_mov_b32 v48, 0
    v_mov_b32 v49, 0
    v_rcp_f32 v168, v72
    s_nop 0
    v_mul_f32 v64, v64, v168
    v_mul_f32 v65, v65, v168
    v_mul_f32 v66, v66, v168
    v_mul_f32 v67, v67, v168
    v_mul_f32 v68, v68, v168
    v_mul_f32 v69, v69, v168
    v_mul_f32 v70, v70, v168
    v_mul_f32 v71, v71, v168
    v_cvt_pk_bf16_f32 v76, v64, v65
    v_cvt_pk_bf16_f32 v77, v66, v67
    v_cvt_pk_bf16_f32 v78, v68, v69
    v_cvt_pk_bf16_f32 v79, v70, v71
    buffer_store_dwordx4 v[76:79], v16, s[4:7], s35 offen sc1
    s_add_u32 s35, s35, 32768
    v_mfma_f32_16x16x32_bf16 v[40:43], a[20:23], v[216:219], v[108:111]
    v_exp_f32 v32, v32
    v_exp_f32 v33, v33
    v_exp_f32 v34, v34
    v_exp_f32 v35, v35
    v_cvt_pk_bf16_f32 v50, v32, v33
    v_cvt_pk_bf16_f32 v51, v34, v35
    v_mfma_f32_16x16x32_bf16 v[44:47], a[24:27], v[216:219], v[108:111]
    v_exp_f32 v36, v36
    v_exp_f32 v37, v37
    v_mfma_f32_16x16x32_bf16 v[64:67], a[88:91], v[48:51], 0
    v_mfma_f32_16x16x32_bf16 v[68:71], a[92:95], v[48:51], 0
    v_mfma_f32_16x16x32_bf16 v[72:75], v[132:135], v[48:51], 0
    v_exp_f32 v38, v38
    v_exp_f32 v39, v39
    v_cvt_pk_bf16_f32 v52, v36, v37
    v_cvt_pk_bf16_f32 v53, v38, v39
    v_mfma_f32_16x16x32_bf16 v[32:35], a[28:31], v[216:219], v[108:111]
    v_exp_f32 v40, v40
    v_exp_f32 v41, v41
    v_exp_f32 v42, v42
    v_exp_f32 v43, v43
    v_cvt_pk_bf16_f32 v54, v40, v41
    v_cvt_pk_bf16_f32 v55, v42, v43
    v_mfma_f32_16x16x32_bf16 v[36:39], a[32:35], v[216:219], v[112:115]
    v_exp_f32 v44, v44
    v_exp_f32 v45, v45
    v_mfma_f32_16x16x32_bf16 v[64:67], a[96:99], v[52:55], v[64:67]
    v_mfma_f32_16x16x32_bf16 v[68:71], a[100:103], v[52:55], v[68:71]
    v_mfma_f32_16x16x32_bf16 v[72:75], v[132:135], v[52:55], v[72:75]
    v_exp_f32 v46, v46
    v_exp_f32 v47, v47
    v_cvt_pk_bf16_f32 v48, v44, v45
    v_cvt_pk_bf16_f32 v49, v46, v47
    v_mfma_f32_16x16x32_bf16 v[40:43], a[36:39], v[216:219], v[112:115]
    v_exp_f32 v32, v32
    v_exp_f32 v33, v33
    v_exp_f32 v34, v34
    v_exp_f32 v35, v35
    v_cvt_pk_bf16_f32 v50, v32, v33
    v_cvt_pk_bf16_f32 v51, v34, v35
    v_mfma_f32_16x16x32_bf16 v[44:47], a[40:43], v[216:219], v[112:115]
    v_exp_f32 v36, v36
    v_exp_f32 v37, v37
    v_mfma_f32_16x16x32_bf16 v[64:67], a[104:107], v[48:51], v[64:67]
    v_mfma_f32_16x16x32_bf16 v[68:71], a[108:111], v[48:51], v[68:71]
    v_mfma_f32_16x16x32_bf16 v[72:75], v[132:135], v[48:51], v[72:75]
    v_exp_f32 v38, v38
    v_exp_f32 v39, v39
    v_cvt_pk_bf16_f32 v52, v36, v37
    v_cvt_pk_bf16_f32 v53, v38, v39
    v_mfma_f32_16x16x32_bf16 v[32:35], a[44:47], v[216:219], v[112:115]
    v_exp_f32 v40, v40
    v_exp_f32 v41, v41
    v_exp_f32 v42, v42
    v_exp_f32 v43, v43
    v_cvt_pk_bf16_f32 v54, v40, v41
    v_cvt_pk_bf16_f32 v55, v42, v43
    v_mfma_f32_16x16x32_bf16 v[36:39], a[48:51], v[216:219], v[116:119]
    v_exp_f32 v44, v44
    v_exp_f32 v45, v45
    v_mfma_f32_16x16x32_bf16 v[64:67], a[112:115], v[52:55], v[64:67]
    v_mfma_f32_16x16x32_bf16 v[68:71], a[116:119], v[52:55], v[68:71]
    v_mfma_f32_16x16x32_bf16 v[72:75], v[132:135], v[52:55], v[72:75]
    v_exp_f32 v46, v46
    v_exp_f32 v47, v47
    v_cvt_pk_bf16_f32 v48, v44, v45
    v_cvt_pk_bf16_f32 v49, v46, v47
    v_mfma_f32_16x16x32_bf16 v[40:43], a[52:55], v[216:219], v[116:119]
    v_exp_f32 v32, v32
    v_exp_f32 v33, v33
    v_exp_f32 v34, v34
    v_exp_f32 v35, v35
    v_cvt_pk_bf16_f32 v50, v32, v33
    v_cvt_pk_bf16_f32 v51, v34, v35
    v_mfma_f32_16x16x32_bf16 v[44:47], a[56:59], v[216:219], v[116:119]
    v_exp_f32 v36, v36
    v_exp_f32 v37, v37
    v_mfma_f32_16x16x32_bf16 v[64:67], a[120:123], v[48:51], v[64:67]
    v_mfma_f32_16x16x32_bf16 v[68:71], a[124:127], v[48:51], v[68:71]
    v_mfma_f32_16x16x32_bf16 v[72:75], v[132:135], v[48:51], v[72:75]
    v_exp_f32 v38, v38
    v_exp_f32 v39, v39
    v_cvt_pk_bf16_f32 v52, v36, v37
    v_cvt_pk_bf16_f32 v53, v38, v39
    v_mfma_f32_16x16x32_bf16 v[32:35], a[60:63], v[216:219], v[116:119]
    v_exp_f32 v40, v40
    v_exp_f32 v41, v41
    v_exp_f32 v42, v42
    v_exp_f32 v43, v43
    v_cvt_pk_bf16_f32 v54, v40, v41
    v_cvt_pk_bf16_f32 v55, v42, v43
    v_mfma_f32_16x16x32_bf16 v[36:39], v[220:223], v[216:219], v[120:123]
    v_exp_f32 v44, v44
    v_exp_f32 v45, v45
    v_mfma_f32_16x16x32_bf16 v[64:67], a[128:131], v[52:55], v[64:67]
    v_mfma_f32_16x16x32_bf16 v[68:71], a[132:135], v[52:55], v[68:71]
    v_mfma_f32_16x16x32_bf16 v[72:75], v[132:135], v[52:55], v[72:75]
    v_exp_f32 v46, v46
    v_exp_f32 v47, v47
    v_cvt_pk_bf16_f32 v48, v44, v45
    v_cvt_pk_bf16_f32 v49, v46, v47
    v_mfma_f32_16x16x32_bf16 v[40:43], v[224:227], v[216:219], v[120:123]
    v_exp_f32 v32, v32
    v_exp_f32 v33, v33
    v_exp_f32 v34, v34
    v_exp_f32 v35, v35
    v_cvt_pk_bf16_f32 v50, v32, v33
    v_cvt_pk_bf16_f32 v51, v34, v35
    v_mfma_f32_16x16x32_bf16 v[44:47], v[228:231], v[216:219], v[120:123]
    v_exp_f32 v36, v36
    v_exp_f32 v37, v37
    v_mfma_f32_16x16x32_bf16 v[64:67], a[136:139], v[48:51], v[64:67]
    v_mfma_f32_16x16x32_bf16 v[68:71], a[140:143], v[48:51], v[68:71]
    v_mfma_f32_16x16x32_bf16 v[72:75], v[132:135], v[48:51], v[72:75]
    v_exp_f32 v38, v38
    v_exp_f32 v39, v39
    v_cvt_pk_bf16_f32 v52, v36, v37
    v_cvt_pk_bf16_f32 v53, v38, v39
    v_mfma_f32_16x16x32_bf16 v[32:35], v[232:235], v[216:219], v[128:131]
    v_exp_f32 v40, v40
    v_exp_f32 v41, v41
    v_exp_f32 v42, v42
    v_exp_f32 v43, v43
    v_cvt_pk_bf16_f32 v54, v40, v41
    v_cvt_pk_bf16_f32 v55, v42, v43
    s_nop 0
    v_exp_f32 v44, v44
    v_exp_f32 v45, v45
    v_mfma_f32_16x16x32_bf16 v[64:67], v[236:239], v[52:55], v[64:67]
    v_mfma_f32_16x16x32_bf16 v[68:71], v[240:243], v[52:55], v[68:71]
    v_mfma_f32_16x16x32_bf16 v[72:75], v[132:135], v[52:55], v[72:75]
    v_exp_f32 v46, v46
    v_exp_f32 v47, v47
    v_cvt_pk_bf16_f32 v48, v44, v45
    v_cvt_pk_bf16_f32 v49, v46, v47
    s_nop 0
    v_exp_f32 v32, v32
    v_exp_f32 v33, v33
    v_exp_f32 v34, v34
    v_exp_f32 v35, v35
    v_cvt_pk_bf16_f32 v50, v32, v33
    v_cvt_pk_bf16_f32 v51, v34, v35
    s_nop 1
    v_mfma_f32_16x16x32_bf16 v[64:67], v[244:247], v[48:51], v[64:67]
    v_mfma_f32_16x16x32_bf16 v[68:71], v[248:251], v[48:51], v[68:71]
    v_mfma_f32_16x16x32_bf16 v[72:75], v[132:135], v[48:51], v[72:75]
    s_nop 7
    v_rcp_f32 v168, v72
    s_nop 0
    v_mul_f32 v64, v64, v168
    v_mul_f32 v65, v65, v168
    v_mul_f32 v66, v66, v168
    v_mul_f32 v67, v67, v168
    v_mul_f32 v68, v68, v168
    v_mul_f32 v69, v69, v168
    v_mul_f32 v70, v70, v168
    v_mul_f32 v71, v71, v168
    v_cvt_pk_bf16_f32 v76, v64, v65
    v_cvt_pk_bf16_f32 v77, v66, v67
    v_cvt_pk_bf16_f32 v78, v68, v69
    v_cvt_pk_bf16_f32 v79, v70, v71
    buffer_store_dwordx4 v[76:79], v16, s[4:7], s35 offen sc1
    s_add_u32 s35, s35, 32768
    s_waitcnt vmcnt(4)
    v_lshlrev_b32 v21, 4, v0
    v_add_u32 v21, 147456, v21
    ds_write_b128 v21, v[140:143]
    v_mov_b32 v148, 0
    v_mov_b32 v149, 0
    v_mov_b32 v150, 0
    v_mov_b32 v151, 0
    ds_write_b128 v21, v[148:151] offset:4096
    s_waitcnt lgkmcnt(0)
    v_and_b32 v23, 3, v1
    v_lshrrev_b32 v24, 4, v1
    v_lshlrev_b32 v24, 1, v24
    v_add_u32 v24, v24, v23
    v_lshlrev_b32 v24, 4, v24
    v_add_u32 v24, 147456, v24
    v_mov_b32 v25, 151552
    v_cmp_gt_u32 vcc, 2, v23
    s_nop 1
    v_cndmask_b32 v20, v25, v24, vcc
    v_mov_b32 v64, 0
    v_mov_b32 v65, 0
    v_mov_b32 v66, 0
    v_mov_b32 v67, 0
    v_mov_b32 v68, 0
    v_mov_b32 v69, 0
    v_mov_b32 v70, 0
    v_mov_b32 v71, 0
    v_and_b32 v23, 15, v1
    v_lshlrev_b32 v23, 7, v23
    v_lshrrev_b32 v24, 4, v1
    v_lshlrev_b32 v24, 3, v24
    v_add_u32 v23, v23, v24
    s_lshl_b32 s17, s20, 12
    s_add_u32 s17, s17, 131072
    v_add_u32 v23, s17, v23
    ds_read_b64 v[96:97], v23 offset:0
    ds_read_b64 v[98:99], v23 offset:32
    ds_read_b64 v[100:101], v23 offset:64
    ds_read_b64 v[102:103], v23 offset:96
    ds_read_b64 v[104:105], v23 offset:2048
    ds_read_b64 v[106:107], v23 offset:2080
    ds_read_b64 v[108:109], v23 offset:2112
    ds_read_b64 v[110:111], v23 offset:2144
    s_waitcnt lgkmcnt(0)
    v_lshlrev_b32 v32, 16, v96
    v_and_b32 v33, 0xffff0000, v96
    v_lshlrev_b32 v34, 16, v97
    v_and_b32 v35, 0xffff0000, v97
    v_lshlrev_b32 v40, 16, v98
    v_and_b32 v41, 0xffff0000, v98
    v_lshlrev_b32 v42, 16, v99
    v_and_b32 v43, 0xffff0000, v99
    v_lshlrev_b32 v48, 16, v100
    v_and_b32 v49, 0xffff0000, v100
    v_lshlrev_b32 v50, 16, v101
    v_and_b32 v51, 0xffff0000, v101
    v_lshlrev_b32 v56, 16, v102
    v_and_b32 v57, 0xffff0000, v102
    v_lshlrev_b32 v58, 16, v103
    v_and_b32 v59, 0xffff0000, v103
    v_lshlrev_b32 v36, 16, v104
    v_and_b32 v37, 0xffff0000, v104
    v_lshlrev_b32 v38, 16, v105
    v_and_b32 v39, 0xffff0000, v105
    v_lshlrev_b32 v44, 16, v106
    v_and_b32 v45, 0xffff0000, v106
    v_lshlrev_b32 v46, 16, v107
    v_and_b32 v47, 0xffff0000, v107
    v_lshlrev_b32 v52, 16, v108
    v_and_b32 v53, 0xffff0000, v108
    v_lshlrev_b32 v54, 16, v109
    v_and_b32 v55, 0xffff0000, v109
    v_lshlrev_b32 v60, 16, v110
    v_and_b32 v61, 0xffff0000, v110
    v_lshlrev_b32 v62, 16, v111
    v_and_b32 v63, 0xffff0000, v111
    s_waitcnt vmcnt(0)
    s_barrier
    s_cmp_eq_u32 s20, 1
    s_cbranch_scc0 Lh0_6
    s_lshl_b32 s16, s21, 3
    s_lshl_b32 s16, s16, 8
    s_add_u32 s16, s16, 42074112
    v_lshlrev_b32 v28, 8, v1
    v_mov_b32 v31, 0x10000000
    v_cmp_gt_u32 vcc, 8, v1
    s_nop 1
    v_cndmask_b32 v28, v31, v28, vcc
    v_mov_b32 v31, 1
    buffer_atomic_add v31, v28, s[4:7], s16 offen sc1
Lh0_6:
    s_cmp_eq_u32 s20, 0
    s_cbranch_scc0 Lh1_7
    s_lshl_b32 s16, s72, 3
    s_and_b32 s17, s73, 7
    s_add_u32 s16, s16, s17
    s_lshl_b32 s16, s16, 8
    s_add_u32 s16, s16, 42074112
    s_mov_b32 s74, s16
    buffer_load_dword v31, v30, s[4:7], s74 offen sc1
Lh1_7:
    v_mov_b32 v128, 0
    v_mov_b32 v129, 0
    v_mov_b32 v130, 0
    v_mov_b32 v131, 0
    v_mov_b32 v132, 0
    v_mov_b32 v133, 0
    v_mov_b32 v134, 0
    v_mov_b32 v135, 0
    v_mov_b32 v136, 0
    v_mov_b32 v137, 0
    v_mov_b32 v138, 0
    v_mov_b32 v139, 0
    v_mov_b32 v140, 0
    v_mov_b32 v141, 0
    v_mov_b32 v142, 0
    v_mov_b32 v143, 0
    v_mov_b32 v146, 0
    v_mov_b32 v147, 0
    v_mov_b32 v148, 0
    v_mov_b32 v149, 0
    v_mov_b32 v150, 0
    v_mov_b32 v151, 0
    v_mov_b32 v152, 0
    v_mov_b32 v153, 0
    v_mov_b32 v154, 0
    v_mov_b32 v155, 0
    v_mov_b32 v156, 0
    v_mov_b32 v157, 0
    v_mov_b32 v158, 0
    v_mov_b32 v159, 0
    v_mov_b32 v160, 0
    v_mov_b32 v161, 0
    v_mov_b32 v162, 0
    v_mov_b32 v163, 0
    v_mov_b32 v164, 0
    v_mov_b32 v165, 0
    v_mov_b32 v166, 0
    v_mov_b32 v167, 0
    v_mov_b32 v168, 0
    v_mov_b32 v169, 0
    v_mov_b32 v170, 0
    v_mov_b32 v171, 0
    v_mov_b32 v172, 0
    v_mov_b32 v173, 0
    v_mov_b32 v174, 0
    v_mov_b32 v175, 0
    v_mov_b32 v176, 0
    v_mov_b32 v177, 0
    v_mov_b32 v178, 0
    v_mov_b32 v179, 0
    v_mov_b32 v180, 0
    v_mov_b32 v181, 0
    v_mov_b32 v182, 0
    v_mov_b32 v183, 0
    v_mov_b32 v184, 0
    v_mov_b32 v185, 0
    v_mov_b32 v186, 0
    v_mov_b32 v187, 0
    v_mov_b32 v188, 0
    v_mov_b32 v189, 0
    v_mov_b32 v190, 0
    v_mov_b32 v191, 0
    v_mov_b32 v192, 0
    v_mov_b32 v193, 0
    v_mov_b32 v194, 0
    v_mov_b32 v195, 0
    v_mov_b32 v196, 0
    v_mov_b32 v197, 0
    v_mov_b32 v198, 0
    v_mov_b32 v199, 0
    v_mov_b32 v200, 0
    v_mov_b32 v201, 0
    v_mov_b32 v202, 0
    v_mov_b32 v203, 0
    v_mov_b32 v204, 0
    v_mov_b32 v205, 0
    v_mov_b32 v206, 0
    v_mov_b32 v207, 0
    v_mov_b32 v208, 0
    v_mov_b32 v209, 0
    v_mov_b32 v210, 0
    v_mov_b32 v211, 0
    v_mov_b32 v212, 0
    v_mov_b32 v213, 0
    v_mov_b32 v214, 0
    v_mov_b32 v215, 0
    v_mov_b32 v216, 0
    v_mov_b32 v217, 0
    v_mov_b32 v218, 0
    v_mov_b32 v219, 0
    v_mov_b32 v220, 0
    v_mov_b32 v221, 0
    v_mov_b32 v222, 0
    v_mov_b32 v223, 0
    v_mov_b32 v224, 0
    v_mov_b32 v225, 0
    v_mov_b32 v226, 0
    v_mov_b32 v227, 0
    v_mov_b32 v228, 0
    v_mov_b32 v229, 0
    v_mov_b32 v230, 0
    v_mov_b32 v231, 0
    v_mov_b32 v232, 0
    v_mov_b32 v233, 0
    v_mov_b32 v234, 0
    v_mov_b32 v235, 0
    v_mov_b32 v236, 0
    v_mov_b32 v237, 0
    v_mov_b32 v238, 0
    v_mov_b32 v239, 0
    v_mov_b32 v240, 0
    v_mov_b32 v241, 0
    v_mov_b32 v242, 0
    v_mov_b32 v243, 0
    v_mov_b32 v244, 0
    v_mov_b32 v245, 0
    v_mov_b32 v246, 0
    v_mov_b32 v247, 0
    v_mov_b32 v248, 0
    v_mov_b32 v249, 0
    v_mov_b32 v250, 0
    v_mov_b32 v251, 0
    v_mov_b32 v252, 0
    v_mov_b32 v253, 0
    v_mov_b32 v254, 0
    v_mov_b32 v255, 0
    s_and_b32 s3, s2, 7
    s_lshl_b32 s3, s3, 2
    s_lshr_b32 s16, s2, 3
    s_and_b32 s16, s16, 3
    s_add_u32 s34, s3, s16
    s_lshr_b32 s35, s2, 5
    s_and_b32 s16, s20, 1
    s_mul_i32 s16, s16, 448
    s_movk_i32 s17, 4682
    s_movk_i32 s18, 7168
    v_add_u32 v23, s16, v1
    v_mul_lo_u32 v24, v23, s17
    v_lshrrev_b32 v24, 16, v24
    v_mul_u32_u24 v25, 14, v24
    v_sub_u32 v25, v23, v25
    v_lshlrev_b32 v25, 4, v25
    v_mul_lo_u32 v24, v24, s18
    v_add_u32 v6, v24, v25
    v_add_u32 v23, s16, v1
    v_add_u32 v23, 64, v23
    v_mul_lo_u32 v24, v23, s17
    v_lshrrev_b32 v24, 16, v24
    v_mul_u32_u24 v25, 14, v24
    v_sub_u32 v25, v23, v25
    v_lshlrev_b32 v25, 4, v25
    v_mul_lo_u32 v24, v24, s18
    v_add_u32 v7, v24, v25
    v_add_u32 v23, s16, v1
    v_add_u32 v23, 128, v23
    v_mul_lo_u32 v24, v23, s17
    v_lshrrev_b32 v24, 16, v24
    v_mul_u32_u24 v25, 14, v24
    v_sub_u32 v25, v23, v25
    v_lshlrev_b32 v25, 4, v25
    v_mul_lo_u32 v24, v24, s18
    v_add_u32 v8, v24, v25
    v_add_u32 v23, s16, v1
    v_add_u32 v23, 192, v23
    v_mul_lo_u32 v24, v23, s17
    v_lshrrev_b32 v24, 16, v24
    v_mul_u32_u24 v25, 14, v24
    v_sub_u32 v25, v23, v25
    v_lshlrev_b32 v25, 4, v25
    v_mul_lo_u32 v24, v24, s18
    v_add_u32 v9, v24, v25
    v_add_u32 v23, s16, v1
    v_add_u32 v23, 256, v23
    v_mul_lo_u32 v24, v23, s17
    v_lshrrev_b32 v24, 16, v24
    v_mul_u32_u24 v25, 14, v24
    v_sub_u32 v25, v23, v25
    v_lshlrev_b32 v25, 4, v25
    v_mul_lo_u32 v24, v24, s18
    v_add_u32 v10, v24, v25
    v_add_u32 v23, s16, v1
    v_add_u32 v23, 320, v23
    v_mul_lo_u32 v24, v23, s17
    v_lshrrev_b32 v24, 16, v24
    v_mul_u32_u24 v25, 14, v24
    v_sub_u32 v25, v23, v25
    v_lshlrev_b32 v25, 4, v25
    v_mul_lo_u32 v24, v24, s18
    v_add_u32 v11, v24, v25
    v_add_u32 v23, s16, v1
    v_add_u32 v23, 384, v23
    v_mul_lo_u32 v24, v23, s17
    v_lshrrev_b32 v24, 16, v24
    v_mul_u32_u24 v25, 14, v24
    v_sub_u32 v25, v23, v25
    v_lshlrev_b32 v25, 4, v25
    v_mul_lo_u32 v24, v24, s18
    v_add_u32 v12, v24, v25
    s_cmp_ge_u32 s20, 2
    s_cselect_b32 s8, s94, s92
    s_cselect_b32 s9, s95, s93
    s_mul_i32 s16, s34, 224
    s_add_u32 s8, s8, s16
    s_addc_u32 s9, s9, 0
    s_sub_u32 s10, 7340032, s16
    s_mov_b32 s11, 0x20000
    s_mul_i32 s26, s20, 7168
    s_mov_b32 s25, 0
    s_cmp_eq_u32 s20, 0
    s_cbranch_scc0 Lh2_8
    s_waitcnt vmcnt(0)
    v_readfirstlane_b32 s17, v31
    s_cmp_ge_u32 s17, 16
    s_cbranch_scc1 Lh2_8
    s_mov_b32 s19, 0
Lhp_9:
    s_add_u32 s19, s19, 1
    s_cmp_gt_u32 s19, 300000
    s_cbranch_scc1 Lh2_8
    buffer_load_dword v31, v30, s[4:7], s74 offen sc1
    s_waitcnt vmcnt(0)
    v_readfirstlane_b32 s17, v31
    s_cmp_ge_u32 s17, 16
    s_cbranch_scc0 Lhp_9
Lh2_8:
    s_barrier
    s_mov_b32 s24, 0
    buffer_load_dwordx4 a[0:3], v14, s[4:7], s24 offen offset:0 sc1
    buffer_load_dwordx4 a[4:7], v15, s[4:7], s24 offen offset:0 sc1
    buffer_load_dwordx4 a[8:11], v14, s[4:7], s24 offen offset:1024 sc1
    buffer_load_dwordx4 a[12:15], v15, s[4:7], s24 offen offset:1024 sc1
    buffer_load_dwordx4 a[16:19], v14, s[4:7], s24 offen offset:2048 sc1
    buffer_load_dwordx4 a[20:23], v15, s[4:7], s24 offen offset:2048 sc1
    buffer_load_dwordx4 a[24:27], v14, s[4:7], s24 offen offset:3072 sc1
    buffer_load_dwordx4 a[28:31], v15, s[4:7], s24 offen offset:3072 sc1
    s_mov_b32 s24, 4096
    buffer_load_dwordx4 a[32:35], v14, s[4:7], s24 offen offset:0 sc1
    buffer_load_dwordx4 a[36:39], v15, s[4:7], s24 offen offset:0 sc1
    buffer_load_dwordx4 a[40:43], v14, s[4:7], s24 offen offset:1024 sc1
    buffer_load_dwordx4 a[44:47], v15, s[4:7], s24 offen offset:1024 sc1
    ds_read_b64_tr_b16 a[128:129], v2 offset:0
    ds_read_b64_tr_b16 a[130:131], v2 offset:2048
    ds_read_b64_tr_b16 a[132:133], v3 offset:0
    ds_read_b64_tr_b16 a[134:135], v3 offset:2048
    ds_read_b64_tr_b16 a[136:137], v4 offset:0
    ds_read_b64_tr_b16 a[138:139], v4 offset:2048
    ds_read_b64_tr_b16 a[140:141], v5 offset:0
    ds_read_b64_tr_b16 a[142:143], v5 offset:2048
    ds_read_b128 a[192:195], v20 offset:0
    ds_read_b64_tr_b16 a[144:145], v2 offset:4096
    ds_read_b64_tr_b16 a[146:147], v2 offset:6144
    ds_read_b64_tr_b16 a[148:149], v3 offset:4096
    ds_read_b64_tr_b16 a[150:151], v3 offset:6144
    ds_read_b64_tr_b16 a[152:153], v4 offset:4096
    ds_read_b64_tr_b16 a[154:155], v4 offset:6144
    ds_read_b64_tr_b16 a[156:157], v5 offset:4096
    ds_read_b64_tr_b16 a[158:159], v5 offset:6144
    ds_read_b128 a[196:199], v20 offset:128
    s_waitcnt vmcnt(10)
    s_waitcnt lgkmcnt(9)
    v_mfma_f32_16x16x32_bf16 v[32:35], a[128:131], a[0:3], v[32:35]
    ds_read_b64_tr_b16 a[160:161], v2 offset:8192
    v_mfma_f32_16x16x32_bf16 v[36:39], a[128:131], a[4:7], v[36:39]
    ds_read_b64_tr_b16 a[162:163], v2 offset:10240
    buffer_load_dwordx4 a[48:51], v14, s[4:7], s24 offen offset:2048 sc1
    v_mfma_f32_16x16x32_bf16 v[44:47], a[132:135], a[4:7], v[44:47]
    ds_read_b64_tr_b16 a[164:165], v3 offset:8192
    v_mfma_f32_16x16x32_bf16 v[40:43], a[132:135], a[0:3], v[40:43]
    ds_read_b64_tr_b16 a[166:167], v3 offset:10240
    v_mfma_f32_16x16x32_bf16 v[48:51], a[136:139], a[0:3], v[48:51]
    ds_read_b64_tr_b16 a[168:169], v4 offset:8192
    buffer_load_dwordx4 a[52:55], v15, s[4:7], s24 offen offset:2048 sc1
    v_mfma_f32_16x16x32_bf16 v[52:55], a[136:139], a[4:7], v[52:55]
    ds_read_b64_tr_b16 a[170:171], v4 offset:10240
    v_mfma_f32_16x16x32_bf16 v[60:63], a[140:143], a[4:7], v[60:63]
    ds_read_b64_tr_b16 a[172:173], v5 offset:8192
    v_mfma_f32_16x16x32_bf16 v[56:59], a[140:143], a[0:3], v[56:59]
    ds_read_b64_tr_b16 a[174:175], v5 offset:10240
    buffer_load_dwordx4 a[56:59], v14, s[4:7], s24 offen offset:3072 sc1
    v_mfma_f32_16x16x32_bf16 v[64:67], a[192:195], a[0:3], v[64:67]
    ds_read_b128 a[200:203], v20 offset:256
    v_mfma_f32_16x16x32_bf16 v[68:71], a[192:195], a[4:7], v[68:71]
    buffer_load_dwordx4 a[60:63], v15, s[4:7], s24 offen offset:3072 sc1
    s_waitcnt vmcnt(12)
    s_waitcnt lgkmcnt(9)
    v_mfma_f32_16x16x32_bf16 v[32:35], a[144:147], a[8:11], v[32:35]
    ds_read_b64_tr_b16 a[176:177], v2 offset:12288
    v_mfma_f32_16x16x32_bf16 v[36:39], a[144:147], a[12:15], v[36:39]
    ds_read_b64_tr_b16 a[178:179], v2 offset:14336
    s_mov_b32 s24, 8192
    buffer_load_dwordx4 a[64:67], v14, s[4:7], s24 offen offset:0 sc1
    v_mfma_f32_16x16x32_bf16 v[44:47], a[148:151], a[12:15], v[44:47]
    ds_read_b64_tr_b16 a[180:181], v3 offset:12288
    v_mfma_f32_16x16x32_bf16 v[40:43], a[148:151], a[8:11], v[40:43]
    ds_read_b64_tr_b16 a[182:183], v3 offset:14336
    v_mfma_f32_16x16x32_bf16 v[48:51], a[152:155], a[8:11], v[48:51]
    ds_read_b64_tr_b16 a[184:185], v4 offset:12288
    buffer_load_dwordx4 a[68:71], v15, s[4:7], s24 offen offset:0 sc1
    v_mfma_f32_16x16x32_bf16 v[52:55], a[152:155], a[12:15], v[52:55]
    ds_read_b64_tr_b16 a[186:187], v4 offset:14336
    v_mfma_f32_16x16x32_bf16 v[60:63], a[156:159], a[12:15], v[60:63]
    ds_read_b64_tr_b16 a[188:189], v5 offset:12288
    v_mfma_f32_16x16x32_bf16 v[56:59], a[156:159], a[8:11], v[56:59]
    ds_read_b64_tr_b16 a[190:191], v5 offset:14336
    buffer_load_dwordx4 a[72:75], v14, s[4:7], s24 offen offset:1024 sc1
    v_mfma_f32_16x16x32_bf16 v[64:67], a[196:199], a[8:11], v[64:67]
    ds_read_b128 a[204:207], v20 offset:384
    v_mfma_f32_16x16x32_bf16 v[68:71], a[196:199], a[12:15], v[68:71]
    buffer_load_dwordx4 a[76:79], v15, s[4:7], s24 offen offset:1024 sc1
    s_waitcnt vmcnt(14)
    s_waitcnt lgkmcnt(9)
    v_mfma_f32_16x16x32_bf16 v[32:35], a[160:163], a[16:19], v[32:35]
    ds_read_b64_tr_b16 a[128:129], v2 offset:16384
    v_mfma_f32_16x16x32_bf16 v[36:39], a[160:163], a[20:23], v[36:39]
    ds_read_b64_tr_b16 a[130:131], v2 offset:18432
    buffer_load_dwordx4 a[80:83], v14, s[4:7], s24 offen offset:2048 sc1
    v_mfma_f32_16x16x32_bf16 v[44:47], a[164:167], a[20:23], v[44:47]
    ds_read_b64_tr_b16 a[132:133], v3 offset:16384
    v_mfma_f32_16x16x32_bf16 v[40:43], a[164:167], a[16:19], v[40:43]
    ds_read_b64_tr_b16 a[134:135], v3 offset:18432
    v_mfma_f32_16x16x32_bf16 v[48:51], a[168:171], a[16:19], v[48:51]
    ds_read_b64_tr_b16 a[136:137], v4 offset:16384
    buffer_load_dwordx4 a[84:87], v15, s[4:7], s24 offen offset:2048 sc1
    v_mfma_f32_16x16x32_bf16 v[52:55], a[168:171], a[20:23], v[52:55]
    ds_read_b64_tr_b16 a[138:139], v4 offset:18432
    v_mfma_f32_16x16x32_bf16 v[60:63], a[172:175], a[20:23], v[60:63]
    ds_read_b64_tr_b16 a[140:141], v5 offset:16384
    v_mfma_f32_16x16x32_bf16 v[56:59], a[172:175], a[16:19], v[56:59]
    ds_read_b64_tr_b16 a[142:143], v5 offset:18432
    buffer_load_dwordx4 a[88:91], v14, s[4:7], s24 offen offset:3072 sc1
    v_mfma_f32_16x16x32_bf16 v[64:67], a[200:203], a[16:19], v[64:67]
    ds_read_b128 a[192:195], v20 offset:512
    v_mfma_f32_16x16x32_bf16 v[68:71], a[200:203], a[20:23], v[68:71]
    buffer_load_dwordx4 a[92:95], v15, s[4:7], s24 offen offset:3072 sc1
    s_waitcnt vmcnt(16)
    s_waitcnt lgkmcnt(9)
    v_mfma_f32_16x16x32_bf16 v[32:35], a[176:179], a[24:27], v[32:35]
    ds_read_b64_tr_b16 a[144:145], v2 offset:20480
    v_mfma_f32_16x16x32_bf16 v[36:39], a[176:179], a[28:31], v[36:39]
    ds_read_b64_tr_b16 a[146:147], v2 offset:22528
    s_mov_b32 s24, 12288
    buffer_load_dwordx4 a[96:99], v14, s[4:7], s24 offen offset:0 sc1
    v_mfma_f32_16x16x32_bf16 v[44:47], a[180:183], a[28:31], v[44:47]
    ds_read_b64_tr_b16 a[148:149], v3 offset:20480
    v_mfma_f32_16x16x32_bf16 v[40:43], a[180:183], a[24:27], v[40:43]
    ds_read_b64_tr_b16 a[150:151], v3 offset:22528
    v_mfma_f32_16x16x32_bf16 v[48:51], a[184:187], a[24:27], v[48:51]
    ds_read_b64_tr_b16 a[152:153], v4 offset:20480
    buffer_load_dwordx4 a[100:103], v15, s[4:7], s24 offen offset:0 sc1
    v_mfma_f32_16x16x32_bf16 v[52:55], a[184:187], a[28:31], v[52:55]
    ds_read_b64_tr_b16 a[154:155], v4 offset:22528
    v_mfma_f32_16x16x32_bf16 v[60:63], a[188:191], a[28:31], v[60:63]
    ds_read_b64_tr_b16 a[156:157], v5 offset:20480
    v_mfma_f32_16x16x32_bf16 v[56:59], a[188:191], a[24:27], v[56:59]
    ds_read_b64_tr_b16 a[158:159], v5 offset:22528
    buffer_load_dwordx4 a[104:107], v14, s[4:7], s24 offen offset:1024 sc1
    v_mfma_f32_16x16x32_bf16 v[64:67], a[204:207], a[24:27], v[64:67]
    ds_read_b128 a[196:199], v20 offset:640
    v_mfma_f32_16x16x32_bf16 v[68:71], a[204:207], a[28:31], v[68:71]
    buffer_load_dwordx4 a[108:111], v15, s[4:7], s24 offen offset:1024 sc1
    s_waitcnt vmcnt(18)
    s_waitcnt lgkmcnt(9)
    v_mfma_f32_16x16x32_bf16 v[32:35], a[128:131], a[32:35], v[32:35]
    ds_read_b64_tr_b16 a[160:161], v2 offset:24576
    v_mfma_f32_16x16x32_bf16 v[36:39], a[128:131], a[36:39], v[36:39]
    ds_read_b64_tr_b16 a[162:163], v2 offset:26624
    buffer_load_dwordx4 a[112:115], v14, s[4:7], s24 offen offset:2048 sc1
    v_mfma_f32_16x16x32_bf16 v[44:47], a[132:135], a[36:39], v[44:47]
    ds_read_b64_tr_b16 a[164:165], v3 offset:24576
    v_mfma_f32_16x16x32_bf16 v[40:43], a[132:135], a[32:35], v[40:43]
    ds_read_b64_tr_b16 a[166:167], v3 offset:26624
    v_mfma_f32_16x16x32_bf16 v[48:51], a[136:139], a[32:35], v[48:51]
    ds_read_b64_tr_b16 a[168:169], v4 offset:24576
    buffer_load_dwordx4 a[116:119], v15, s[4:7], s24 offen offset:2048 sc1
    v_mfma_f32_16x16x32_bf16 v[52:55], a[136:139], a[36:39], v[52:55]
    ds_read_b64_tr_b16 a[170:171], v4 offset:26624
    v_mfma_f32_16x16x32_bf16 v[60:63], a[140:143], a[36:39], v[60:63]
    ds_read_b64_tr_b16 a[172:173], v5 offset:24576
    v_mfma_f32_16x16x32_bf16 v[56:59], a[140:143], a[32:35], v[56:59]
    ds_read_b64_tr_b16 a[174:175], v5 offset:26624
    buffer_load_dwordx4 a[120:123], v14, s[4:7], s24 offen offset:3072 sc1
    v_mfma_f32_16x16x32_bf16 v[64:67], a[192:195], a[32:35], v[64:67]
    ds_read_b128 a[200:203], v20 offset:768
    v_mfma_f32_16x16x32_bf16 v[68:71], a[192:195], a[36:39], v[68:71]
    buffer_load_dwordx4 a[124:127], v15, s[4:7], s24 offen offset:3072 sc1
    s_waitcnt vmcnt(20)
    s_waitcnt lgkmcnt(9)
    v_mfma_f32_16x16x32_bf16 v[32:35], a[144:147], a[40:43], v[32:35]
    ds_read_b64_tr_b16 a[176:177], v2 offset:28672
    v_mfma_f32_16x16x32_bf16 v[36:39], a[144:147], a[44:47], v[36:39]
    ds_read_b64_tr_b16 a[178:179], v2 offset:30720
    s_mov_b32 s24, 16384
    buffer_load_dwordx4 a[0:3], v14, s[4:7], s24 offen offset:0 sc1
    v_mfma_f32_16x16x32_bf16 v[44:47], a[148:151], a[44:47], v[44:47]
    ds_read_b64_tr_b16 a[180:181], v3 offset:28672
    v_mfma_f32_16x16x32_bf16 v[40:43], a[148:151], a[40:43], v[40:43]
    ds_read_b64_tr_b16 a[182:183], v3 offset:30720
    v_mfma_f32_16x16x32_bf16 v[48:51], a[152:155], a[40:43], v[48:51]
    ds_read_b64_tr_b16 a[184:185], v4 offset:28672
    buffer_load_dwordx4 a[4:7], v15, s[4:7], s24 offen offset:0 sc1
    v_mfma_f32_16x16x32_bf16 v[52:55], a[152:155], a[44:47], v[52:55]
    ds_read_b64_tr_b16 a[186:187], v4 offset:30720
    v_mfma_f32_16x16x32_bf16 v[60:63], a[156:159], a[44:47], v[60:63]
    ds_read_b64_tr_b16 a[188:189], v5 offset:28672
    v_mfma_f32_16x16x32_bf16 v[56:59], a[156:159], a[40:43], v[56:59]
    ds_read_b64_tr_b16 a[190:191], v5 offset:30720
    buffer_load_dwordx4 a[8:11], v14, s[4:7], s24 offen offset:1024 sc1
    v_mfma_f32_16x16x32_bf16 v[64:67], a[196:199], a[40:43], v[64:67]
    ds_read_b128 a[204:207], v20 offset:896
    v_mfma_f32_16x16x32_bf16 v[68:71], a[196:199], a[44:47], v[68:71]
    buffer_load_dwordx4 a[12:15], v15, s[4:7], s24 offen offset:1024 sc1
    s_waitcnt vmcnt(22)
    s_waitcnt lgkmcnt(9)
    v_mfma_f32_16x16x32_bf16 v[32:35], a[160:163], a[48:51], v[32:35]
    ds_read_b64_tr_b16 a[128:129], v2 offset:32768
    v_mfma_f32_16x16x32_bf16 v[36:39], a[160:163], a[52:55], v[36:39]
    ds_read_b64_tr_b16 a[130:131], v2 offset:34816
    buffer_load_dwordx4 a[16:19], v14, s[4:7], s24 offen offset:2048 sc1
    v_mfma_f32_16x16x32_bf16 v[44:47], a[164:167], a[52:55], v[44:47]
    ds_read_b64_tr_b16 a[132:133], v3 offset:32768
    v_mfma_f32_16x16x32_bf16 v[40:43], a[164:167], a[48:51], v[40:43]
    ds_read_b64_tr_b16 a[134:135], v3 offset:34816
    v_mfma_f32_16x16x32_bf16 v[48:51], a[168:171], a[48:51], v[48:51]
    ds_read_b64_tr_b16 a[136:137], v4 offset:32768
    buffer_load_dwordx4 a[20:23], v15, s[4:7], s24 offen offset:2048 sc1
    v_mfma_f32_16x16x32_bf16 v[52:55], a[168:171], a[52:55], v[52:55]
    ds_read_b64_tr_b16 a[138:139], v4 offset:34816
    v_mfma_f32_16x16x32_bf16 v[60:63], a[172:175], a[52:55], v[60:63]
    ds_read_b64_tr_b16 a[140:141], v5 offset:32768
    v_mfma_f32_16x16x32_bf16 v[56:59], a[172:175], a[48:51], v[56:59]
    ds_read_b64_tr_b16 a[142:143], v5 offset:34816
    v_mfma_f32_16x16x32_bf16 v[64:67], a[200:203], a[48:51], v[64:67]
    ds_read_b128 a[192:195], v20 offset:1024
    v_mfma_f32_16x16x32_bf16 v[68:71], a[200:203], a[52:55], v[68:71]
    s_waitcnt vmcnt(22)
    s_waitcnt lgkmcnt(9)
    v_mfma_f32_16x16x32_bf16 v[32:35], a[176:179], a[56:59], v[32:35]
    ds_read_b64_tr_b16 a[144:145], v2 offset:36864
    v_mfma_f32_16x16x32_bf16 v[36:39], a[176:179], a[60:63], v[36:39]
    ds_read_b64_tr_b16 a[146:147], v2 offset:38912
    buffer_load_dwordx4 a[24:27], v14, s[4:7], s24 offen offset:3072 sc1
    v_mfma_f32_16x16x32_bf16 v[44:47], a[180:183], a[60:63], v[44:47]
    ds_read_b64_tr_b16 a[148:149], v3 offset:36864
    v_mfma_f32_16x16x32_bf16 v[40:43], a[180:183], a[56:59], v[40:43]
    ds_read_b64_tr_b16 a[150:151], v3 offset:38912
    v_mfma_f32_16x16x32_bf16 v[48:51], a[184:187], a[56:59], v[48:51]
    ds_read_b64_tr_b16 a[152:153], v4 offset:36864
    buffer_load_dwordx4 a[28:31], v15, s[4:7], s24 offen offset:3072 sc1
    v_mfma_f32_16x16x32_bf16 v[52:55], a[184:187], a[60:63], v[52:55]
    ds_read_b64_tr_b16 a[154:155], v4 offset:38912
    v_mfma_f32_16x16x32_bf16 v[60:63], a[188:191], a[60:63], v[60:63]
    ds_read_b64_tr_b16 a[156:157], v5 offset:36864
    v_mfma_f32_16x16x32_bf16 v[56:59], a[188:191], a[56:59], v[56:59]
    ds_read_b64_tr_b16 a[158:159], v5 offset:38912
    v_mfma_f32_16x16x32_bf16 v[64:67], a[204:207], a[56:59], v[64:67]
    ds_read_b128 a[196:199], v20 offset:1152
    v_mfma_f32_16x16x32_bf16 v[68:71], a[204:207], a[60:63], v[68:71]
    s_waitcnt vmcnt(22)
    s_waitcnt lgkmcnt(9)
    v_mfma_f32_16x16x32_bf16 v[32:35], a[128:131], a[64:67], v[32:35]
    ds_read_b64_tr_b16 a[160:161], v2 offset:40960
    v_mfma_f32_16x16x32_bf16 v[36:39], a[128:131], a[68:71], v[36:39]
    ds_read_b64_tr_b16 a[162:163], v2 offset:43008
    s_mov_b32 s24, 20480
    buffer_load_dwordx4 a[32:35], v14, s[4:7], s24 offen offset:0 sc1
    v_mfma_f32_16x16x32_bf16 v[44:47], a[132:135], a[68:71], v[44:47]
    ds_read_b64_tr_b16 a[164:165], v3 offset:40960
    v_mfma_f32_16x16x32_bf16 v[40:43], a[132:135], a[64:67], v[40:43]
    ds_read_b64_tr_b16 a[166:167], v3 offset:43008
    v_mfma_f32_16x16x32_bf16 v[48:51], a[136:139], a[64:67], v[48:51]
    ds_read_b64_tr_b16 a[168:169], v4 offset:40960
    buffer_load_dwordx4 a[36:39], v15, s[4:7], s24 offen offset:0 sc1
    v_mfma_f32_16x16x32_bf16 v[52:55], a[136:139], a[68:71], v[52:55]
    ds_read_b64_tr_b16 a[170:171], v4 offset:43008
    v_mfma_f32_16x16x32_bf16 v[60:63], a[140:143], a[68:71], v[60:63]
    ds_read_b64_tr_b16 a[172:173], v5 offset:40960
    v_mfma_f32_16x16x32_bf16 v[56:59], a[140:143], a[64:67], v[56:59]
    ds_read_b64_tr_b16 a[174:175], v5 offset:43008
    v_mfma_f32_16x16x32_bf16 v[64:67], a[192:195], a[64:67], v[64:67]
    ds_read_b128 a[200:203], v20 offset:1280
    v_mfma_f32_16x16x32_bf16 v[68:71], a[192:195], a[68:71], v[68:71]
    s_waitcnt vmcnt(22)
    s_waitcnt lgkmcnt(9)
    v_mfma_f32_16x16x32_bf16 v[32:35], a[144:147], a[72:75], v[32:35]
    ds_read_b64_tr_b16 a[176:177], v2 offset:45056
    v_mfma_f32_16x16x32_bf16 v[36:39], a[144:147], a[76:79], v[36:39]
    ds_read_b64_tr_b16 a[178:179], v2 offset:47104
    buffer_load_dwordx4 a[40:43], v14, s[4:7], s24 offen offset:1024 sc1
    v_mfma_f32_16x16x32_bf16 v[44:47], a[148:151], a[76:79], v[44:47]
    ds_read_b64_tr_b16 a[180:181], v3 offset:45056
    v_mfma_f32_16x16x32_bf16 v[40:43], a[148:151], a[72:75], v[40:43]
    ds_read_b64_tr_b16 a[182:183], v3 offset:47104
    v_mfma_f32_16x16x32_bf16 v[48:51], a[152:155], a[72:75], v[48:51]
    ds_read_b64_tr_b16 a[184:185], v4 offset:45056
    buffer_load_dwordx4 a[44:47], v15, s[4:7], s24 offen offset:1024 sc1
    v_mfma_f32_16x16x32_bf16 v[52:55], a[152:155], a[76:79], v[52:55]
    ds_read_b64_tr_b16 a[186:187], v4 offset:47104
    v_mfma_f32_16x16x32_bf16 v[60:63], a[156:159], a[76:79], v[60:63]
    ds_read_b64_tr_b16 a[188:189], v5 offset:45056
    v_mfma_f32_16x16x32_bf16 v[56:59], a[156:159], a[72:75], v[56:59]
    ds_read_b64_tr_b16 a[190:191], v5 offset:47104
    v_mfma_f32_16x16x32_bf16 v[64:67], a[196:199], a[72:75], v[64:67]
    ds_read_b128 a[204:207], v20 offset:1408
    v_mfma_f32_16x16x32_bf16 v[68:71], a[196:199], a[76:79], v[68:71]
    s_waitcnt vmcnt(22)
    s_waitcnt lgkmcnt(9)
    v_mfma_f32_16x16x32_bf16 v[32:35], a[160:163], a[80:83], v[32:35]
    ds_read_b64_tr_b16 a[128:129], v2 offset:49152
    v_mfma_f32_16x16x32_bf16 v[36:39], a[160:163], a[84:87], v[36:39]
    ds_read_b64_tr_b16 a[130:131], v2 offset:51200
    buffer_load_dwordx4 a[48:51], v14, s[4:7], s24 offen offset:2048 sc1
    v_mfma_f32_16x16x32_bf16 v[44:47], a[164:167], a[84:87], v[44:47]
    ds_read_b64_tr_b16 a[132:133], v3 offset:49152
    v_mfma_f32_16x16x32_bf16 v[40:43], a[164:167], a[80:83], v[40:43]
    ds_read_b64_tr_b16 a[134:135], v3 offset:51200
    v_mfma_f32_16x16x32_bf16 v[48:51], a[168:171], a[80:83], v[48:51]
    ds_read_b64_tr_b16 a[136:137], v4 offset:49152
    buffer_load_dwordx4 a[52:55], v15, s[4:7], s24 offen offset:2048 sc1
    v_mfma_f32_16x16x32_bf16 v[52:55], a[168:171], a[84:87], v[52:55]
    ds_read_b64_tr_b16 a[138:139], v4 offset:51200
    v_mfma_f32_16x16x32_bf16 v[60:63], a[172:175], a[84:87], v[60:63]
    ds_read_b64_tr_b16 a[140:141], v5 offset:49152
    v_mfma_f32_16x16x32_bf16 v[56:59], a[172:175], a[80:83], v[56:59]
    ds_read_b64_tr_b16 a[142:143], v5 offset:51200
    v_mfma_f32_16x16x32_bf16 v[64:67], a[200:203], a[80:83], v[64:67]
    ds_read_b128 a[192:195], v20 offset:1536
    v_mfma_f32_16x16x32_bf16 v[68:71], a[200:203], a[84:87], v[68:71]
    s_waitcnt vmcnt(22)
    s_waitcnt lgkmcnt(9)
    v_mfma_f32_16x16x32_bf16 v[32:35], a[176:179], a[88:91], v[32:35]
    ds_read_b64_tr_b16 a[144:145], v2 offset:53248
    v_mfma_f32_16x16x32_bf16 v[36:39], a[176:179], a[92:95], v[36:39]
    ds_read_b64_tr_b16 a[146:147], v2 offset:55296
    buffer_load_dwordx4 a[56:59], v14, s[4:7], s24 offen offset:3072 sc1
    v_mfma_f32_16x16x32_bf16 v[44:47], a[180:183], a[92:95], v[44:47]
    ds_read_b64_tr_b16 a[148:149], v3 offset:53248
    v_mfma_f32_16x16x32_bf16 v[40:43], a[180:183], a[88:91], v[40:43]
    ds_read_b64_tr_b16 a[150:151], v3 offset:55296
    v_mfma_f32_16x16x32_bf16 v[48:51], a[184:187], a[88:91], v[48:51]
    ds_read_b64_tr_b16 a[152:153], v4 offset:53248
    buffer_load_dwordx4 a[60:63], v15, s[4:7], s24 offen offset:3072 sc1
    v_mfma_f32_16x16x32_bf16 v[52:55], a[184:187], a[92:95], v[52:55]
    ds_read_b64_tr_b16 a[154:155], v4 offset:55296
    v_mfma_f32_16x16x32_bf16 v[60:63], a[188:191], a[92:95], v[60:63]
    ds_read_b64_tr_b16 a[156:157], v5 offset:53248
    v_mfma_f32_16x16x32_bf16 v[56:59], a[188:191], a[88:91], v[56:59]
    ds_read_b64_tr_b16 a[158:159], v5 offset:55296
    v_mfma_f32_16x16x32_bf16 v[64:67], a[204:207], a[88:91], v[64:67]
    ds_read_b128 a[196:199], v20 offset:1664
    v_mfma_f32_16x16x32_bf16 v[68:71], a[204:207], a[92:95], v[68:71]
    s_waitcnt vmcnt(22)
    s_waitcnt lgkmcnt(9)
    v_mfma_f32_16x16x32_bf16 v[32:35], a[128:131], a[96:99], v[32:35]
    ds_read_b64_tr_b16 a[160:161], v2 offset:57344
    v_mfma_f32_16x16x32_bf16 v[36:39], a[128:131], a[100:103], v[36:39]
    ds_read_b64_tr_b16 a[162:163], v2 offset:59392
    s_mov_b32 s24, 24576
    buffer_load_dwordx4 a[64:67], v14, s[4:7], s24 offen offset:0 sc1
    v_mfma_f32_16x16x32_bf16 v[44:47], a[132:135], a[100:103], v[44:47]
    ds_read_b64_tr_b16 a[164:165], v3 offset:57344
    v_mfma_f32_16x16x32_bf16 v[40:43], a[132:135], a[96:99], v[40:43]
    ds_read_b64_tr_b16 a[166:167], v3 offset:59392
    v_mfma_f32_16x16x32_bf16 v[48:51], a[136:139], a[96:99], v[48:51]
    ds_read_b64_tr_b16 a[168:169], v4 offset:57344
    buffer_load_dwordx4 a[68:71], v15, s[4:7], s24 offen offset:0 sc1
    v_mfma_f32_16x16x32_bf16 v[52:55], a[136:139], a[100:103], v[52:55]
    ds_read_b64_tr_b16 a[170:171], v4 offset:59392
    v_mfma_f32_16x16x32_bf16 v[60:63], a[140:143], a[100:103], v[60:63]
    ds_read_b64_tr_b16 a[172:173], v5 offset:57344
    v_mfma_f32_16x16x32_bf16 v[56:59], a[140:143], a[96:99], v[56:59]
    ds_read_b64_tr_b16 a[174:175], v5 offset:59392
    v_mfma_f32_16x16x32_bf16 v[64:67], a[192:195], a[96:99], v[64:67]
    ds_read_b128 a[200:203], v20 offset:1792
    v_mfma_f32_16x16x32_bf16 v[68:71], a[192:195], a[100:103], v[68:71]
    s_waitcnt vmcnt(22)
    s_waitcnt lgkmcnt(9)
    v_mfma_f32_16x16x32_bf16 v[32:35], a[144:147], a[104:107], v[32:35]
    ds_read_b64_tr_b16 a[176:177], v2 offset:61440
    v_mfma_f32_16x16x32_bf16 v[36:39], a[144:147], a[108:111], v[36:39]
    ds_read_b64_tr_b16 a[178:179], v2 offset:63488
    buffer_load_dwordx4 a[72:75], v14, s[4:7], s24 offen offset:1024 sc1
    v_mfma_f32_16x16x32_bf16 v[44:47], a[148:151], a[108:111], v[44:47]
    ds_read_b64_tr_b16 a[180:181], v3 offset:61440
    v_mfma_f32_16x16x32_bf16 v[40:43], a[148:151], a[104:107], v[40:43]
    ds_read_b64_tr_b16 a[182:183], v3 offset:63488
    v_mfma_f32_16x16x32_bf16 v[48:51], a[152:155], a[104:107], v[48:51]
    ds_read_b64_tr_b16 a[184:185], v4 offset:61440
    buffer_load_dwordx4 a[76:79], v15, s[4:7], s24 offen offset:1024 sc1
    v_mfma_f32_16x16x32_bf16 v[52:55], a[152:155], a[108:111], v[52:55]
    ds_read_b64_tr_b16 a[186:187], v4 offset:63488
    v_mfma_f32_16x16x32_bf16 v[60:63], a[156:159], a[108:111], v[60:63]
    ds_read_b64_tr_b16 a[188:189], v5 offset:61440
    v_mfma_f32_16x16x32_bf16 v[56:59], a[156:159], a[104:107], v[56:59]
    ds_read_b64_tr_b16 a[190:191], v5 offset:63488
    v_mfma_f32_16x16x32_bf16 v[64:67], a[196:199], a[104:107], v[64:67]
    ds_read_b128 a[204:207], v20 offset:1920
    v_mfma_f32_16x16x32_bf16 v[68:71], a[196:199], a[108:111], v[68:71]
    s_waitcnt vmcnt(22)
    s_waitcnt lgkmcnt(9)
    v_mfma_f32_16x16x32_bf16 v[32:35], a[160:163], a[112:115], v[32:35]
    v_xor_b32 v2, 65536, v2
    v_xor_b32 v3, 65536, v3
    v_xor_b32 v4, 65536, v4
    v_xor_b32 v5, 65536, v5
    v_xor_b32 v20, 2048, v20
    ds_read_b64_tr_b16 a[128:129], v2 offset:0
    v_mfma_f32_16x16x32_bf16 v[36:39], a[160:163], a[116:119], v[36:39]
    ds_read_b64_tr_b16 a[130:131], v2 offset:2048
    buffer_load_dwordx4 a[80:83], v14, s[4:7], s24 offen offset:2048 sc1
    v_mfma_f32_16x16x32_bf16 v[44:47], a[164:167], a[116:119], v[44:47]
    ds_read_b64_tr_b16 a[132:133], v3 offset:0
    v_mfma_f32_16x16x32_bf16 v[40:43], a[164:167], a[112:115], v[40:43]
    ds_read_b64_tr_b16 a[134:135], v3 offset:2048
    v_mfma_f32_16x16x32_bf16 v[48:51], a[168:171], a[112:115], v[48:51]
    ds_read_b64_tr_b16 a[136:137], v4 offset:0
    buffer_load_dwordx4 a[84:87], v15, s[4:7], s24 offen offset:2048 sc1
    v_mfma_f32_16x16x32_bf16 v[52:55], a[168:171], a[116:119], v[52:55]
    ds_read_b64_tr_b16 a[138:139], v4 offset:2048
    v_mfma_f32_16x16x32_bf16 v[60:63], a[172:175], a[116:119], v[60:63]
    ds_read_b64_tr_b16 a[140:141], v5 offset:0
    v_mfma_f32_16x16x32_bf16 v[56:59], a[172:175], a[112:115], v[56:59]
    ds_read_b64_tr_b16 a[142:143], v5 offset:2048
    v_mfma_f32_16x16x32_bf16 v[64:67], a[200:203], a[112:115], v[64:67]
    ds_read_b128 a[192:195], v20 offset:0
    v_mfma_f32_16x16x32_bf16 v[68:71], a[200:203], a[116:119], v[68:71]
    s_waitcnt vmcnt(22)
    s_waitcnt lgkmcnt(9)
    v_mfma_f32_16x16x32_bf16 v[32:35], a[176:179], a[120:123], v[32:35]
    ds_read_b64_tr_b16 a[144:145], v2 offset:4096
    v_mfma_f32_16x16x32_bf16 v[36:39], a[176:179], a[124:127], v[36:39]
    ds_read_b64_tr_b16 a[146:147], v2 offset:6144
    buffer_load_dwordx4 a[88:91], v14, s[4:7], s24 offen offset:3072 sc1
    v_mfma_f32_16x16x32_bf16 v[44:47], a[180:183], a[124:127], v[44:47]
    ds_read_b64_tr_b16 a[148:149], v3 offset:4096
    v_mfma_f32_16x16x32_bf16 v[40:43], a[180:183], a[120:123], v[40:43]
    ds_read_b64_tr_b16 a[150:151], v3 offset:6144
    v_mfma_f32_16x16x32_bf16 v[48:51], a[184:187], a[120:123], v[48:51]
    ds_read_b64_tr_b16 a[152:153], v4 offset:4096
    buffer_load_dwordx4 a[92:95], v15, s[4:7], s24 offen offset:3072 sc1
    v_mfma_f32_16x16x32_bf16 v[52:55], a[184:187], a[124:127], v[52:55]
    ds_read_b64_tr_b16 a[154:155], v4 offset:6144
    v_mfma_f32_16x16x32_bf16 v[60:63], a[188:191], a[124:127], v[60:63]
    ds_read_b64_tr_b16 a[156:157], v5 offset:4096
    v_mfma_f32_16x16x32_bf16 v[56:59], a[188:191], a[120:123], v[56:59]
    ds_read_b64_tr_b16 a[158:159], v5 offset:6144
    v_mfma_f32_16x16x32_bf16 v[64:67], a[204:207], a[120:123], v[64:67]
    ds_read_b128 a[196:199], v20 offset:128
    v_mfma_f32_16x16x32_bf16 v[68:71], a[204:207], a[124:127], v[68:71]
    s_waitcnt vmcnt(22)
    s_waitcnt lgkmcnt(9)
    s_barrier
    v_mfma_f32_16x16x32_bf16 v[32:35], a[128:131], a[0:3], v[32:35]
    ds_read_b64_tr_b16 a[160:161], v2 offset:8192
    v_mfma_f32_16x16x32_bf16 v[36:39], a[128:131], a[4:7], v[36:39]
    ds_read_b64_tr_b16 a[162:163], v2 offset:10240
    s_mov_b32 s24, 28672
    buffer_load_dwordx4 a[96:99], v14, s[4:7], s24 offen offset:0 sc1
    v_mfma_f32_16x16x32_bf16 v[44:47], a[132:135], a[4:7], v[44:47]
    ds_read_b64_tr_b16 a[164:165], v3 offset:8192
    v_mfma_f32_16x16x32_bf16 v[40:43], a[132:135], a[0:3], v[40:43]
    ds_read_b64_tr_b16 a[166:167], v3 offset:10240
    v_mfma_f32_16x16x32_bf16 v[48:51], a[136:139], a[0:3], v[48:51]
    ds_read_b64_tr_b16 a[168:169], v4 offset:8192
    buffer_load_dwordx4 a[100:103], v15, s[4:7], s24 offen offset:0 sc1
    v_mfma_f32_16x16x32_bf16 v[52:55], a[136:139], a[4:7], v[52:55]
    ds_read_b64_tr_b16 a[170:171], v4 offset:10240
    v_mfma_f32_16x16x32_bf16 v[60:63], a[140:143], a[4:7], v[60:63]
    ds_read_b64_tr_b16 a[172:173], v5 offset:8192
    v_mfma_f32_16x16x32_bf16 v[56:59], a[140:143], a[0:3], v[56:59]
    ds_read_b64_tr_b16 a[174:175], v5 offset:10240
    v_mfma_f32_16x16x32_bf16 v[64:67], a[192:195], a[0:3], v[64:67]
    ds_read_b128 a[200:203], v20 offset:256
    v_mfma_f32_16x16x32_bf16 v[68:71], a[192:195], a[4:7], v[68:71]
    s_waitcnt vmcnt(22)
    s_waitcnt lgkmcnt(9)
    v_mfma_f32_16x16x32_bf16 v[32:35], a[144:147], a[8:11], v[32:35]
    ds_read_b64_tr_b16 a[176:177], v2 offset:12288
    v_mfma_f32_16x16x32_bf16 v[36:39], a[144:147], a[12:15], v[36:39]
    ds_read_b64_tr_b16 a[178:179], v2 offset:14336
    buffer_load_dwordx4 a[104:107], v14, s[4:7], s24 offen offset:1024 sc1
    v_mfma_f32_16x16x32_bf16 v[44:47], a[148:151], a[12:15], v[44:47]
    ds_read_b64_tr_b16 a[180:181], v3 offset:12288
    v_mfma_f32_16x16x32_bf16 v[40:43], a[148:151], a[8:11], v[40:43]
    ds_read_b64_tr_b16 a[182:183], v3 offset:14336
    v_mfma_f32_16x16x32_bf16 v[48:51], a[152:155], a[8:11], v[48:51]
    ds_read_b64_tr_b16 a[184:185], v4 offset:12288
    buffer_load_dwordx4 a[108:111], v15, s[4:7], s24 offen offset:1024 sc1
    v_mfma_f32_16x16x32_bf16 v[52:55], a[152:155], a[12:15], v[52:55]
    ds_read_b64_tr_b16 a[186:187], v4 offset:14336
    v_mfma_f32_16x16x32_bf16 v[60:63], a[156:159], a[12:15], v[60:63]
    ds_read_b64_tr_b16 a[188:189], v5 offset:12288
    v_mfma_f32_16x16x32_bf16 v[56:59], a[156:159], a[8:11], v[56:59]
    ds_read_b64_tr_b16 a[190:191], v5 offset:14336
    s_add_u32 m0, s26, 0
    s_nop 0
    buffer_load_dwordx4 v6, s[8:11], s25 offen lds
    v_mfma_f32_16x16x32_bf16 v[64:67], a[196:199], a[8:11], v[64:67]
    ds_read_b128 a[204:207], v20 offset:384
    v_mfma_f32_16x16x32_bf16 v[68:71], a[196:199], a[12:15], v[68:71]
    s_waitcnt vmcnt(23)
    s_waitcnt lgkmcnt(9)
    v_mfma_f32_16x16x32_bf16 v[32:35], a[160:163], a[16:19], v[32:35]
    ds_read_b64_tr_b16 a[128:129], v2 offset:16384
    v_mfma_f32_16x16x32_bf16 v[36:39], a[160:163], a[20:23], v[36:39]
    ds_read_b64_tr_b16 a[130:131], v2 offset:18432
    buffer_load_dwordx4 a[112:115], v14, s[4:7], s24 offen offset:2048 sc1
    v_mfma_f32_16x16x32_bf16 v[44:47], a[164:167], a[20:23], v[44:47]
    ds_read_b64_tr_b16 a[132:133], v3 offset:16384
    v_mfma_f32_16x16x32_bf16 v[40:43], a[164:167], a[16:19], v[40:43]
    ds_read_b64_tr_b16 a[134:135], v3 offset:18432
    v_mfma_f32_16x16x32_bf16 v[48:51], a[168:171], a[16:19], v[48:51]
    ds_read_b64_tr_b16 a[136:137], v4 offset:16384
    buffer_load_dwordx4 a[116:119], v15, s[4:7], s24 offen offset:2048 sc1
    v_mfma_f32_16x16x32_bf16 v[52:55], a[168:171], a[20:23], v[52:55]
    ds_read_b64_tr_b16 a[138:139], v4 offset:18432
    v_mfma_f32_16x16x32_bf16 v[60:63], a[172:175], a[20:23], v[60:63]
    ds_read_b64_tr_b16 a[140:141], v5 offset:16384
    v_mfma_f32_16x16x32_bf16 v[56:59], a[172:175], a[16:19], v[56:59]
    ds_read_b64_tr_b16 a[142:143], v5 offset:18432
    s_add_u32 m0, s26, 1024
    s_nop 0
    buffer_load_dwordx4 v7, s[8:11], s25 offen lds
    v_mfma_f32_16x16x32_bf16 v[64:67], a[200:203], a[16:19], v[64:67]
    ds_read_b128 a[192:195], v20 offset:512
    v_mfma_f32_16x16x32_bf16 v[68:71], a[200:203], a[20:23], v[68:71]
    s_waitcnt vmcnt(24)
    s_waitcnt lgkmcnt(9)
    v_mfma_f32_16x16x32_bf16 v[32:35], a[176:179], a[24:27], v[32:35]
    ds_read_b64_tr_b16 a[144:145], v2 offset:20480
    v_mfma_f32_16x16x32_bf16 v[36:39], a[176:179], a[28:31], v[36:39]
    ds_read_b64_tr_b16 a[146:147], v2 offset:22528
    buffer_load_dwordx4 a[120:123], v14, s[4:7], s24 offen offset:3072 sc1
    v_mfma_f32_16x16x32_bf16 v[44:47], a[180:183], a[28:31], v[44:47]
    ds_read_b64_tr_b16 a[148:149], v3 offset:20480
    v_mfma_f32_16x16x32_bf16 v[40:43], a[180:183], a[24:27], v[40:43]
    ds_read_b64_tr_b16 a[150:151], v3 offset:22528
    v_mfma_f32_16x16x32_bf16 v[48:51], a[184:187], a[24:27], v[48:51]
    ds_read_b64_tr_b16 a[152:153], v4 offset:20480
    buffer_load_dwordx4 a[124:127], v15, s[4:7], s24 offen offset:3072 sc1
    v_mfma_f32_16x16x32_bf16 v[52:55], a[184:187], a[28:31], v[52:55]
    ds_read_b64_tr_b16 a[154:155], v4 offset:22528
    v_mfma_f32_16x16x32_bf16 v[60:63], a[188:191], a[28:31], v[60:63]
    ds_read_b64_tr_b16 a[156:157], v5 offset:20480
    v_mfma_f32_16x16x32_bf16 v[56:59], a[188:191], a[24:27], v[56:59]
    ds_read_b64_tr_b16 a[158:159], v5 offset:22528
    s_add_u32 m0, s26, 2048
    s_nop 0
    buffer_load_dwordx4 v8, s[8:11], s25 offen lds
    v_mfma_f32_16x16x32_bf16 v[64:67], a[204:207], a[24:27], v[64:67]
    ds_read_b128 a[196:199], v20 offset:640
    v_mfma_f32_16x16x32_bf16 v[68:71], a[204:207], a[28:31], v[68:71]
    s_waitcnt vmcnt(25)
    s_waitcnt lgkmcnt(9)
    v_mfma_f32_16x16x32_bf16 v[32:35], a[128:131], a[32:35], v[32:35]
    ds_read_b64_tr_b16 a[160:161], v2 offset:24576
    v_mfma_f32_16x16x32_bf16 v[36:39], a[128:131], a[36:39], v[36:39]
    ds_read_b64_tr_b16 a[162:163], v2 offset:26624
    s_add_u32 m0, s26, 3072
    s_nop 0
    buffer_load_dwordx4 v9, s[8:11], s25 offen lds
    v_mfma_f32_16x16x32_bf16 v[44:47], a[132:135], a[36:39], v[44:47]
    ds_read_b64_tr_b16 a[164:165], v3 offset:24576
    v_mfma_f32_16x16x32_bf16 v[40:43], a[132:135], a[32:35], v[40:43]
    ds_read_b64_tr_b16 a[166:167], v3 offset:26624
    v_mfma_f32_16x16x32_bf16 v[48:51], a[136:139], a[32:35], v[48:51]
    ds_read_b64_tr_b16 a[168:169], v4 offset:24576
    v_mfma_f32_16x16x32_bf16 v[52:55], a[136:139], a[36:39], v[52:55]
    ds_read_b64_tr_b16 a[170:171], v4 offset:26624
    v_mfma_f32_16x16x32_bf16 v[60:63], a[140:143], a[36:39], v[60:63]
    ds_read_b64_tr_b16 a[172:173], v5 offset:24576
    v_mfma_f32_16x16x32_bf16 v[56:59], a[140:143], a[32:35], v[56:59]
    ds_read_b64_tr_b16 a[174:175], v5 offset:26624
    v_mfma_f32_16x16x32_bf16 v[64:67], a[192:195], a[32:35], v[64:67]
    ds_read_b128 a[200:203], v20 offset:768
    v_mfma_f32_16x16x32_bf16 v[68:71], a[192:195], a[36:39], v[68:71]
    s_waitcnt vmcnt(24)
    s_waitcnt lgkmcnt(9)
    v_mfma_f32_16x16x32_bf16 v[32:35], a[144:147], a[40:43], v[32:35]
    ds_read_b64_tr_b16 a[176:177], v2 offset:28672
    v_mfma_f32_16x16x32_bf16 v[36:39], a[144:147], a[44:47], v[36:39]
    ds_read_b64_tr_b16 a[178:179], v2 offset:30720
    s_add_u32 m0, s26, 4096
    s_nop 0
    buffer_load_dwordx4 v10, s[8:11], s25 offen lds
    v_mfma_f32_16x16x32_bf16 v[44:47], a[148:151], a[44:47], v[44:47]
    ds_read_b64_tr_b16 a[180:181], v3 offset:28672
    v_mfma_f32_16x16x32_bf16 v[40:43], a[148:151], a[40:43], v[40:43]
    ds_read_b64_tr_b16 a[182:183], v3 offset:30720
    v_mfma_f32_16x16x32_bf16 v[48:51], a[152:155], a[40:43], v[48:51]
    ds_read_b64_tr_b16 a[184:185], v4 offset:28672
    v_mfma_f32_16x16x32_bf16 v[52:55], a[152:155], a[44:47], v[52:55]
    ds_read_b64_tr_b16 a[186:187], v4 offset:30720
    v_mfma_f32_16x16x32_bf16 v[60:63], a[156:159], a[44:47], v[60:63]
    ds_read_b64_tr_b16 a[188:189], v5 offset:28672
    v_mfma_f32_16x16x32_bf16 v[56:59], a[156:159], a[40:43], v[56:59]
    ds_read_b64_tr_b16 a[190:191], v5 offset:30720
    v_mfma_f32_16x16x32_bf16 v[64:67], a[196:199], a[40:43], v[64:67]
    ds_read_b128 a[204:207], v20 offset:896
    v_mfma_f32_16x16x32_bf16 v[68:71], a[196:199], a[44:47], v[68:71]
    s_waitcnt vmcnt(23)
    s_waitcnt lgkmcnt(9)
    v_mfma_f32_16x16x32_bf16 v[32:35], a[160:163], a[48:51], v[32:35]
    ds_read_b64_tr_b16 a[128:129], v2 offset:32768
    v_mfma_f32_16x16x32_bf16 v[36:39], a[160:163], a[52:55], v[36:39]
    ds_read_b64_tr_b16 a[130:131], v2 offset:34816
    s_add_u32 m0, s26, 5120
    s_nop 0
    buffer_load_dwordx4 v11, s[8:11], s25 offen lds
    v_mfma_f32_16x16x32_bf16 v[44:47], a[164:167], a[52:55], v[44:47]
    ds_read_b64_tr_b16 a[132:133], v3 offset:32768
    v_mfma_f32_16x16x32_bf16 v[40:43], a[164:167], a[48:51], v[40:43]
    ds_read_b64_tr_b16 a[134:135], v3 offset:34816
    v_mfma_f32_16x16x32_bf16 v[48:51], a[168:171], a[48:51], v[48:51]
    ds_read_b64_tr_b16 a[136:137], v4 offset:32768
    v_mfma_f32_16x16x32_bf16 v[52:55], a[168:171], a[52:55], v[52:55]
    ds_read_b64_tr_b16 a[138:139], v4 offset:34816
    v_mfma_f32_16x16x32_bf16 v[60:63], a[172:175], a[52:55], v[60:63]
    ds_read_b64_tr_b16 a[140:141], v5 offset:32768
    v_mfma_f32_16x16x32_bf16 v[56:59], a[172:175], a[48:51], v[56:59]
    ds_read_b64_tr_b16 a[142:143], v5 offset:34816
    v_mfma_f32_16x16x32_bf16 v[64:67], a[200:203], a[48:51], v[64:67]
    ds_read_b128 a[192:195], v20 offset:1024
    v_mfma_f32_16x16x32_bf16 v[68:71], a[200:203], a[52:55], v[68:71]
    s_waitcnt vmcnt(22)
    s_waitcnt lgkmcnt(9)
    v_mfma_f32_16x16x32_bf16 v[32:35], a[176:179], a[56:59], v[32:35]
    ds_read_b64_tr_b16 a[144:145], v2 offset:36864
    v_mfma_f32_16x16x32_bf16 v[36:39], a[176:179], a[60:63], v[36:39]
    ds_read_b64_tr_b16 a[146:147], v2 offset:38912
    s_add_u32 m0, s26, 6144
    s_nop 0
    buffer_load_dwordx4 v12, s[8:11], s25 offen lds
    v_mfma_f32_16x16x32_bf16 v[44:47], a[180:183], a[60:63], v[44:47]
    ds_read_b64_tr_b16 a[148:149], v3 offset:36864
    v_mfma_f32_16x16x32_bf16 v[40:43], a[180:183], a[56:59], v[40:43]
    ds_read_b64_tr_b16 a[150:151], v3 offset:38912
    v_mfma_f32_16x16x32_bf16 v[48:51], a[184:187], a[56:59], v[48:51]
    ds_read_b64_tr_b16 a[152:153], v4 offset:36864
    v_mfma_f32_16x16x32_bf16 v[52:55], a[184:187], a[60:63], v[52:55]
    ds_read_b64_tr_b16 a[154:155], v4 offset:38912
    v_mfma_f32_16x16x32_bf16 v[60:63], a[188:191], a[60:63], v[60:63]
    ds_read_b64_tr_b16 a[156:157], v5 offset:36864
    v_mfma_f32_16x16x32_bf16 v[56:59], a[188:191], a[56:59], v[56:59]
    ds_read_b64_tr_b16 a[158:159], v5 offset:38912
    v_mfma_f32_16x16x32_bf16 v[64:67], a[204:207], a[56:59], v[64:67]
    ds_read_b128 a[196:199], v20 offset:1152
    v_mfma_f32_16x16x32_bf16 v[68:71], a[204:207], a[60:63], v[68:71]
    s_waitcnt vmcnt(21)
    s_waitcnt lgkmcnt(9)
    v_mfma_f32_16x16x32_bf16 v[32:35], a[128:131], a[64:67], v[32:35]
    ds_read_b64_tr_b16 a[160:161], v2 offset:40960
    v_mfma_f32_16x16x32_bf16 v[36:39], a[128:131], a[68:71], v[36:39]
    ds_read_b64_tr_b16 a[162:163], v2 offset:43008
    s_add_u32 s25, s25, 458752
    s_add_u32 s26, s26, 28672
    s_add_u32 m0, s26, 0
    s_nop 0
    buffer_load_dwordx4 v6, s[8:11], s25 offen lds
    v_mfma_f32_16x16x32_bf16 v[44:47], a[132:135], a[68:71], v[44:47]
    ds_read_b64_tr_b16 a[164:165], v3 offset:40960
    v_mfma_f32_16x16x32_bf16 v[40:43], a[132:135], a[64:67], v[40:43]
    ds_read_b64_tr_b16 a[166:167], v3 offset:43008
    v_mfma_f32_16x16x32_bf16 v[48:51], a[136:139], a[64:67], v[48:51]
    ds_read_b64_tr_b16 a[168:169], v4 offset:40960
    v_mfma_f32_16x16x32_bf16 v[52:55], a[136:139], a[68:71], v[52:55]
    ds_read_b64_tr_b16 a[170:171], v4 offset:43008
    v_mfma_f32_16x16x32_bf16 v[60:63], a[140:143], a[68:71], v[60:63]
    ds_read_b64_tr_b16 a[172:173], v5 offset:40960
    v_mfma_f32_16x16x32_bf16 v[56:59], a[140:143], a[64:67], v[56:59]
    ds_read_b64_tr_b16 a[174:175], v5 offset:43008
    v_mfma_f32_16x16x32_bf16 v[64:67], a[192:195], a[64:67], v[64:67]
    ds_read_b128 a[200:203], v20 offset:1280
    v_mfma_f32_16x16x32_bf16 v[68:71], a[192:195], a[68:71], v[68:71]
    s_waitcnt vmcnt(20)
    s_waitcnt lgkmcnt(9)
    v_mfma_f32_16x16x32_bf16 v[32:35], a[144:147], a[72:75], v[32:35]
    ds_read_b64_tr_b16 a[176:177], v2 offset:45056
    v_mfma_f32_16x16x32_bf16 v[36:39], a[144:147], a[76:79], v[36:39]
    ds_read_b64_tr_b16 a[178:179], v2 offset:47104
    s_add_u32 m0, s26, 1024
    s_nop 0
    buffer_load_dwordx4 v7, s[8:11], s25 offen lds
    v_mfma_f32_16x16x32_bf16 v[44:47], a[148:151], a[76:79], v[44:47]
    ds_read_b64_tr_b16 a[180:181], v3 offset:45056
    v_mfma_f32_16x16x32_bf16 v[40:43], a[148:151], a[72:75], v[40:43]
    ds_read_b64_tr_b16 a[182:183], v3 offset:47104
    v_mfma_f32_16x16x32_bf16 v[48:51], a[152:155], a[72:75], v[48:51]
    ds_read_b64_tr_b16 a[184:185], v4 offset:45056
    v_mfma_f32_16x16x32_bf16 v[52:55], a[152:155], a[76:79], v[52:55]
    ds_read_b64_tr_b16 a[186:187], v4 offset:47104
    v_mfma_f32_16x16x32_bf16 v[60:63], a[156:159], a[76:79], v[60:63]
    ds_read_b64_tr_b16 a[188:189], v5 offset:45056
    v_mfma_f32_16x16x32_bf16 v[56:59], a[156:159], a[72:75], v[56:59]
    ds_read_b64_tr_b16 a[190:191], v5 offset:47104
    v_mfma_f32_16x16x32_bf16 v[64:67], a[196:199], a[72:75], v[64:67]
    ds_read_b128 a[204:207], v20 offset:1408
    v_mfma_f32_16x16x32_bf16 v[68:71], a[196:199], a[76:79], v[68:71]
    s_waitcnt vmcnt(19)
    s_waitcnt lgkmcnt(9)
    v_mfma_f32_16x16x32_bf16 v[32:35], a[160:163], a[80:83], v[32:35]
    ds_read_b64_tr_b16 a[128:129], v2 offset:49152
    v_mfma_f32_16x16x32_bf16 v[36:39], a[160:163], a[84:87], v[36:39]
    ds_read_b64_tr_b16 a[130:131], v2 offset:51200
    s_add_u32 m0, s26, 2048
    s_nop 0
    buffer_load_dwordx4 v8, s[8:11], s25 offen lds
    v_mfma_f32_16x16x32_bf16 v[44:47], a[164:167], a[84:87], v[44:47]
    ds_read_b64_tr_b16 a[132:133], v3 offset:49152
    v_mfma_f32_16x16x32_bf16 v[40:43], a[164:167], a[80:83], v[40:43]
    ds_read_b64_tr_b16 a[134:135], v3 offset:51200
    v_mfma_f32_16x16x32_bf16 v[48:51], a[168:171], a[80:83], v[48:51]
    ds_read_b64_tr_b16 a[136:137], v4 offset:49152
    v_mfma_f32_16x16x32_bf16 v[52:55], a[168:171], a[84:87], v[52:55]
    ds_read_b64_tr_b16 a[138:139], v4 offset:51200
    v_mfma_f32_16x16x32_bf16 v[60:63], a[172:175], a[84:87], v[60:63]
    ds_read_b64_tr_b16 a[140:141], v5 offset:49152
    v_mfma_f32_16x16x32_bf16 v[56:59], a[172:175], a[80:83], v[56:59]
    ds_read_b64_tr_b16 a[142:143], v5 offset:51200
    v_mfma_f32_16x16x32_bf16 v[64:67], a[200:203], a[80:83], v[64:67]
    ds_read_b128 a[192:195], v20 offset:1536
    v_mfma_f32_16x16x32_bf16 v[68:71], a[200:203], a[84:87], v[68:71]
    s_waitcnt vmcnt(18)
    s_waitcnt lgkmcnt(9)
    v_mfma_f32_16x16x32_bf16 v[32:35], a[176:179], a[88:91], v[32:35]
    ds_read_b64_tr_b16 a[144:145], v2 offset:53248
    v_mfma_f32_16x16x32_bf16 v[36:39], a[176:179], a[92:95], v[36:39]
    ds_read_b64_tr_b16 a[146:147], v2 offset:55296
    s_add_u32 m0, s26, 3072
    s_nop 0
    buffer_load_dwordx4 v9, s[8:11], s25 offen lds
    v_mfma_f32_16x16x32_bf16 v[44:47], a[180:183], a[92:95], v[44:47]
    ds_read_b64_tr_b16 a[148:149], v3 offset:53248
    v_mfma_f32_16x16x32_bf16 v[40:43], a[180:183], a[88:91], v[40:43]
    ds_read_b64_tr_b16 a[150:151], v3 offset:55296
    v_mfma_f32_16x16x32_bf16 v[48:51], a[184:187], a[88:91], v[48:51]
    ds_read_b64_tr_b16 a[152:153], v4 offset:53248
    v_mfma_f32_16x16x32_bf16 v[52:55], a[184:187], a[92:95], v[52:55]
    ds_read_b64_tr_b16 a[154:155], v4 offset:55296
    v_mfma_f32_16x16x32_bf16 v[60:63], a[188:191], a[92:95], v[60:63]
    ds_read_b64_tr_b16 a[156:157], v5 offset:53248
    v_mfma_f32_16x16x32_bf16 v[56:59], a[188:191], a[88:91], v[56:59]
    ds_read_b64_tr_b16 a[158:159], v5 offset:55296
    v_mfma_f32_16x16x32_bf16 v[64:67], a[204:207], a[88:91], v[64:67]
    ds_read_b128 a[196:199], v20 offset:1664
    v_mfma_f32_16x16x32_bf16 v[68:71], a[204:207], a[92:95], v[68:71]
    s_waitcnt vmcnt(17)
    s_waitcnt lgkmcnt(9)
    v_mfma_f32_16x16x32_bf16 v[32:35], a[128:131], a[96:99], v[32:35]
    ds_read_b64_tr_b16 a[160:161], v2 offset:57344
    v_mfma_f32_16x16x32_bf16 v[36:39], a[128:131], a[100:103], v[36:39]
    ds_read_b64_tr_b16 a[162:163], v2 offset:59392
    s_add_u32 m0, s26, 4096
    s_nop 0
    buffer_load_dwordx4 v10, s[8:11], s25 offen lds
    v_mfma_f32_16x16x32_bf16 v[44:47], a[132:135], a[100:103], v[44:47]
    ds_read_b64_tr_b16 a[164:165], v3 offset:57344
    v_mfma_f32_16x16x32_bf16 v[40:43], a[132:135], a[96:99], v[40:43]
    ds_read_b64_tr_b16 a[166:167], v3 offset:59392
    v_mfma_f32_16x16x32_bf16 v[48:51], a[136:139], a[96:99], v[48:51]
    ds_read_b64_tr_b16 a[168:169], v4 offset:57344
    v_mfma_f32_16x16x32_bf16 v[52:55], a[136:139], a[100:103], v[52:55]
    ds_read_b64_tr_b16 a[170:171], v4 offset:59392
    v_mfma_f32_16x16x32_bf16 v[60:63], a[140:143], a[100:103], v[60:63]
    ds_read_b64_tr_b16 a[172:173], v5 offset:57344
    v_mfma_f32_16x16x32_bf16 v[56:59], a[140:143], a[96:99], v[56:59]
    ds_read_b64_tr_b16 a[174:175], v5 offset:59392
    v_mfma_f32_16x16x32_bf16 v[64:67], a[192:195], a[96:99], v[64:67]
    ds_read_b128 a[200:203], v20 offset:1792
    v_mfma_f32_16x16x32_bf16 v[68:71], a[192:195], a[100:103], v[68:71]
    s_waitcnt vmcnt(16)
    s_waitcnt lgkmcnt(9)
    v_mfma_f32_16x16x32_bf16 v[32:35], a[144:147], a[104:107], v[32:35]
    ds_read_b64_tr_b16 a[176:177], v2 offset:61440
    v_mfma_f32_16x16x32_bf16 v[36:39], a[144:147], a[108:111], v[36:39]
    ds_read_b64_tr_b16 a[178:179], v2 offset:63488
    s_add_u32 m0, s26, 5120
    s_nop 0
    buffer_load_dwordx4 v11, s[8:11], s25 offen lds
    v_mfma_f32_16x16x32_bf16 v[44:47], a[148:151], a[108:111], v[44:47]
    ds_read_b64_tr_b16 a[180:181], v3 offset:61440
    v_mfma_f32_16x16x32_bf16 v[40:43], a[148:151], a[104:107], v[40:43]
    ds_read_b64_tr_b16 a[182:183], v3 offset:63488
    v_mfma_f32_16x16x32_bf16 v[48:51], a[152:155], a[104:107], v[48:51]
    ds_read_b64_tr_b16 a[184:185], v4 offset:61440
    v_mfma_f32_16x16x32_bf16 v[52:55], a[152:155], a[108:111], v[52:55]
    ds_read_b64_tr_b16 a[186:187], v4 offset:63488
    v_mfma_f32_16x16x32_bf16 v[60:63], a[156:159], a[108:111], v[60:63]
    ds_read_b64_tr_b16 a[188:189], v5 offset:61440
    v_mfma_f32_16x16x32_bf16 v[56:59], a[156:159], a[104:107], v[56:59]
    ds_read_b64_tr_b16 a[190:191], v5 offset:63488
    v_mfma_f32_16x16x32_bf16 v[64:67], a[196:199], a[104:107], v[64:67]
    ds_read_b128 a[204:207], v20 offset:1920
    v_mfma_f32_16x16x32_bf16 v[68:71], a[196:199], a[108:111], v[68:71]
    s_waitcnt vmcnt(14)
    s_waitcnt lgkmcnt(9)
    v_mfma_f32_16x16x32_bf16 v[32:35], a[160:163], a[112:115], v[32:35]
    v_mfma_f32_16x16x32_bf16 v[36:39], a[160:163], a[116:119], v[36:39]
    s_add_u32 m0, s26, 6144
    s_nop 0
    buffer_load_dwordx4 v12, s[8:11], s25 offen lds
    v_mfma_f32_16x16x32_bf16 v[44:47], a[164:167], a[116:119], v[44:47]
    v_mfma_f32_16x16x32_bf16 v[40:43], a[164:167], a[112:115], v[40:43]
    v_mfma_f32_16x16x32_bf16 v[48:51], a[168:171], a[112:115], v[48:51]
    v_mfma_f32_16x16x32_bf16 v[52:55], a[168:171], a[116:119], v[52:55]
    v_mfma_f32_16x16x32_bf16 v[60:63], a[172:175], a[116:119], v[60:63]
    v_mfma_f32_16x16x32_bf16 v[56:59], a[172:175], a[112:115], v[56:59]
    v_mfma_f32_16x16x32_bf16 v[64:67], a[200:203], a[112:115], v[64:67]
    v_mfma_f32_16x16x32_bf16 v[68:71], a[200:203], a[116:119], v[68:71]
    s_waitcnt vmcnt(12)
    s_waitcnt lgkmcnt(0)
    v_mfma_f32_16x16x32_bf16 v[32:35], a[176:179], a[120:123], v[32:35]
    v_mfma_f32_16x16x32_bf16 v[36:39], a[176:179], a[124:127], v[36:39]
    v_mfma_f32_16x16x32_bf16 v[44:47], a[180:183], a[124:127], v[44:47]
    v_mfma_f32_16x16x32_bf16 v[40:43], a[180:183], a[120:123], v[40:43]
    v_mfma_f32_16x16x32_bf16 v[48:51], a[184:187], a[120:123], v[48:51]
    v_mfma_f32_16x16x32_bf16 v[52:55], a[184:187], a[124:127], v[52:55]
    v_mfma_f32_16x16x32_bf16 v[60:63], a[188:191], a[124:127], v[60:63]
    v_mfma_f32_16x16x32_bf16 v[56:59], a[188:191], a[120:123], v[56:59]
    v_mfma_f32_16x16x32_bf16 v[64:67], a[204:207], a[120:123], v[64:67]
    v_mfma_f32_16x16x32_bf16 v[68:71], a[204:207], a[124:127], v[68:71]
    s_nop 7
    v_add_f32 v64, v64, v65
    v_add_f32 v64, v64, v144
    v_add_f32 v68, v68, v69
    v_add_f32 v68, v68, v145
    s_lshl_b32 s16, s72, 2
    s_add_u32 s16, s16, s20
    s_lshl_b32 s16, s16, 16
    s_lshl_b32 s17, s73, 11
    s_add_u32 s16, s16, s17
    s_add_u32 s16, s16, 16777216
    v_lshlrev_b32 v23, 4, v1
    v_add_u32 v23, s16, v23
    v_add_u32 v24, 32768, v23
    v_pk_add_f32 v[32:33], v[32:33], v[64:65] op_sel:[0,0] op_sel_hi:[1,0] neg_lo:[0,1] neg_hi:[0,1]
    v_pk_add_f32 v[34:35], v[34:35], v[64:65] op_sel:[0,0] op_sel_hi:[1,0] neg_lo:[0,1] neg_hi:[0,1]
    v_cvt_pk_bf16_f32 v96, v32, v33
    v_cvt_pk_bf16_f32 v97, v34, v35
    v_pk_add_f32 v[40:41], v[40:41], v[64:65] op_sel:[0,0] op_sel_hi:[1,0] neg_lo:[0,1] neg_hi:[0,1]
    v_pk_add_f32 v[42:43], v[42:43], v[64:65] op_sel:[0,0] op_sel_hi:[1,0] neg_lo:[0,1] neg_hi:[0,1]
    v_cvt_pk_bf16_f32 v98, v40, v41
    v_cvt_pk_bf16_f32 v99, v42, v43
    buffer_store_dwordx4 v[96:99], v23, s[4:7], 0 offen offset:0 sc1
    v_pk_add_f32 v[48:49], v[48:49], v[64:65] op_sel:[0,0] op_sel_hi:[1,0] neg_lo:[0,1] neg_hi:[0,1]
    v_pk_add_f32 v[50:51], v[50:51], v[64:65] op_sel:[0,0] op_sel_hi:[1,0] neg_lo:[0,1] neg_hi:[0,1]
    v_cvt_pk_bf16_f32 v100, v48, v49
    v_cvt_pk_bf16_f32 v101, v50, v51
    v_pk_add_f32 v[56:57], v[56:57], v[64:65] op_sel:[0,0] op_sel_hi:[1,0] neg_lo:[0,1] neg_hi:[0,1]
    v_pk_add_f32 v[58:59], v[58:59], v[64:65] op_sel:[0,0] op_sel_hi:[1,0] neg_lo:[0,1] neg_hi:[0,1]
    v_cvt_pk_bf16_f32 v102, v56, v57
    v_cvt_pk_bf16_f32 v103, v58, v59
    buffer_store_dwordx4 v[100:103], v23, s[4:7], 0 offen offset:1024 sc1
    v_pk_add_f32 v[36:37], v[36:37], v[68:69] op_sel:[0,0] op_sel_hi:[1,0] neg_lo:[0,1] neg_hi:[0,1]
    v_pk_add_f32 v[38:39], v[38:39], v[68:69] op_sel:[0,0] op_sel_hi:[1,0] neg_lo:[0,1] neg_hi:[0,1]
    v_cvt_pk_bf16_f32 v104, v36, v37
    v_cvt_pk_bf16_f32 v105, v38, v39
    v_pk_add_f32 v[44:45], v[44:45], v[68:69] op_sel:[0,0] op_sel_hi:[1,0] neg_lo:[0,1] neg_hi:[0,1]
    v_pk_add_f32 v[46:47], v[46:47], v[68:69] op_sel:[0,0] op_sel_hi:[1,0] neg_lo:[0,1] neg_hi:[0,1]
    v_cvt_pk_bf16_f32 v106, v44, v45
    v_cvt_pk_bf16_f32 v107, v46, v47
    buffer_store_dwordx4 v[104:107], v24, s[4:7], 0 offen offset:0 sc1
    v_pk_add_f32 v[52:53], v[52:53], v[68:69] op_sel:[0,0] op_sel_hi:[1,0] neg_lo:[0,1] neg_hi:[0,1]
    v_pk_add_f32 v[54:55], v[54:55], v[68:69] op_sel:[0,0] op_sel_hi:[1,0] neg_lo:[0,1] neg_hi:[0,1]
    v_cvt_pk_bf16_f32 v108, v52, v53
    v_cvt_pk_bf16_f32 v109, v54, v55
    v_pk_add_f32 v[60:61], v[60:61], v[68:69] op_sel:[0,0] op_sel_hi:[1,0] neg_lo:[0,1] neg_hi:[0,1]
    v_pk_add_f32 v[62:63], v[62:63], v[68:69] op_sel:[0,0] op_sel_hi:[1,0] neg_lo:[0,1] neg_hi:[0,1]
    v_cvt_pk_bf16_f32 v110, v60, v61
    v_cvt_pk_bf16_f32 v111, v62, v63
    buffer_store_dwordx4 v[108:111], v24, s[4:7], 0 offen offset:1024 sc1
    s_lshl_b32 s16, s72, 9
    s_lshl_b32 s17, s20, 7
    s_add_u32 s16, s16, s17
    s_add_u32 s16, s16, 40173568
    s_cmp_eq_u32 s73, 0
    s_cselect_b32 s16, s16, 0x10000000
    v_lshrrev_b32 v26, 4, v1
    v_cmp_eq_u32 vcc, 1, v26
    v_lshlrev_b32 v25, 2, v1
    s_nop 0
    v_cndmask_b32 v27, v64, v68, vcc
    v_cmp_gt_u32 vcc, 32, v1
    v_mov_b32 v28, 0x10000000
    s_nop 0
    v_cndmask_b32 v25, v28, v25, vcc
    buffer_store_dword v27, v25, s[4:7], s16 offen sc1
    v_pk_add_f32 v[112:113], v[32:33], v[34:35]
    v_pk_mul_f32 v[114:115], v[32:33], v[32:33]
    v_pk_fma_f32 v[114:115], v[34:35], v[34:35], v[114:115]
    v_pk_add_f32 v[112:113], v[112:113], v[40:41]
    v_pk_fma_f32 v[114:115], v[40:41], v[40:41], v[114:115]
    v_pk_add_f32 v[112:113], v[112:113], v[42:43]
    v_pk_fma_f32 v[114:115], v[42:43], v[42:43], v[114:115]
    v_pk_add_f32 v[112:113], v[112:113], v[48:49]
    v_pk_fma_f32 v[114:115], v[48:49], v[48:49], v[114:115]
    v_pk_add_f32 v[112:113], v[112:113], v[50:51]
    v_pk_fma_f32 v[114:115], v[50:51], v[50:51], v[114:115]
    v_pk_add_f32 v[112:113], v[112:113], v[56:57]
    v_pk_fma_f32 v[114:115], v[56:57], v[56:57], v[114:115]
    v_pk_add_f32 v[112:113], v[112:113], v[58:59]
    v_pk_fma_f32 v[114:115], v[58:59], v[58:59], v[114:115]
    v_add_f32 v120, v112, v113
    v_add_f32 v121, v114, v115
    v_pk_add_f32 v[116:117], v[36:37], v[38:39]
    v_pk_mul_f32 v[118:119], v[36:37], v[36:37]
    v_pk_fma_f32 v[118:119], v[38:39], v[38:39], v[118:119]
    v_pk_add_f32 v[116:117], v[116:117], v[44:45]
    v_pk_fma_f32 v[118:119], v[44:45], v[44:45], v[118:119]
    v_pk_add_f32 v[116:117], v[116:117], v[46:47]
    v_pk_fma_f32 v[118:119], v[46:47], v[46:47], v[118:119]
    v_pk_add_f32 v[116:117], v[116:117], v[52:53]
    v_pk_fma_f32 v[118:119], v[52:53], v[52:53], v[118:119]
    v_pk_add_f32 v[116:117], v[116:117], v[54:55]
    v_pk_fma_f32 v[118:119], v[54:55], v[54:55], v[118:119]
    v_pk_add_f32 v[116:117], v[116:117], v[60:61]
    v_pk_fma_f32 v[118:119], v[60:61], v[60:61], v[118:119]
    v_pk_add_f32 v[116:117], v[116:117], v[62:63]
    v_pk_fma_f32 v[118:119], v[62:63], v[62:63], v[118:119]
    v_add_f32 v122, v116, v117
    v_add_f32 v123, v118, v119
    v_mov_b32 v124, v120
    v_mov_b32 v125, v121
    v_mov_b32 v126, v122
    v_mov_b32 v127, v123
    s_nop 1
    v_permlane16_swap_b32 v120, v124
    v_permlane16_swap_b32 v121, v125
    v_permlane16_swap_b32 v122, v126
    v_permlane16_swap_b32 v123, v127
    s_nop 1
    v_add_f32 v120, v120, v124
    v_add_f32 v121, v121, v125
    v_add_f32 v122, v122, v126
    v_add_f32 v123, v123, v127
    v_mov_b32 v124, v120
    v_mov_b32 v125, v121
    v_mov_b32 v126, v122
    v_mov_b32 v127, v123
    s_nop 1
    v_permlane32_swap_b32 v120, v124
    v_permlane32_swap_b32 v121, v125
    v_permlane32_swap_b32 v122, v126
    v_permlane32_swap_b32 v123, v127
    s_nop 1
    v_add_f32 v120, v120, v124
    v_add_f32 v121, v121, v125
    v_add_f32 v122, v122, v126
    v_add_f32 v123, v123, v127
    s_lshl_b32 s16, s72, 2
    s_add_u32 s16, s16, s20
    s_lshl_b32 s16, s16, 12
    s_lshl_b32 s17, s73, 7
    s_add_u32 s16, s16, s17
    s_add_u32 s16, s16, 37748736
    v_and_b32 v23, 15, v1
    v_lshlrev_b32 v23, 3, v23
    v_lshrrev_b32 v24, 4, v1
    v_lshlrev_b32 v25, 11, v24
    v_add3_u32 v23, v23, v25, s16
    v_cmp_eq_u32 vcc, 1, v24
    s_nop 1
    v_cndmask_b32 v120, v120, v122, vcc
    v_cndmask_b32 v121, v121, v123, vcc
    v_cmp_gt_u32 vcc, 2, v24
    v_mov_b32 v25, 0x10000000
    s_nop 0
    v_cndmask_b32 v23, v25, v23, vcc
    buffer_store_dwordx2 v[120:121], v23, s[4:7], 0 offen sc1
    v_lshrrev_b32 v23, 2, v1
    v_mul_u32_u24 v23, 224, v23
    v_and_b32 v24, 3, v1
    v_lshlrev_b32 v24, 3, v24
    v_add_u32 v2, v23, v24
    v_mov_b32 v3, v2
    s_lshl_b32 s16, s35, 2
    s_add_u32 s16, s16, s20
    s_lshl_b32 s16, s16, 17
    s_add_u32 s17, s16, 16777216
    v_lshlrev_b32 v23, 4, v1
    v_add_u32 v13, s17, v23
    s_add_u32 s17, s17, 32768
    v_add_u32 v14, s17, v23
    s_add_u32 s17, s17, 32768
    v_add_u32 v15, s17, v23
    s_add_u32 s17, s17, 32768
    v_add_u32 v16, s17, v23
    s_mov_b32 s27, 0
    s_mov_b32 s24, 0
    s_mul_i32 s29, s20, 7168
    s_add_u32 s29, s29, 114688
    v_mov_b32 v32, 0
    v_mov_b32 v33, 0
    v_mov_b32 v34, 0
    v_mov_b32 v35, 0
    v_mov_b32 v36, 0
    v_mov_b32 v37, 0
    v_mov_b32 v38, 0
    v_mov_b32 v39, 0
    v_mov_b32 v40, 0
    v_mov_b32 v41, 0
    v_mov_b32 v42, 0
    v_mov_b32 v43, 0
    v_mov_b32 v44, 0
    v_mov_b32 v45, 0
    v_mov_b32 v46, 0
    v_mov_b32 v47, 0
    v_mov_b32 v48, 0
    v_mov_b32 v49, 0
    v_mov_b32 v50, 0
    v_mov_b32 v51, 0
    v_mov_b32 v52, 0
    v_mov_b32 v53, 0
    v_mov_b32 v54, 0
    v_mov_b32 v55, 0
    v_mov_b32 v56, 0
    v_mov_b32 v57, 0
    v_mov_b32 v58, 0
    v_mov_b32 v59, 0
    v_mov_b32 v60, 0
    v_mov_b32 v61, 0
    v_mov_b32 v62, 0
    v_mov_b32 v63, 0
    v_mov_b32 v64, 0
    v_mov_b32 v65, 0
    v_mov_b32 v66, 0
    v_mov_b32 v67, 0
    v_mov_b32 v68, 0
    v_mov_b32 v69, 0
    v_mov_b32 v70, 0
    v_mov_b32 v71, 0
    v_mov_b32 v72, 0
    v_mov_b32 v73, 0
    v_mov_b32 v74, 0
    v_mov_b32 v75, 0
    v_mov_b32 v76, 0
    v_mov_b32 v77, 0
    v_mov_b32 v78, 0
    v_mov_b32 v79, 0
    v_mov_b32 v80, 0
    v_mov_b32 v81, 0
    v_mov_b32 v82, 0
    v_mov_b32 v83, 0
    v_mov_b32 v84, 0
    v_mov_b32 v85, 0
    v_mov_b32 v86, 0
    v_mov_b32 v87, 0
    v_mov_b32 v88, 0
    v_mov_b32 v89, 0
    v_mov_b32 v90, 0
    v_mov_b32 v91, 0
    v_mov_b32 v92, 0
    v_mov_b32 v93, 0
    v_mov_b32 v94, 0
    v_mov_b32 v95, 0
    v_mov_b32 v96, 0
    v_mov_b32 v97, 0
    v_mov_b32 v98, 0
    v_mov_b32 v99, 0
    v_mov_b32 v100, 0
    v_mov_b32 v101, 0
    v_mov_b32 v102, 0
    v_mov_b32 v103, 0
    v_mov_b32 v104, 0
    v_mov_b32 v105, 0
    v_mov_b32 v106, 0
    v_mov_b32 v107, 0
    v_mov_b32 v108, 0
    v_mov_b32 v109, 0
    v_mov_b32 v110, 0
    v_mov_b32 v111, 0
    v_mov_b32 v112, 0
    v_mov_b32 v113, 0
    v_mov_b32 v114, 0
    v_mov_b32 v115, 0
    v_mov_b32 v116, 0
    v_mov_b32 v117, 0
    v_mov_b32 v118, 0
    v_mov_b32 v119, 0
    v_mov_b32 v120, 0
    v_mov_b32 v121, 0
    v_mov_b32 v122, 0
    v_mov_b32 v123, 0
    v_mov_b32 v124, 0
    v_mov_b32 v125, 0
    v_mov_b32 v126, 0
    v_mov_b32 v127, 0
    v_mov_b32 v144, 0
    v_mov_b32 v145, 0
    s_and_b32 s3, s2, 7
    s_lshr_b32 s16, s2, 3
    s_and_b32 s70, s3, 1
    s_lshr_b32 s17, s3, 1
    s_lshl_b32 s17, s17, 1
    s_and_b32 s18, s16, 1
    s_add_u32 s17, s17, s18
    s_lshr_b32 s18, s2, 7
    s_lshl_b32 s18, s18, 3
    s_add_u32 s68, s17, s18
    s_bfe_u32 s69, s16, 0x30001
    s_lshl_b32 s71, s69, 1
    s_add_u32 s71, s71, s70
    v_lshrrev_b32 v4, 4, v1
    v_bfe_u32 v5, v1, 1, 3
    v_and_b32 v26, 1, v1
    v_lshlrev_b32 v26, 4, v26
    s_lshl_b32 s16, s20, 16
    v_add_u32 v27, 0, v4
    v_xor_b32 v27, v27, v5
    v_lshlrev_b32 v27, 5, v27
    v_add_u32 v27, v27, v26
    v_add_u32 v28, 0, v4
    v_lshlrev_b32 v28, 11, v28
    v_add3_u32 v27, v27, v28, s16
    v_mov_b32 v18, v27
    v_add_u32 v27, 4, v4
    v_xor_b32 v27, v27, v5
    v_lshlrev_b32 v27, 5, v27
    v_add_u32 v27, v27, v26
    v_add_u32 v28, 4, v4
    v_lshlrev_b32 v28, 11, v28
    v_add3_u32 v27, v27, v28, s16
    v_subrev_u32 v19, 1024, v27
    v_add_u32 v27, 0, v4
    v_xor_b32 v27, v27, v5
    v_lshlrev_b32 v27, 5, v27
    v_add_u32 v27, v27, v26
    v_add_u32 v28, 8, v4
    v_lshlrev_b32 v28, 11, v28
    v_add3_u32 v27, v27, v28, s16
    v_subrev_u32 v20, 2048, v27
    v_add_u32 v27, 4, v4
    v_xor_b32 v27, v27, v5
    v_lshlrev_b32 v27, 5, v27
    v_add_u32 v27, v27, v26
    v_add_u32 v28, 12, v4
    v_lshlrev_b32 v28, 11, v28
    v_add3_u32 v27, v27, v28, s16
    v_subrev_u32 v21, 3072, v27
    v_add_u32 v27, 0, v4
    v_xor_b32 v27, v27, v5
    v_lshlrev_b32 v27, 5, v27
    v_add_u32 v27, v27, v26
    v_add_u32 v28, 16, v4
    v_lshlrev_b32 v28, 11, v28
    v_add3_u32 v27, v27, v28, s16
    v_mov_b32 v22, v27
    v_add_u32 v27, 4, v4
    v_xor_b32 v27, v27, v5
    v_lshlrev_b32 v27, 5, v27
    v_add_u32 v27, v27, v26
    v_add_u32 v28, 20, v4
    v_lshlrev_b32 v28, 11, v28
    v_add3_u32 v27, v27, v28, s16
    v_subrev_u32 v23, 1024, v27
    v_add_u32 v27, 0, v4
    v_xor_b32 v27, v27, v5
    v_lshlrev_b32 v27, 5, v27
    v_add_u32 v27, v27, v26
    v_add_u32 v28, 24, v4
    v_lshlrev_b32 v28, 11, v28
    v_add3_u32 v27, v27, v28, s16
    v_subrev_u32 v24, 2048, v27
    v_add_u32 v27, 4, v4
    v_xor_b32 v27, v27, v5
    v_lshlrev_b32 v27, 5, v27
    v_add_u32 v27, v27, v26
    v_add_u32 v28, 28, v4
    v_lshlrev_b32 v28, 11, v28
    v_add3_u32 v27, v27, v28, s16
    v_subrev_u32 v25, 3072, v27
    s_mul_i32 s16, s70, 3670016
    s_lshl_b32 s17, s69, 8
    s_add_u32 s16, s16, s17
    s_add_u32 s12, s96, s16
    s_addc_u32 s13, s97, 0
    s_sub_u32 s14, 3670016, s17
    s_mov_b32 s15, 0x20000
    s_waitcnt vmcnt(0)
    s_barrier
    s_cmp_eq_u32 s20, 1
    s_cbranch_scc0 Lh0_10
    s_lshr_b32 s16, s72, 1
    s_lshl_b32 s16, s16, 3
    s_lshl_b32 s16, s16, 8
    s_add_u32 s16, s16, 42106880
    v_lshlrev_b32 v28, 8, v1
    v_mov_b32 v31, 0x10000000
    v_cmp_gt_u32 vcc, 8, v1
    s_nop 1
    v_cndmask_b32 v28, v31, v28, vcc
    v_mov_b32 v31, 1
    buffer_atomic_add v31, v28, s[4:7], s16 offen sc1
Lh0_10:
    s_cmp_eq_u32 s20, 0
    s_cbranch_scc0 Lh1_11
    s_lshl_b32 s16, s35, 3
    s_and_b32 s17, s34, 7
    s_add_u32 s16, s16, s17
    s_lshl_b32 s16, s16, 8
    s_add_u32 s16, s16, 42106880
    s_mov_b32 s74, s16
    buffer_load_dword v31, v30, s[4:7], s74 offen sc1
Lh1_11:
    s_lshl_b32 s16, s2, 1
    s_and_b32 s17, s20, 1
    s_add_u32 s16, s16, s17
    s_mul_i32 s16, s16, 2688
    v_lshlrev_b32 v28, 7, v1
    v_add_u32 v17, s16, v28
    v_mov_b32 v4, 0x10000000
    v_cmp_gt_u32 vcc, 21, v1
    s_nop 1
    v_cndmask_b32 v17, v4, v17, vcc
    s_mul_i32 s16, s2, 28672
    s_mul_i32 s17, s20, 7168
    s_add_u32 s16, s16, s17
    v_add_u32 v29, s16, v28
    v_cndmask_b32 v29, v4, v29, vcc
    s_mov_b32 s77, 4128768
    s_mov_b32 s79, 4294959232
    s_cmp_eq_u32 s20, 0
    s_cbranch_scc0 Lh2_12
    s_waitcnt vmcnt(0)
    v_readfirstlane_b32 s17, v31
    s_cmp_ge_u32 s17, 32
    s_cbranch_scc1 Lh2_12
    s_mov_b32 s19, 0
Lhp_13:
    s_add_u32 s19, s19, 1
    s_cmp_gt_u32 s19, 300000
    s_cbranch_scc1 Lh2_12
    buffer_load_dword v31, v30, s[4:7], s74 offen sc1
    s_waitcnt vmcnt(0)
    v_readfirstlane_b32 s17, v31
    s_cmp_ge_u32 s17, 32
    s_cbranch_scc0 Lhp_13
Lh2_12:
    s_barrier
    buffer_load_dwordx4 a[0:3], v13, s[4:7], s24 offen sc1
    buffer_load_dwordx4 a[4:7], v14, s[4:7], s24 offen sc1
    buffer_load_dwordx4 a[8:11], v15, s[4:7], s24 offen sc1
    buffer_load_dwordx4 a[12:15], v16, s[4:7], s24 offen sc1
    s_add_u32 s24, s24, 1024
    buffer_load_dwordx4 a[16:19], v13, s[4:7], s24 offen sc1
    buffer_load_dwordx4 a[20:23], v14, s[4:7], s24 offen sc1
    buffer_load_dwordx4 a[24:27], v15, s[4:7], s24 offen sc1
    buffer_load_dwordx4 a[28:31], v16, s[4:7], s24 offen sc1
    s_add_u32 s24, s24, 1024
    buffer_load_dwordx4 a[32:35], v13, s[4:7], s24 offen sc1
    buffer_load_dwordx4 a[36:39], v14, s[4:7], s24 offen sc1
    buffer_load_dwordx4 a[40:43], v15, s[4:7], s24 offen sc1
    buffer_load_dwordx4 a[44:47], v16, s[4:7], s24 offen sc1
    s_add_u32 s24, s24, 1024
    s_add_u32 s25, s25, 458752
    s_add_u32 s26, s26, 28672
    s_add_u32 m0, s26, 0
    s_nop 0
    buffer_load_dwordx4 v6, s[8:11], s25 offen lds
    s_add_u32 m0, s26, 1024
    s_nop 0
    buffer_load_dwordx4 v7, s[8:11], s25 offen lds
    s_add_u32 m0, s26, 2048
    s_nop 0
    buffer_load_dwordx4 v8, s[8:11], s25 offen lds
    s_add_u32 m0, s26, 3072
    s_nop 0
    buffer_load_dwordx4 v9, s[8:11], s25 offen lds
    s_barrier
    ds_read_b64_tr_b16 a[64:65], v3 offset:0
    ds_read_b64_tr_b16 a[66:67], v3 offset:3584
    ds_read_b64_tr_b16 a[68:69], v3 offset:32
    ds_read_b64_tr_b16 a[70:71], v3 offset:3616
    ds_read_b64_tr_b16 a[72:73], v3 offset:64
    ds_read_b64_tr_b16 a[74:75], v3 offset:3648
    ds_read_b64_tr_b16 a[76:77], v3 offset:96
    ds_read_b64_tr_b16 a[78:79], v3 offset:3680
    ds_read_b64_tr_b16 a[80:81], v3 offset:128
    ds_read_b64_tr_b16 a[82:83], v3 offset:3712
    s_mov_b32 s28, 7
    s_mov_b32 s33, 0

.p2align 6
L4_loop:
    s_waitcnt vmcnt(12)
    s_waitcnt lgkmcnt(8)
    v_mfma_f32_16x16x32_bf16 v[32:35], a[64:67], a[0:3], v[32:35]
    ds_read_b64_tr_b16 a[84:85], v3 offset:160
    v_mfma_f32_16x16x32_bf16 v[36:39], a[64:67], a[4:7], v[36:39]
    ds_read_b64_tr_b16 a[86:87], v3 offset:3744
    v_mfma_f32_16x16x32_bf16 v[40:43], a[64:67], a[8:11], v[40:43]
    buffer_load_dword v28, v17, s[80:83], s77 offen
    v_mfma_f32_16x16x32_bf16 v[44:47], a[64:67], a[12:15], v[44:47]
    s_waitcnt lgkmcnt(8)
    buffer_load_dword v28, v29, s[36:39], s79 offen
    v_mfma_f32_16x16x32_bf16 v[60:63], a[68:71], a[12:15], v[60:63]
    ds_read_b64_tr_b16 a[88:89], v3 offset:192
    v_mfma_f32_16x16x32_bf16 v[56:59], a[68:71], a[8:11], v[56:59]
    ds_read_b64_tr_b16 a[90:91], v3 offset:3776
    v_mfma_f32_16x16x32_bf16 v[52:55], a[68:71], a[4:7], v[52:55]
    buffer_load_dwordx4 a[48:51], v13, s[4:7], s24 offen sc1
    v_mfma_f32_16x16x32_bf16 v[48:51], a[68:71], a[0:3], v[48:51]
    s_waitcnt lgkmcnt(8)
    v_mfma_f32_16x16x32_bf16 v[64:67], a[72:75], a[0:3], v[64:67]
    ds_read_b64_tr_b16 a[64:65], v3 offset:14336
    v_mfma_f32_16x16x32_bf16 v[68:71], a[72:75], a[4:7], v[68:71]
    ds_read_b64_tr_b16 a[66:67], v3 offset:17920
    v_mfma_f32_16x16x32_bf16 v[72:75], a[72:75], a[8:11], v[72:75]
    buffer_load_dwordx4 a[52:55], v14, s[4:7], s24 offen sc1
    v_mfma_f32_16x16x32_bf16 v[76:79], a[72:75], a[12:15], v[76:79]
    s_waitcnt lgkmcnt(8)
    v_mfma_f32_16x16x32_bf16 v[92:95], a[76:79], a[12:15], v[92:95]
    ds_read_b64_tr_b16 a[68:69], v3 offset:14368
    v_mfma_f32_16x16x32_bf16 v[88:91], a[76:79], a[8:11], v[88:91]
    ds_read_b64_tr_b16 a[70:71], v3 offset:17952
    v_mfma_f32_16x16x32_bf16 v[84:87], a[76:79], a[4:7], v[84:87]
    buffer_load_dwordx4 a[56:59], v15, s[4:7], s24 offen sc1
    v_mfma_f32_16x16x32_bf16 v[80:83], a[76:79], a[0:3], v[80:83]
    s_waitcnt lgkmcnt(8)
    v_mfma_f32_16x16x32_bf16 v[96:99], a[80:83], a[0:3], v[96:99]
    ds_read_b64_tr_b16 a[72:73], v3 offset:14400
    v_mfma_f32_16x16x32_bf16 v[100:103], a[80:83], a[4:7], v[100:103]
    ds_read_b64_tr_b16 a[74:75], v3 offset:17984
    v_mfma_f32_16x16x32_bf16 v[104:107], a[80:83], a[8:11], v[104:107]
    buffer_load_dwordx4 a[60:63], v16, s[4:7], s24 offen sc1
    v_mfma_f32_16x16x32_bf16 v[108:111], a[80:83], a[12:15], v[108:111]
    s_waitcnt lgkmcnt(8)
    v_mfma_f32_16x16x32_bf16 v[124:127], a[84:87], a[12:15], v[124:127]
    ds_read_b64_tr_b16 a[76:77], v3 offset:14432
    v_mfma_f32_16x16x32_bf16 v[120:123], a[84:87], a[8:11], v[120:123]
    ds_read_b64_tr_b16 a[78:79], v3 offset:18016
    v_mfma_f32_16x16x32_bf16 v[116:119], a[84:87], a[4:7], v[116:119]
    s_add_u32 s24, s24, 1024
    v_mfma_f32_16x16x32_bf16 v[112:115], a[84:87], a[0:3], v[112:115]
    s_waitcnt lgkmcnt(8)
    s_add_u32 m0, s26, 4096
    v_mfma_f32_16x16x32_bf16 v[128:131], a[88:91], a[0:3], v[128:131]
    ds_read_b64_tr_b16 a[80:81], v3 offset:14464
    v_mfma_f32_16x16x32_bf16 v[132:135], a[88:91], a[4:7], v[132:135]
    ds_read_b64_tr_b16 a[82:83], v3 offset:18048
    v_mfma_f32_16x16x32_bf16 v[136:139], a[88:91], a[8:11], v[136:139]
    s_cmp_ge_u32 s24, 32768
    buffer_load_dwordx4 v10, s[8:11], s25 offen lds
    v_mfma_f32_16x16x32_bf16 v[140:143], a[88:91], a[12:15], v[140:143]
    s_waitcnt lgkmcnt(8)
    s_cselect_b32 s24, 0x10000000, s24
    s_add_u32 m0, s26, 5120
    v_mfma_f32_16x16x32_bf16 v[156:159], a[64:67], a[12:15], v[156:159]
    ds_read_b64_tr_b16 a[84:85], v3 offset:14496
    v_mfma_f32_16x16x32_bf16 v[152:155], a[64:67], a[8:11], v[152:155]
    ds_read_b64_tr_b16 a[86:87], v3 offset:18080
    v_mfma_f32_16x16x32_bf16 v[148:151], a[64:67], a[4:7], v[148:151]
    buffer_load_dwordx4 v11, s[8:11], s25 offen lds
    v_mfma_f32_16x16x32_bf16 v[144:147], a[64:67], a[0:3], v[144:147]
    s_waitcnt lgkmcnt(8)
    s_add_u32 m0, s26, 6144
    v_mfma_f32_16x16x32_bf16 v[160:163], a[68:71], a[0:3], v[160:163]
    ds_read_b64_tr_b16 a[88:89], v3 offset:14528
    v_mfma_f32_16x16x32_bf16 v[164:167], a[68:71], a[4:7], v[164:167]
    ds_read_b64_tr_b16 a[90:91], v3 offset:18112
    v_mfma_f32_16x16x32_bf16 v[168:171], a[68:71], a[8:11], v[168:171]
    buffer_load_dwordx4 v12, s[8:11], s25 offen lds
    v_mfma_f32_16x16x32_bf16 v[172:175], a[68:71], a[12:15], v[172:175]
    s_waitcnt lgkmcnt(8)
    v_mfma_f32_16x16x32_bf16 v[188:191], a[72:75], a[12:15], v[188:191]
    ds_read_b64_tr_b16 a[64:65], v3 offset:7168
    v_mfma_f32_16x16x32_bf16 v[184:187], a[72:75], a[8:11], v[184:187]
    ds_read_b64_tr_b16 a[66:67], v3 offset:10752
    v_mfma_f32_16x16x32_bf16 v[180:183], a[72:75], a[4:7], v[180:183]
    s_add_u32 s25, s25, 458752
    v_mfma_f32_16x16x32_bf16 v[176:179], a[72:75], a[0:3], v[176:179]
    s_waitcnt lgkmcnt(8)
    v_mfma_f32_16x16x32_bf16 v[192:195], a[76:79], a[0:3], v[192:195]
    ds_read_b64_tr_b16 a[68:69], v3 offset:7200
    v_mfma_f32_16x16x32_bf16 v[196:199], a[76:79], a[4:7], v[196:199]
    ds_read_b64_tr_b16 a[70:71], v3 offset:10784
    v_mfma_f32_16x16x32_bf16 v[200:203], a[76:79], a[8:11], v[200:203]
    s_add_u32 s26, s26, 28672
    v_mfma_f32_16x16x32_bf16 v[204:207], a[76:79], a[12:15], v[204:207]
    s_waitcnt lgkmcnt(8)
    s_cmp_ge_u32 s26, s29
    v_mfma_f32_16x16x32_bf16 v[220:223], a[80:83], a[12:15], v[220:223]
    ds_read_b64_tr_b16 a[72:73], v3 offset:7232
    v_mfma_f32_16x16x32_bf16 v[216:219], a[80:83], a[8:11], v[216:219]
    ds_read_b64_tr_b16 a[74:75], v3 offset:10816
    v_mfma_f32_16x16x32_bf16 v[212:215], a[80:83], a[4:7], v[212:215]
    s_cselect_b32 s30, 114688, 0
    v_mfma_f32_16x16x32_bf16 v[208:211], a[80:83], a[0:3], v[208:211]
    s_waitcnt lgkmcnt(8)
    s_sub_u32 s26, s26, s30
    v_mfma_f32_16x16x32_bf16 v[224:227], a[84:87], a[0:3], v[224:227]
    ds_read_b64_tr_b16 a[76:77], v3 offset:7264
    v_mfma_f32_16x16x32_bf16 v[228:231], a[84:87], a[4:7], v[228:231]
    ds_read_b64_tr_b16 a[78:79], v3 offset:10848
    v_mfma_f32_16x16x32_bf16 v[232:235], a[84:87], a[8:11], v[232:235]
    s_add_u32 s27, s27, 28672
    v_mfma_f32_16x16x32_bf16 v[236:239], a[84:87], a[12:15], v[236:239]
    s_waitcnt lgkmcnt(8)
    s_cmp_ge_u32 s27, 114688
    v_mfma_f32_16x16x32_bf16 v[252:255], a[88:91], a[12:15], v[252:255]
    ds_read_b64_tr_b16 a[80:81], v3 offset:7296
    v_mfma_f32_16x16x32_bf16 v[248:251], a[88:91], a[8:11], v[248:251]
    ds_read_b64_tr_b16 a[82:83], v3 offset:10880
    v_mfma_f32_16x16x32_bf16 v[244:247], a[88:91], a[4:7], v[244:247]
    s_cselect_b32 s27, 0, s27
    v_mfma_f32_16x16x32_bf16 v[240:243], a[88:91], a[0:3], v[240:243]
    s_waitcnt vmcnt(17)
    s_waitcnt lgkmcnt(8)
    v_mfma_f32_16x16x32_bf16 v[32:35], a[64:67], a[16:19], v[32:35]
    ds_read_b64_tr_b16 a[84:85], v3 offset:7328
    v_mfma_f32_16x16x32_bf16 v[36:39], a[64:67], a[20:23], v[36:39]
    ds_read_b64_tr_b16 a[86:87], v3 offset:10912
    v_mfma_f32_16x16x32_bf16 v[40:43], a[64:67], a[24:27], v[40:43]
    s_add_u32 s77, s77, 1376256
    s_add_u32 s79, s79, 2688
    v_mfma_f32_16x16x32_bf16 v[44:47], a[64:67], a[28:31], v[44:47]
    s_waitcnt lgkmcnt(8)
    v_mfma_f32_16x16x32_bf16 v[60:63], a[68:71], a[28:31], v[60:63]
    ds_read_b64_tr_b16 a[88:89], v3 offset:7360
    v_mfma_f32_16x16x32_bf16 v[56:59], a[68:71], a[24:27], v[56:59]
    ds_read_b64_tr_b16 a[90:91], v3 offset:10944
    v_mfma_f32_16x16x32_bf16 v[52:55], a[68:71], a[20:23], v[52:55]
    buffer_load_dwordx4 a[0:3], v13, s[4:7], s24 offen sc1
    v_mfma_f32_16x16x32_bf16 v[48:51], a[68:71], a[16:19], v[48:51]
    s_waitcnt lgkmcnt(8)
    v_mfma_f32_16x16x32_bf16 v[64:67], a[72:75], a[16:19], v[64:67]
    ds_read_b64_tr_b16 a[64:65], v3 offset:21504
    v_mfma_f32_16x16x32_bf16 v[68:71], a[72:75], a[20:23], v[68:71]
    ds_read_b64_tr_b16 a[66:67], v3 offset:25088
    v_mfma_f32_16x16x32_bf16 v[72:75], a[72:75], a[24:27], v[72:75]
    buffer_load_dwordx4 a[4:7], v14, s[4:7], s24 offen sc1
    v_mfma_f32_16x16x32_bf16 v[76:79], a[72:75], a[28:31], v[76:79]
    s_waitcnt lgkmcnt(8)
    v_mfma_f32_16x16x32_bf16 v[92:95], a[76:79], a[28:31], v[92:95]
    ds_read_b64_tr_b16 a[68:69], v3 offset:21536
    v_mfma_f32_16x16x32_bf16 v[88:91], a[76:79], a[24:27], v[88:91]
    ds_read_b64_tr_b16 a[70:71], v3 offset:25120
    v_mfma_f32_16x16x32_bf16 v[84:87], a[76:79], a[20:23], v[84:87]
    buffer_load_dwordx4 a[8:11], v15, s[4:7], s24 offen sc1
    v_mfma_f32_16x16x32_bf16 v[80:83], a[76:79], a[16:19], v[80:83]
    s_waitcnt lgkmcnt(8)
    v_mfma_f32_16x16x32_bf16 v[96:99], a[80:83], a[16:19], v[96:99]
    ds_read_b64_tr_b16 a[72:73], v3 offset:21568
    v_mfma_f32_16x16x32_bf16 v[100:103], a[80:83], a[20:23], v[100:103]
    ds_read_b64_tr_b16 a[74:75], v3 offset:25152
    v_mfma_f32_16x16x32_bf16 v[104:107], a[80:83], a[24:27], v[104:107]
    buffer_load_dwordx4 a[12:15], v16, s[4:7], s24 offen sc1
    v_mfma_f32_16x16x32_bf16 v[108:111], a[80:83], a[28:31], v[108:111]
    s_waitcnt lgkmcnt(8)
    v_mfma_f32_16x16x32_bf16 v[124:127], a[84:87], a[28:31], v[124:127]
    ds_read_b64_tr_b16 a[76:77], v3 offset:21600
    v_mfma_f32_16x16x32_bf16 v[120:123], a[84:87], a[24:27], v[120:123]
    ds_read_b64_tr_b16 a[78:79], v3 offset:25184
    v_mfma_f32_16x16x32_bf16 v[116:119], a[84:87], a[20:23], v[116:119]
    s_add_u32 s24, s24, 1024
    v_mfma_f32_16x16x32_bf16 v[112:115], a[84:87], a[16:19], v[112:115]
    s_waitcnt lgkmcnt(8)
    v_mfma_f32_16x16x32_bf16 v[128:131], a[88:91], a[16:19], v[128:131]
    ds_read_b64_tr_b16 a[80:81], v3 offset:21632
    v_mfma_f32_16x16x32_bf16 v[132:135], a[88:91], a[20:23], v[132:135]
    ds_read_b64_tr_b16 a[82:83], v3 offset:25216
    v_mfma_f32_16x16x32_bf16 v[136:139], a[88:91], a[24:27], v[136:139]
    s_cmp_ge_u32 s24, 32768
    v_mfma_f32_16x16x32_bf16 v[140:143], a[88:91], a[28:31], v[140:143]
    s_waitcnt lgkmcnt(8)
    s_cselect_b32 s24, 0x10000000, s24
    v_mfma_f32_16x16x32_bf16 v[156:159], a[64:67], a[28:31], v[156:159]
    ds_read_b64_tr_b16 a[84:85], v3 offset:21664
    v_mfma_f32_16x16x32_bf16 v[152:155], a[64:67], a[24:27], v[152:155]
    ds_read_b64_tr_b16 a[86:87], v3 offset:25248
    v_mfma_f32_16x16x32_bf16 v[148:151], a[64:67], a[20:23], v[148:151]
    v_mfma_f32_16x16x32_bf16 v[144:147], a[64:67], a[16:19], v[144:147]
    s_waitcnt lgkmcnt(8)
    v_mfma_f32_16x16x32_bf16 v[160:163], a[68:71], a[16:19], v[160:163]
    ds_read_b64_tr_b16 a[88:89], v3 offset:21696
    v_mfma_f32_16x16x32_bf16 v[164:167], a[68:71], a[20:23], v[164:167]
    ds_read_b64_tr_b16 a[90:91], v3 offset:25280
    v_mfma_f32_16x16x32_bf16 v[168:171], a[68:71], a[24:27], v[168:171]
    v_mfma_f32_16x16x32_bf16 v[172:175], a[68:71], a[28:31], v[172:175]
    s_waitcnt lgkmcnt(8)
    v_mfma_f32_16x16x32_bf16 v[188:191], a[72:75], a[28:31], v[188:191]
    s_waitcnt vmcnt(19)
    s_barrier
    v_add_u32 v3, s27, v2
    v_mfma_f32_16x16x32_bf16 v[184:187], a[72:75], a[24:27], v[184:187]
    ds_read_b64_tr_b16 a[64:65], v3 offset:0
    v_mfma_f32_16x16x32_bf16 v[180:183], a[72:75], a[20:23], v[180:183]
    ds_read_b64_tr_b16 a[66:67], v3 offset:3584
    v_mfma_f32_16x16x32_bf16 v[176:179], a[72:75], a[16:19], v[176:179]
    s_waitcnt lgkmcnt(8)
    s_add_u32 m0, s26, 0
    v_mfma_f32_16x16x32_bf16 v[192:195], a[76:79], a[16:19], v[192:195]
    ds_read_b64_tr_b16 a[68:69], v3 offset:32
    v_mfma_f32_16x16x32_bf16 v[196:199], a[76:79], a[20:23], v[196:199]
    ds_read_b64_tr_b16 a[70:71], v3 offset:3616
    v_mfma_f32_16x16x32_bf16 v[200:203], a[76:79], a[24:27], v[200:203]
    buffer_load_dwordx4 v6, s[8:11], s25 offen lds
    v_mfma_f32_16x16x32_bf16 v[204:207], a[76:79], a[28:31], v[204:207]
    s_waitcnt lgkmcnt(8)
    s_add_u32 m0, s26, 1024
    v_mfma_f32_16x16x32_bf16 v[220:223], a[80:83], a[28:31], v[220:223]
    ds_read_b64_tr_b16 a[72:73], v3 offset:64
    v_mfma_f32_16x16x32_bf16 v[216:219], a[80:83], a[24:27], v[216:219]
    ds_read_b64_tr_b16 a[74:75], v3 offset:3648
    v_mfma_f32_16x16x32_bf16 v[212:215], a[80:83], a[20:23], v[212:215]
    buffer_load_dwordx4 v7, s[8:11], s25 offen lds
    v_mfma_f32_16x16x32_bf16 v[208:211], a[80:83], a[16:19], v[208:211]
    s_waitcnt lgkmcnt(8)
    s_add_u32 m0, s26, 2048
    v_mfma_f32_16x16x32_bf16 v[224:227], a[84:87], a[16:19], v[224:227]
    ds_read_b64_tr_b16 a[76:77], v3 offset:96
    v_mfma_f32_16x16x32_bf16 v[228:231], a[84:87], a[20:23], v[228:231]
    ds_read_b64_tr_b16 a[78:79], v3 offset:3680
    v_mfma_f32_16x16x32_bf16 v[232:235], a[84:87], a[24:27], v[232:235]
    buffer_load_dwordx4 v8, s[8:11], s25 offen lds
    v_mfma_f32_16x16x32_bf16 v[236:239], a[84:87], a[28:31], v[236:239]
    s_waitcnt lgkmcnt(8)
    s_add_u32 m0, s26, 3072
    v_mfma_f32_16x16x32_bf16 v[252:255], a[88:91], a[28:31], v[252:255]
    ds_read_b64_tr_b16 a[80:81], v3 offset:128
    v_mfma_f32_16x16x32_bf16 v[248:251], a[88:91], a[24:27], v[248:251]
    ds_read_b64_tr_b16 a[82:83], v3 offset:3712
    v_mfma_f32_16x16x32_bf16 v[244:247], a[88:91], a[20:23], v[244:247]
    buffer_load_dwordx4 v9, s[8:11], s25 offen lds
    v_mfma_f32_16x16x32_bf16 v[240:243], a[88:91], a[16:19], v[240:243]
    s_waitcnt vmcnt(12)
    s_waitcnt lgkmcnt(8)
    v_mfma_f32_16x16x32_bf16 v[32:35], a[64:67], a[32:35], v[32:35]
    ds_read_b64_tr_b16 a[84:85], v3 offset:160
    v_mfma_f32_16x16x32_bf16 v[36:39], a[64:67], a[36:39], v[36:39]
    ds_read_b64_tr_b16 a[86:87], v3 offset:3744
    v_mfma_f32_16x16x32_bf16 v[40:43], a[64:67], a[40:43], v[40:43]
    v_mfma_f32_16x16x32_bf16 v[44:47], a[64:67], a[44:47], v[44:47]
    s_waitcnt lgkmcnt(8)
    v_mfma_f32_16x16x32_bf16 v[60:63], a[68:71], a[44:47], v[60:63]
    ds_read_b64_tr_b16 a[88:89], v3 offset:192
    v_mfma_f32_16x16x32_bf16 v[56:59], a[68:71], a[40:43], v[56:59]
    ds_read_b64_tr_b16 a[90:91], v3 offset:3776
    v_mfma_f32_16x16x32_bf16 v[52:55], a[68:71], a[36:39], v[52:55]
    buffer_load_dwordx4 a[16:19], v13, s[4:7], s24 offen sc1
    v_mfma_f32_16x16x32_bf16 v[48:51], a[68:71], a[32:35], v[48:51]
    s_waitcnt lgkmcnt(8)
    v_mfma_f32_16x16x32_bf16 v[64:67], a[72:75], a[32:35], v[64:67]
    ds_read_b64_tr_b16 a[64:65], v3 offset:14336
    v_mfma_f32_16x16x32_bf16 v[68:71], a[72:75], a[36:39], v[68:71]
    ds_read_b64_tr_b16 a[66:67], v3 offset:17920
    v_mfma_f32_16x16x32_bf16 v[72:75], a[72:75], a[40:43], v[72:75]
    buffer_load_dwordx4 a[20:23], v14, s[4:7], s24 offen sc1
    v_mfma_f32_16x16x32_bf16 v[76:79], a[72:75], a[44:47], v[76:79]
    s_waitcnt lgkmcnt(8)
    v_mfma_f32_16x16x32_bf16 v[92:95], a[76:79], a[44:47], v[92:95]
    ds_read_b64_tr_b16 a[68:69], v3 offset:14368
    v_mfma_f32_16x16x32_bf16 v[88:91], a[76:79], a[40:43], v[88:91]
    ds_read_b64_tr_b16 a[70:71], v3 offset:17952
    v_mfma_f32_16x16x32_bf16 v[84:87], a[76:79], a[36:39], v[84:87]
    buffer_load_dwordx4 a[24:27], v15, s[4:7], s24 offen sc1
    v_mfma_f32_16x16x32_bf16 v[80:83], a[76:79], a[32:35], v[80:83]
    s_waitcnt lgkmcnt(8)
    v_mfma_f32_16x16x32_bf16 v[96:99], a[80:83], a[32:35], v[96:99]
    ds_read_b64_tr_b16 a[72:73], v3 offset:14400
    v_mfma_f32_16x16x32_bf16 v[100:103], a[80:83], a[36:39], v[100:103]
    ds_read_b64_tr_b16 a[74:75], v3 offset:17984
    v_mfma_f32_16x16x32_bf16 v[104:107], a[80:83], a[40:43], v[104:107]
    buffer_load_dwordx4 a[28:31], v16, s[4:7], s24 offen sc1
    v_mfma_f32_16x16x32_bf16 v[108:111], a[80:83], a[44:47], v[108:111]
    s_waitcnt lgkmcnt(8)
    v_mfma_f32_16x16x32_bf16 v[124:127], a[84:87], a[44:47], v[124:127]
    ds_read_b64_tr_b16 a[76:77], v3 offset:14432
    v_mfma_f32_16x16x32_bf16 v[120:123], a[84:87], a[40:43], v[120:123]
    ds_read_b64_tr_b16 a[78:79], v3 offset:18016
    v_mfma_f32_16x16x32_bf16 v[116:119], a[84:87], a[36:39], v[116:119]
    s_add_u32 s24, s24, 1024
    v_mfma_f32_16x16x32_bf16 v[112:115], a[84:87], a[32:35], v[112:115]
    s_waitcnt lgkmcnt(8)
    s_add_u32 m0, s26, 4096
    v_mfma_f32_16x16x32_bf16 v[128:131], a[88:91], a[32:35], v[128:131]
    ds_read_b64_tr_b16 a[80:81], v3 offset:14464
    v_mfma_f32_16x16x32_bf16 v[132:135], a[88:91], a[36:39], v[132:135]
    ds_read_b64_tr_b16 a[82:83], v3 offset:18048
    v_mfma_f32_16x16x32_bf16 v[136:139], a[88:91], a[40:43], v[136:139]
    s_cmp_ge_u32 s24, 32768
    buffer_load_dwordx4 v10, s[8:11], s25 offen lds
    v_mfma_f32_16x16x32_bf16 v[140:143], a[88:91], a[44:47], v[140:143]
    s_waitcnt lgkmcnt(8)
    s_cselect_b32 s24, 0x10000000, s24
    s_add_u32 m0, s26, 5120
    v_mfma_f32_16x16x32_bf16 v[156:159], a[64:67], a[44:47], v[156:159]
    ds_read_b64_tr_b16 a[84:85], v3 offset:14496
    v_mfma_f32_16x16x32_bf16 v[152:155], a[64:67], a[40:43], v[152:155]
    ds_read_b64_tr_b16 a[86:87], v3 offset:18080
    v_mfma_f32_16x16x32_bf16 v[148:151], a[64:67], a[36:39], v[148:151]
    buffer_load_dwordx4 v11, s[8:11], s25 offen lds
    v_mfma_f32_16x16x32_bf16 v[144:147], a[64:67], a[32:35], v[144:147]
    s_waitcnt lgkmcnt(8)
    s_add_u32 m0, s26, 6144
    v_mfma_f32_16x16x32_bf16 v[160:163], a[68:71], a[32:35], v[160:163]
    ds_read_b64_tr_b16 a[88:89], v3 offset:14528
    v_mfma_f32_16x16x32_bf16 v[164:167], a[68:71], a[36:39], v[164:167]
    ds_read_b64_tr_b16 a[90:91], v3 offset:18112
    v_mfma_f32_16x16x32_bf16 v[168:171], a[68:71], a[40:43], v[168:171]
    buffer_load_dwordx4 v12, s[8:11], s25 offen lds
    v_mfma_f32_16x16x32_bf16 v[172:175], a[68:71], a[44:47], v[172:175]
    s_waitcnt lgkmcnt(8)
    v_mfma_f32_16x16x32_bf16 v[188:191], a[72:75], a[44:47], v[188:191]
    ds_read_b64_tr_b16 a[64:65], v3 offset:7168
    v_mfma_f32_16x16x32_bf16 v[184:187], a[72:75], a[40:43], v[184:187]
    ds_read_b64_tr_b16 a[66:67], v3 offset:10752
    v_mfma_f32_16x16x32_bf16 v[180:183], a[72:75], a[36:39], v[180:183]
    s_add_u32 s25, s25, 458752
    v_mfma_f32_16x16x32_bf16 v[176:179], a[72:75], a[32:35], v[176:179]
    s_waitcnt lgkmcnt(8)
    v_mfma_f32_16x16x32_bf16 v[192:195], a[76:79], a[32:35], v[192:195]
    ds_read_b64_tr_b16 a[68:69], v3 offset:7200
    v_mfma_f32_16x16x32_bf16 v[196:199], a[76:79], a[36:39], v[196:199]
    ds_read_b64_tr_b16 a[70:71], v3 offset:10784
    v_mfma_f32_16x16x32_bf16 v[200:203], a[76:79], a[40:43], v[200:203]
    s_add_u32 s26, s26, 28672
    v_mfma_f32_16x16x32_bf16 v[204:207], a[76:79], a[44:47], v[204:207]
    s_waitcnt lgkmcnt(8)
    s_cmp_ge_u32 s26, s29
    v_mfma_f32_16x16x32_bf16 v[220:223], a[80:83], a[44:47], v[220:223]
    ds_read_b64_tr_b16 a[72:73], v3 offset:7232
    v_mfma_f32_16x16x32_bf16 v[216:219], a[80:83], a[40:43], v[216:219]
    ds_read_b64_tr_b16 a[74:75], v3 offset:10816
    v_mfma_f32_16x16x32_bf16 v[212:215], a[80:83], a[36:39], v[212:215]
    s_cselect_b32 s30, 114688, 0
    v_mfma_f32_16x16x32_bf16 v[208:211], a[80:83], a[32:35], v[208:211]
    s_waitcnt lgkmcnt(8)
    s_sub_u32 s26, s26, s30
    v_mfma_f32_16x16x32_bf16 v[224:227], a[84:87], a[32:35], v[224:227]
    ds_read_b64_tr_b16 a[76:77], v3 offset:7264
    v_mfma_f32_16x16x32_bf16 v[228:231], a[84:87], a[36:39], v[228:231]
    ds_read_b64_tr_b16 a[78:79], v3 offset:10848
    v_mfma_f32_16x16x32_bf16 v[232:235], a[84:87], a[40:43], v[232:235]
    s_add_u32 s27, s27, 28672
    v_mfma_f32_16x16x32_bf16 v[236:239], a[84:87], a[44:47], v[236:239]
    s_waitcnt lgkmcnt(8)
    s_cmp_ge_u32 s27, 114688
    v_mfma_f32_16x16x32_bf16 v[252:255], a[88:91], a[44:47], v[252:255]
    ds_read_b64_tr_b16 a[80:81], v3 offset:7296
    v_mfma_f32_16x16x32_bf16 v[248:251], a[88:91], a[40:43], v[248:251]
    ds_read_b64_tr_b16 a[82:83], v3 offset:10880
    v_mfma_f32_16x16x32_bf16 v[244:247], a[88:91], a[36:39], v[244:247]
    s_cselect_b32 s27, 0, s27
    v_mfma_f32_16x16x32_bf16 v[240:243], a[88:91], a[32:35], v[240:243]
    s_waitcnt vmcnt(17)
    s_waitcnt lgkmcnt(8)
    v_mfma_f32_16x16x32_bf16 v[32:35], a[64:67], a[48:51], v[32:35]
    ds_read_b64_tr_b16 a[84:85], v3 offset:7328
    v_mfma_f32_16x16x32_bf16 v[36:39], a[64:67], a[52:55], v[36:39]
    ds_read_b64_tr_b16 a[86:87], v3 offset:10912
    v_mfma_f32_16x16x32_bf16 v[40:43], a[64:67], a[56:59], v[40:43]
    v_mfma_f32_16x16x32_bf16 v[44:47], a[64:67], a[60:63], v[44:47]
    s_waitcnt lgkmcnt(8)
    v_mfma_f32_16x16x32_bf16 v[60:63], a[68:71], a[60:63], v[60:63]
    ds_read_b64_tr_b16 a[88:89], v3 offset:7360
    v_mfma_f32_16x16x32_bf16 v[56:59], a[68:71], a[56:59], v[56:59]
    ds_read_b64_tr_b16 a[90:91], v3 offset:10944
    v_mfma_f32_16x16x32_bf16 v[52:55], a[68:71], a[52:55], v[52:55]
    buffer_load_dwordx4 a[32:35], v13, s[4:7], s24 offen sc1
    v_mfma_f32_16x16x32_bf16 v[48:51], a[68:71], a[48:51], v[48:51]
    s_waitcnt lgkmcnt(8)
    v_mfma_f32_16x16x32_bf16 v[64:67], a[72:75], a[48:51], v[64:67]
    ds_read_b64_tr_b16 a[64:65], v3 offset:21504
    v_mfma_f32_16x16x32_bf16 v[68:71], a[72:75], a[52:55], v[68:71]
    ds_read_b64_tr_b16 a[66:67], v3 offset:25088
    v_mfma_f32_16x16x32_bf16 v[72:75], a[72:75], a[56:59], v[72:75]
    buffer_load_dwordx4 a[36:39], v14, s[4:7], s24 offen sc1
    v_mfma_f32_16x16x32_bf16 v[76:79], a[72:75], a[60:63], v[76:79]
    s_waitcnt lgkmcnt(8)
    v_mfma_f32_16x16x32_bf16 v[92:95], a[76:79], a[60:63], v[92:95]
    ds_read_b64_tr_b16 a[68:69], v3 offset:21536
    v_mfma_f32_16x16x32_bf16 v[88:91], a[76:79], a[56:59], v[88:91]
    ds_read_b64_tr_b16 a[70:71], v3 offset:25120
    v_mfma_f32_16x16x32_bf16 v[84:87], a[76:79], a[52:55], v[84:87]
    buffer_load_dwordx4 a[40:43], v15, s[4:7], s24 offen sc1
    v_mfma_f32_16x16x32_bf16 v[80:83], a[76:79], a[48:51], v[80:83]
    s_waitcnt lgkmcnt(8)
    v_mfma_f32_16x16x32_bf16 v[96:99], a[80:83], a[48:51], v[96:99]
    ds_read_b64_tr_b16 a[72:73], v3 offset:21568
    v_mfma_f32_16x16x32_bf16 v[100:103], a[80:83], a[52:55], v[100:103]
    ds_read_b64_tr_b16 a[74:75], v3 offset:25152
    v_mfma_f32_16x16x32_bf16 v[104:107], a[80:83], a[56:59], v[104:107]
    buffer_load_dwordx4 a[44:47], v16, s[4:7], s24 offen sc1
    v_mfma_f32_16x16x32_bf16 v[108:111], a[80:83], a[60:63], v[108:111]
    s_waitcnt lgkmcnt(8)
    v_mfma_f32_16x16x32_bf16 v[124:127], a[84:87], a[60:63], v[124:127]
    ds_read_b64_tr_b16 a[76:77], v3 offset:21600
    v_mfma_f32_16x16x32_bf16 v[120:123], a[84:87], a[56:59], v[120:123]
    ds_read_b64_tr_b16 a[78:79], v3 offset:25184
    v_mfma_f32_16x16x32_bf16 v[116:119], a[84:87], a[52:55], v[116:119]
    s_add_u32 s24, s24, 1024
    v_mfma_f32_16x16x32_bf16 v[112:115], a[84:87], a[48:51], v[112:115]
    s_waitcnt lgkmcnt(8)
    v_mfma_f32_16x16x32_bf16 v[128:131], a[88:91], a[48:51], v[128:131]
    ds_read_b64_tr_b16 a[80:81], v3 offset:21632
    v_mfma_f32_16x16x32_bf16 v[132:135], a[88:91], a[52:55], v[132:135]
    ds_read_b64_tr_b16 a[82:83], v3 offset:25216
    v_mfma_f32_16x16x32_bf16 v[136:139], a[88:91], a[56:59], v[136:139]
    s_cmp_ge_u32 s24, 32768
    v_mfma_f32_16x16x32_bf16 v[140:143], a[88:91], a[60:63], v[140:143]
    s_waitcnt lgkmcnt(8)
    s_cselect_b32 s24, 0x10000000, s24
    v_mfma_f32_16x16x32_bf16 v[156:159], a[64:67], a[60:63], v[156:159]
    ds_read_b64_tr_b16 a[84:85], v3 offset:21664
    v_mfma_f32_16x16x32_bf16 v[152:155], a[64:67], a[56:59], v[152:155]
    ds_read_b64_tr_b16 a[86:87], v3 offset:25248
    v_mfma_f32_16x16x32_bf16 v[148:151], a[64:67], a[52:55], v[148:151]
    v_mfma_f32_16x16x32_bf16 v[144:147], a[64:67], a[48:51], v[144:147]
    s_waitcnt lgkmcnt(8)
    v_mfma_f32_16x16x32_bf16 v[160:163], a[68:71], a[48:51], v[160:163]
    ds_read_b64_tr_b16 a[88:89], v3 offset:21696
    v_mfma_f32_16x16x32_bf16 v[164:167], a[68:71], a[52:55], v[164:167]
    ds_read_b64_tr_b16 a[90:91], v3 offset:25280
    v_mfma_f32_16x16x32_bf16 v[168:171], a[68:71], a[56:59], v[168:171]
    v_mfma_f32_16x16x32_bf16 v[172:175], a[68:71], a[60:63], v[172:175]
    s_waitcnt lgkmcnt(8)
    v_mfma_f32_16x16x32_bf16 v[188:191], a[72:75], a[60:63], v[188:191]
    s_waitcnt vmcnt(19)
    s_barrier
    v_add_u32 v3, s27, v2
    v_mfma_f32_16x16x32_bf16 v[184:187], a[72:75], a[56:59], v[184:187]
    ds_read_b64_tr_b16 a[64:65], v3 offset:0
    v_mfma_f32_16x16x32_bf16 v[180:183], a[72:75], a[52:55], v[180:183]
    ds_read_b64_tr_b16 a[66:67], v3 offset:3584
    v_mfma_f32_16x16x32_bf16 v[176:179], a[72:75], a[48:51], v[176:179]
    s_waitcnt lgkmcnt(8)
    s_add_u32 m0, s26, 0
    v_mfma_f32_16x16x32_bf16 v[192:195], a[76:79], a[48:51], v[192:195]
    ds_read_b64_tr_b16 a[68:69], v3 offset:32
    v_mfma_f32_16x16x32_bf16 v[196:199], a[76:79], a[52:55], v[196:199]
    ds_read_b64_tr_b16 a[70:71], v3 offset:3616
    v_mfma_f32_16x16x32_bf16 v[200:203], a[76:79], a[56:59], v[200:203]
    buffer_load_dwordx4 v6, s[8:11], s25 offen lds
    v_mfma_f32_16x16x32_bf16 v[204:207], a[76:79], a[60:63], v[204:207]
    s_waitcnt lgkmcnt(8)
    s_add_u32 m0, s26, 1024
    v_mfma_f32_16x16x32_bf16 v[220:223], a[80:83], a[60:63], v[220:223]
    ds_read_b64_tr_b16 a[72:73], v3 offset:64
    v_mfma_f32_16x16x32_bf16 v[216:219], a[80:83], a[56:59], v[216:219]
    ds_read_b64_tr_b16 a[74:75], v3 offset:3648
    v_mfma_f32_16x16x32_bf16 v[212:215], a[80:83], a[52:55], v[212:215]
    buffer_load_dwordx4 v7, s[8:11], s25 offen lds
    v_mfma_f32_16x16x32_bf16 v[208:211], a[80:83], a[48:51], v[208:211]
    s_waitcnt lgkmcnt(8)
    s_add_u32 m0, s26, 2048
    v_mfma_f32_16x16x32_bf16 v[224:227], a[84:87], a[48:51], v[224:227]
    ds_read_b64_tr_b16 a[76:77], v3 offset:96
    v_mfma_f32_16x16x32_bf16 v[228:231], a[84:87], a[52:55], v[228:231]
    ds_read_b64_tr_b16 a[78:79], v3 offset:3680
    v_mfma_f32_16x16x32_bf16 v[232:235], a[84:87], a[56:59], v[232:235]
    buffer_load_dwordx4 v8, s[8:11], s25 offen lds
    v_mfma_f32_16x16x32_bf16 v[236:239], a[84:87], a[60:63], v[236:239]
    s_waitcnt lgkmcnt(8)
    s_add_u32 m0, s26, 3072
    v_mfma_f32_16x16x32_bf16 v[252:255], a[88:91], a[60:63], v[252:255]
    ds_read_b64_tr_b16 a[80:81], v3 offset:128
    v_mfma_f32_16x16x32_bf16 v[248:251], a[88:91], a[56:59], v[248:251]
    ds_read_b64_tr_b16 a[82:83], v3 offset:3712
    v_mfma_f32_16x16x32_bf16 v[244:247], a[88:91], a[52:55], v[244:247]
    buffer_load_dwordx4 v9, s[8:11], s25 offen lds
    v_mfma_f32_16x16x32_bf16 v[240:243], a[88:91], a[48:51], v[240:243]
    s_sub_u32 s28, s28, 1
    s_cmp_lg_u32 s28, 0
    s_cbranch_scc1 L4_loop
    s_branch L4_end
L4_end:
    s_waitcnt vmcnt(19)
    s_waitcnt lgkmcnt(8)
    v_mfma_f32_16x16x32_bf16 v[32:35], a[64:67], a[0:3], v[32:35]
    ds_read_b64_tr_b16 a[84:85], v3 offset:160
    v_mfma_f32_16x16x32_bf16 v[36:39], a[64:67], a[4:7], v[36:39]
    ds_read_b64_tr_b16 a[86:87], v3 offset:3744
    v_mfma_f32_16x16x32_bf16 v[40:43], a[64:67], a[8:11], v[40:43]
    v_mfma_f32_16x16x32_bf16 v[44:47], a[64:67], a[12:15], v[44:47]
    s_waitcnt lgkmcnt(8)
    v_mfma_f32_16x16x32_bf16 v[60:63], a[68:71], a[12:15], v[60:63]
    ds_read_b64_tr_b16 a[88:89], v3 offset:192
    v_mfma_f32_16x16x32_bf16 v[56:59], a[68:71], a[8:11], v[56:59]
    ds_read_b64_tr_b16 a[90:91], v3 offset:3776
    v_mfma_f32_16x16x32_bf16 v[52:55], a[68:71], a[4:7], v[52:55]
    buffer_load_dwordx4 a[48:51], v13, s[4:7], s24 offen sc1
    v_mfma_f32_16x16x32_bf16 v[48:51], a[68:71], a[0:3], v[48:51]
    s_waitcnt lgkmcnt(8)
    v_mfma_f32_16x16x32_bf16 v[64:67], a[72:75], a[0:3], v[64:67]
    ds_read_b64_tr_b16 a[64:65], v3 offset:14336
    v_mfma_f32_16x16x32_bf16 v[68:71], a[72:75], a[4:7], v[68:71]
    ds_read_b64_tr_b16 a[66:67], v3 offset:17920
    v_mfma_f32_16x16x32_bf16 v[72:75], a[72:75], a[8:11], v[72:75]
    buffer_load_dwordx4 a[52:55], v14, s[4:7], s24 offen sc1
    v_mfma_f32_16x16x32_bf16 v[76:79], a[72:75], a[12:15], v[76:79]
    s_waitcnt lgkmcnt(8)
    v_mfma_f32_16x16x32_bf16 v[92:95], a[76:79], a[12:15], v[92:95]
    ds_read_b64_tr_b16 a[68:69], v3 offset:14368
    v_mfma_f32_16x16x32_bf16 v[88:91], a[76:79], a[8:11], v[88:91]
    ds_read_b64_tr_b16 a[70:71], v3 offset:17952
    v_mfma_f32_16x16x32_bf16 v[84:87], a[76:79], a[4:7], v[84:87]
    buffer_load_dwordx4 a[56:59], v15, s[4:7], s24 offen sc1
    v_mfma_f32_16x16x32_bf16 v[80:83], a[76:79], a[0:3], v[80:83]
    s_waitcnt lgkmcnt(8)
    v_mfma_f32_16x16x32_bf16 v[96:99], a[80:83], a[0:3], v[96:99]
    ds_read_b64_tr_b16 a[72:73], v3 offset:14400
    v_mfma_f32_16x16x32_bf16 v[100:103], a[80:83], a[4:7], v[100:103]
    ds_read_b64_tr_b16 a[74:75], v3 offset:17984
    v_mfma_f32_16x16x32_bf16 v[104:107], a[80:83], a[8:11], v[104:107]
    buffer_load_dwordx4 a[60:63], v16, s[4:7], s24 offen sc1
    v_mfma_f32_16x16x32_bf16 v[108:111], a[80:83], a[12:15], v[108:111]
    s_waitcnt lgkmcnt(8)
    v_mfma_f32_16x16x32_bf16 v[124:127], a[84:87], a[12:15], v[124:127]
    ds_read_b64_tr_b16 a[76:77], v3 offset:14432
    v_mfma_f32_16x16x32_bf16 v[120:123], a[84:87], a[8:11], v[120:123]
    ds_read_b64_tr_b16 a[78:79], v3 offset:18016
    v_mfma_f32_16x16x32_bf16 v[116:119], a[84:87], a[4:7], v[116:119]
    v_mfma_f32_16x16x32_bf16 v[112:115], a[84:87], a[0:3], v[112:115]
    s_waitcnt lgkmcnt(8)
    v_mfma_f32_16x16x32_bf16 v[128:131], a[88:91], a[0:3], v[128:131]
    ds_read_b64_tr_b16 a[80:81], v3 offset:14464
    v_mfma_f32_16x16x32_bf16 v[132:135], a[88:91], a[4:7], v[132:135]
    ds_read_b64_tr_b16 a[82:83], v3 offset:18048
    v_mfma_f32_16x16x32_bf16 v[136:139], a[88:91], a[8:11], v[136:139]
    v_mfma_f32_16x16x32_bf16 v[140:143], a[88:91], a[12:15], v[140:143]
    s_waitcnt lgkmcnt(8)
    v_mfma_f32_16x16x32_bf16 v[156:159], a[64:67], a[12:15], v[156:159]
    ds_read_b64_tr_b16 a[84:85], v3 offset:14496
    v_mfma_f32_16x16x32_bf16 v[152:155], a[64:67], a[8:11], v[152:155]
    ds_read_b64_tr_b16 a[86:87], v3 offset:18080
    v_mfma_f32_16x16x32_bf16 v[148:151], a[64:67], a[4:7], v[148:151]
    v_mfma_f32_16x16x32_bf16 v[144:147], a[64:67], a[0:3], v[144:147]
    s_waitcnt lgkmcnt(8)
    v_mfma_f32_16x16x32_bf16 v[160:163], a[68:71], a[0:3], v[160:163]
    ds_read_b64_tr_b16 a[88:89], v3 offset:14528
    v_mfma_f32_16x16x32_bf16 v[164:167], a[68:71], a[4:7], v[164:167]
    ds_read_b64_tr_b16 a[90:91], v3 offset:18112
    v_mfma_f32_16x16x32_bf16 v[168:171], a[68:71], a[8:11], v[168:171]
    v_mfma_f32_16x16x32_bf16 v[172:175], a[68:71], a[12:15], v[172:175]
    s_waitcnt lgkmcnt(8)
    v_mfma_f32_16x16x32_bf16 v[188:191], a[72:75], a[12:15], v[188:191]
    ds_read_b64_tr_b16 a[64:65], v3 offset:7168
    v_mfma_f32_16x16x32_bf16 v[184:187], a[72:75], a[8:11], v[184:187]
    ds_read_b64_tr_b16 a[66:67], v3 offset:10752
    v_mfma_f32_16x16x32_bf16 v[180:183], a[72:75], a[4:7], v[180:183]
    v_mfma_f32_16x16x32_bf16 v[176:179], a[72:75], a[0:3], v[176:179]
    s_waitcnt lgkmcnt(8)
    v_mfma_f32_16x16x32_bf16 v[192:195], a[76:79], a[0:3], v[192:195]
    ds_read_b64_tr_b16 a[68:69], v3 offset:7200
    v_mfma_f32_16x16x32_bf16 v[196:199], a[76:79], a[4:7], v[196:199]
    ds_read_b64_tr_b16 a[70:71], v3 offset:10784
    v_mfma_f32_16x16x32_bf16 v[200:203], a[76:79], a[8:11], v[200:203]
    v_mfma_f32_16x16x32_bf16 v[204:207], a[76:79], a[12:15], v[204:207]
    s_waitcnt lgkmcnt(8)
    v_mfma_f32_16x16x32_bf16 v[220:223], a[80:83], a[12:15], v[220:223]
    ds_read_b64_tr_b16 a[72:73], v3 offset:7232
    v_mfma_f32_16x16x32_bf16 v[216:219], a[80:83], a[8:11], v[216:219]
    ds_read_b64_tr_b16 a[74:75], v3 offset:10816
    v_mfma_f32_16x16x32_bf16 v[212:215], a[80:83], a[4:7], v[212:215]
    v_mfma_f32_16x16x32_bf16 v[208:211], a[80:83], a[0:3], v[208:211]
    s_waitcnt lgkmcnt(8)
    v_mfma_f32_16x16x32_bf16 v[224:227], a[84:87], a[0:3], v[224:227]
    ds_read_b64_tr_b16 a[76:77], v3 offset:7264
    v_mfma_f32_16x16x32_bf16 v[228:231], a[84:87], a[4:7], v[228:231]
    ds_read_b64_tr_b16 a[78:79], v3 offset:10848
    v_mfma_f32_16x16x32_bf16 v[232:235], a[84:87], a[8:11], v[232:235]
    s_add_u32 s27, s27, 28672
    v_mfma_f32_16x16x32_bf16 v[236:239], a[84:87], a[12:15], v[236:239]
    s_waitcnt lgkmcnt(8)
    s_cmp_ge_u32 s27, 114688
    v_mfma_f32_16x16x32_bf16 v[252:255], a[88:91], a[12:15], v[252:255]
    ds_read_b64_tr_b16 a[80:81], v3 offset:7296
    v_mfma_f32_16x16x32_bf16 v[248:251], a[88:91], a[8:11], v[248:251]
    ds_read_b64_tr_b16 a[82:83], v3 offset:10880
    v_mfma_f32_16x16x32_bf16 v[244:247], a[88:91], a[4:7], v[244:247]
    s_cselect_b32 s27, 0, s27
    v_mfma_f32_16x16x32_bf16 v[240:243], a[88:91], a[0:3], v[240:243]
    s_waitcnt vmcnt(15)
    s_waitcnt lgkmcnt(8)
    v_mfma_f32_16x16x32_bf16 v[32:35], a[64:67], a[16:19], v[32:35]
    ds_read_b64_tr_b16 a[84:85], v3 offset:7328
    v_mfma_f32_16x16x32_bf16 v[36:39], a[64:67], a[20:23], v[36:39]
    ds_read_b64_tr_b16 a[86:87], v3 offset:10912
    v_mfma_f32_16x16x32_bf16 v[40:43], a[64:67], a[24:27], v[40:43]
    s_lshl_b32 s16, s35, 4
    v_mfma_f32_16x16x32_bf16 v[44:47], a[64:67], a[28:31], v[44:47]
    s_waitcnt lgkmcnt(8)
    s_lshl_b32 s17, s20, 2
    v_mfma_f32_16x16x32_bf16 v[60:63], a[68:71], a[28:31], v[60:63]
    ds_read_b64_tr_b16 a[88:89], v3 offset:7360
    v_mfma_f32_16x16x32_bf16 v[56:59], a[68:71], a[24:27], v[56:59]
    ds_read_b64_tr_b16 a[90:91], v3 offset:10944
    v_mfma_f32_16x16x32_bf16 v[52:55], a[68:71], a[20:23], v[52:55]
    s_add_u32 s16, s16, s17
    v_mfma_f32_16x16x32_bf16 v[48:51], a[68:71], a[16:19], v[48:51]
    s_waitcnt lgkmcnt(8)
    s_mul_i32 s16, s16, 112
    v_mfma_f32_16x16x32_bf16 v[64:67], a[72:75], a[16:19], v[64:67]
    ds_read_b64_tr_b16 a[64:65], v3 offset:21504
    v_mfma_f32_16x16x32_bf16 v[68:71], a[72:75], a[20:23], v[68:71]
    ds_read_b64_tr_b16 a[66:67], v3 offset:25088
    v_mfma_f32_16x16x32_bf16 v[72:75], a[72:75], a[24:27], v[72:75]
    s_mul_i32 s17, s34, 7
    v_mfma_f32_16x16x32_bf16 v[76:79], a[72:75], a[28:31], v[76:79]
    s_waitcnt lgkmcnt(8)
    s_lshr_b32 s17, s17, 1
    v_mfma_f32_16x16x32_bf16 v[92:95], a[76:79], a[28:31], v[92:95]
    ds_read_b64_tr_b16 a[68:69], v3 offset:21536
    v_mfma_f32_16x16x32_bf16 v[88:91], a[76:79], a[24:27], v[88:91]
    ds_read_b64_tr_b16 a[70:71], v3 offset:25120
    v_mfma_f32_16x16x32_bf16 v[84:87], a[76:79], a[20:23], v[84:87]
    s_add_u32 s16, s16, s17
    v_mfma_f32_16x16x32_bf16 v[80:83], a[76:79], a[16:19], v[80:83]
    s_waitcnt lgkmcnt(8)
    s_lshl_b32 s16, s16, 10
    v_mfma_f32_16x16x32_bf16 v[96:99], a[80:83], a[16:19], v[96:99]
    ds_read_b64_tr_b16 a[72:73], v3 offset:21568
    v_mfma_f32_16x16x32_bf16 v[100:103], a[80:83], a[20:23], v[100:103]
    ds_read_b64_tr_b16 a[74:75], v3 offset:25152
    v_mfma_f32_16x16x32_bf16 v[104:107], a[80:83], a[24:27], v[104:107]
    s_add_u32 s16, s16, 20971520
    v_mfma_f32_16x16x32_bf16 v[108:111], a[80:83], a[28:31], v[108:111]
    s_waitcnt lgkmcnt(8)
    v_lshlrev_b32 v26, 4, v1
    v_mfma_f32_16x16x32_bf16 v[124:127], a[84:87], a[28:31], v[124:127]
    ds_read_b64_tr_b16 a[76:77], v3 offset:21600
    v_mfma_f32_16x16x32_bf16 v[120:123], a[84:87], a[24:27], v[120:123]
    ds_read_b64_tr_b16 a[78:79], v3 offset:25184
    v_mfma_f32_16x16x32_bf16 v[116:119], a[84:87], a[20:23], v[116:119]
    v_add_u32 v13, s16, v26
    v_mfma_f32_16x16x32_bf16 v[112:115], a[84:87], a[16:19], v[112:115]
    s_waitcnt lgkmcnt(8)
    s_add_u32 s16, s16, 114688
    v_mfma_f32_16x16x32_bf16 v[128:131], a[88:91], a[16:19], v[128:131]
    ds_read_b64_tr_b16 a[80:81], v3 offset:21632
    v_mfma_f32_16x16x32_bf16 v[132:135], a[88:91], a[20:23], v[132:135]
    ds_read_b64_tr_b16 a[82:83], v3 offset:25216
    v_mfma_f32_16x16x32_bf16 v[136:139], a[88:91], a[24:27], v[136:139]
    v_add_u32 v14, s16, v26
    v_mfma_f32_16x16x32_bf16 v[140:143], a[88:91], a[28:31], v[140:143]
    s_waitcnt lgkmcnt(8)
    s_add_u32 s16, s16, 114688
    v_mfma_f32_16x16x32_bf16 v[156:159], a[64:67], a[28:31], v[156:159]
    ds_read_b64_tr_b16 a[84:85], v3 offset:21664
    v_mfma_f32_16x16x32_bf16 v[152:155], a[64:67], a[24:27], v[152:155]
    ds_read_b64_tr_b16 a[86:87], v3 offset:25248
    v_mfma_f32_16x16x32_bf16 v[148:151], a[64:67], a[20:23], v[148:151]
    v_add_u32 v15, s16, v26
    v_mfma_f32_16x16x32_bf16 v[144:147], a[64:67], a[16:19], v[144:147]
    s_waitcnt lgkmcnt(8)
    s_add_u32 s16, s16, 114688
    v_mfma_f32_16x16x32_bf16 v[160:163], a[68:71], a[16:19], v[160:163]
    ds_read_b64_tr_b16 a[88:89], v3 offset:21696
    v_mfma_f32_16x16x32_bf16 v[164:167], a[68:71], a[20:23], v[164:167]
    ds_read_b64_tr_b16 a[90:91], v3 offset:25280
    v_mfma_f32_16x16x32_bf16 v[168:171], a[68:71], a[24:27], v[168:171]
    v_add_u32 v16, s16, v26
    v_mfma_f32_16x16x32_bf16 v[172:175], a[68:71], a[28:31], v[172:175]
    s_waitcnt lgkmcnt(8)
    s_add_u32 s16, s16, 114688
    v_mfma_f32_16x16x32_bf16 v[188:191], a[72:75], a[28:31], v[188:191]
    s_waitcnt vmcnt(12)
    s_barrier
    v_add_u32 v3, s27, v2
    v_mfma_f32_16x16x32_bf16 v[184:187], a[72:75], a[24:27], v[184:187]
    ds_read_b64_tr_b16 a[64:65], v3 offset:0
    v_mfma_f32_16x16x32_bf16 v[180:183], a[72:75], a[20:23], v[180:183]
    ds_read_b64_tr_b16 a[66:67], v3 offset:3584
    v_mfma_f32_16x16x32_bf16 v[176:179], a[72:75], a[16:19], v[176:179]
    s_waitcnt lgkmcnt(8)
    v_mfma_f32_16x16x32_bf16 v[192:195], a[76:79], a[16:19], v[192:195]
    ds_read_b64_tr_b16 a[68:69], v3 offset:14336
    v_mfma_f32_16x16x32_bf16 v[196:199], a[76:79], a[20:23], v[196:199]
    ds_read_b64_tr_b16 a[70:71], v3 offset:17920
    v_mfma_f32_16x16x32_bf16 v[200:203], a[76:79], a[24:27], v[200:203]
    v_mfma_f32_16x16x32_bf16 v[204:207], a[76:79], a[28:31], v[204:207]
    s_waitcnt lgkmcnt(8)
    v_mfma_f32_16x16x32_bf16 v[220:223], a[80:83], a[28:31], v[220:223]
    ds_read_b64_tr_b16 a[72:73], v3 offset:7168
    v_mfma_f32_16x16x32_bf16 v[216:219], a[80:83], a[24:27], v[216:219]
    ds_read_b64_tr_b16 a[74:75], v3 offset:10752
    v_mfma_f32_16x16x32_bf16 v[212:215], a[80:83], a[20:23], v[212:215]
    v_mfma_f32_16x16x32_bf16 v[208:211], a[80:83], a[16:19], v[208:211]
    s_waitcnt lgkmcnt(8)
    v_mfma_f32_16x16x32_bf16 v[224:227], a[84:87], a[16:19], v[224:227]
    ds_read_b64_tr_b16 a[76:77], v3 offset:21504
    v_mfma_f32_16x16x32_bf16 v[228:231], a[84:87], a[20:23], v[228:231]
    ds_read_b64_tr_b16 a[78:79], v3 offset:25088
    v_mfma_f32_16x16x32_bf16 v[232:235], a[84:87], a[24:27], v[232:235]
    v_mfma_f32_16x16x32_bf16 v[236:239], a[84:87], a[28:31], v[236:239]
    s_waitcnt lgkmcnt(8)
    v_mfma_f32_16x16x32_bf16 v[252:255], a[88:91], a[28:31], v[252:255]
    ds_read_b64_tr_b16 a[80:81], v3 offset:32
    v_mfma_f32_16x16x32_bf16 v[248:251], a[88:91], a[24:27], v[248:251]
    ds_read_b64_tr_b16 a[82:83], v3 offset:3616
    v_mfma_f32_16x16x32_bf16 v[244:247], a[88:91], a[20:23], v[244:247]
    v_mfma_f32_16x16x32_bf16 v[240:243], a[88:91], a[16:19], v[240:243]
    s_and_b32 s17, s34, 1
    s_cmp_eq_u32 s17, 1
    s_cbranch_scc1 L4_epi1
    s_waitcnt vmcnt(8)
    s_waitcnt lgkmcnt(8)
    v_mfma_f32_16x16x32_bf16 v[32:35], a[64:67], a[32:35], v[32:35]
    ds_read_b64_tr_b16 a[84:85], v3 offset:14368
    v_mfma_f32_16x16x32_bf16 v[36:39], a[64:67], a[36:39], v[36:39]
    ds_read_b64_tr_b16 a[86:87], v3 offset:17952
    v_mfma_f32_16x16x32_bf16 v[40:43], a[64:67], a[40:43], v[40:43]
    v_mfma_f32_16x16x32_bf16 v[44:47], a[64:67], a[44:47], v[44:47]
    s_waitcnt lgkmcnt(8)
    v_mfma_f32_16x16x32_bf16 v[156:159], a[68:71], a[44:47], v[156:159]
    ds_read_b64_tr_b16 a[88:89], v3 offset:7200
    v_mfma_f32_16x16x32_bf16 v[152:155], a[68:71], a[40:43], v[152:155]
    ds_read_b64_tr_b16 a[90:91], v3 offset:10784
    v_mfma_f32_16x16x32_bf16 v[148:151], a[68:71], a[36:39], v[148:151]
    v_mfma_f32_16x16x32_bf16 v[144:147], a[68:71], a[32:35], v[144:147]
    s_waitcnt vmcnt(0)
    s_waitcnt lgkmcnt(8)
    v_mfma_f32_16x16x32_bf16 v[32:35], a[72:75], a[48:51], v[32:35]
    ds_read_b64_tr_b16 a[64:65], v3 offset:21536
    v_mfma_f32_16x16x32_bf16 v[36:39], a[72:75], a[52:55], v[36:39]
    ds_read_b64_tr_b16 a[66:67], v3 offset:25120
    v_mfma_f32_16x16x32_bf16 v[40:43], a[72:75], a[56:59], v[40:43]
    v_mfma_f32_16x16x32_bf16 v[44:47], a[72:75], a[60:63], v[44:47]
    s_waitcnt lgkmcnt(8)
    v_mfma_f32_16x16x32_bf16 v[156:159], a[76:79], a[60:63], v[156:159]
    ds_read_b64_tr_b16 a[68:69], v3 offset:64
    v_mfma_f32_16x16x32_bf16 v[152:155], a[76:79], a[56:59], v[152:155]
    ds_read_b64_tr_b16 a[70:71], v3 offset:3648
    v_mfma_f32_16x16x32_bf16 v[148:151], a[76:79], a[52:55], v[148:151]
    v_mfma_f32_16x16x32_bf16 v[144:147], a[76:79], a[48:51], v[144:147]
    s_waitcnt lgkmcnt(8)
    v_mfma_f32_16x16x32_bf16 v[48:51], a[80:83], a[32:35], v[48:51]
    ds_read_b64_tr_b16 a[72:73], v3 offset:14400
    v_mfma_f32_16x16x32_bf16 v[52:55], a[80:83], a[36:39], v[52:55]
    ds_read_b64_tr_b16 a[74:75], v3 offset:17984
    v_mfma_f32_16x16x32_bf16 v[56:59], a[80:83], a[40:43], v[56:59]
    v_mfma_f32_16x16x32_bf16 v[60:63], a[80:83], a[44:47], v[60:63]
    s_waitcnt lgkmcnt(8)
    v_mfma_f32_16x16x32_bf16 v[172:175], a[84:87], a[44:47], v[172:175]
    ds_read_b64_tr_b16 a[76:77], v3 offset:7232
    v_mfma_f32_16x16x32_bf16 v[168:171], a[84:87], a[40:43], v[168:171]
    ds_read_b64_tr_b16 a[78:79], v3 offset:10816
    v_mul_f32 v32, v32, v144
    v_mfma_f32_16x16x32_bf16 v[164:167], a[84:87], a[36:39], v[164:167]
    v_mul_f32 v33, v33, v145
    v_mul_f32 v34, v34, v146
    v_mfma_f32_16x16x32_bf16 v[160:163], a[84:87], a[32:35], v[160:163]
    s_waitcnt lgkmcnt(8)
    v_mul_f32 v35, v35, v147
    v_cvt_pk_bf16_f32 v32, v32, v33
    v_mfma_f32_16x16x32_bf16 v[48:51], a[88:91], a[48:51], v[48:51]
    ds_read_b64_tr_b16 a[80:81], v3 offset:21568
    v_cvt_pk_bf16_f32 v33, v34, v35
    v_mfma_f32_16x16x32_bf16 v[52:55], a[88:91], a[52:55], v[52:55]
    ds_read_b64_tr_b16 a[82:83], v3 offset:25152
    v_mul_f32 v36, v36, v148
    v_mfma_f32_16x16x32_bf16 v[56:59], a[88:91], a[56:59], v[56:59]
    v_mul_f32 v37, v37, v149
    v_mul_f32 v38, v38, v150
    v_mfma_f32_16x16x32_bf16 v[60:63], a[88:91], a[60:63], v[60:63]
    s_waitcnt lgkmcnt(8)
    v_mul_f32 v39, v39, v151
    v_cvt_pk_bf16_f32 v36, v36, v37
    v_mfma_f32_16x16x32_bf16 v[172:175], a[64:67], a[60:63], v[172:175]
    ds_read_b64_tr_b16 a[84:85], v3 offset:96
    v_cvt_pk_bf16_f32 v37, v38, v39
    v_mfma_f32_16x16x32_bf16 v[168:171], a[64:67], a[56:59], v[168:171]
    ds_read_b64_tr_b16 a[86:87], v3 offset:3680
    v_mul_f32 v40, v40, v152
    v_mfma_f32_16x16x32_bf16 v[164:167], a[64:67], a[52:55], v[164:167]
    v_mul_f32 v41, v41, v153
    v_mul_f32 v42, v42, v154
    v_mfma_f32_16x16x32_bf16 v[160:163], a[64:67], a[48:51], v[160:163]
    s_waitcnt lgkmcnt(8)
    v_mul_f32 v43, v43, v155
    v_cvt_pk_bf16_f32 v40, v40, v41
    v_mfma_f32_16x16x32_bf16 v[64:67], a[68:71], a[32:35], v[64:67]
    ds_read_b64_tr_b16 a[88:89], v3 offset:14432
    v_cvt_pk_bf16_f32 v41, v42, v43
    v_mfma_f32_16x16x32_bf16 v[68:71], a[68:71], a[36:39], v[68:71]
    ds_read_b64_tr_b16 a[90:91], v3 offset:18016
    v_mul_f32 v44, v44, v156
    v_mfma_f32_16x16x32_bf16 v[72:75], a[68:71], a[40:43], v[72:75]
    v_mul_f32 v45, v45, v157
    v_mul_f32 v46, v46, v158
    v_mfma_f32_16x16x32_bf16 v[76:79], a[68:71], a[44:47], v[76:79]
    s_waitcnt lgkmcnt(8)
    v_mul_f32 v47, v47, v159
    v_cvt_pk_bf16_f32 v44, v44, v45
    v_mfma_f32_16x16x32_bf16 v[188:191], a[72:75], a[44:47], v[188:191]
    ds_read_b64_tr_b16 a[64:65], v3 offset:7264
    v_cvt_pk_bf16_f32 v45, v46, v47
    v_mfma_f32_16x16x32_bf16 v[184:187], a[72:75], a[40:43], v[184:187]
    ds_read_b64_tr_b16 a[66:67], v3 offset:10848
    v_mul_f32 v48, v48, v160
    v_mfma_f32_16x16x32_bf16 v[180:183], a[72:75], a[36:39], v[180:183]
    v_mul_f32 v49, v49, v161
    v_mul_f32 v50, v50, v162
    v_mfma_f32_16x16x32_bf16 v[176:179], a[72:75], a[32:35], v[176:179]
    s_waitcnt lgkmcnt(8)
    v_mul_f32 v51, v51, v163
    v_cvt_pk_bf16_f32 v34, v48, v49
    v_mfma_f32_16x16x32_bf16 v[64:67], a[76:79], a[48:51], v[64:67]
    ds_read_b64_tr_b16 a[68:69], v3 offset:21600
    v_cvt_pk_bf16_f32 v35, v50, v51
    v_mfma_f32_16x16x32_bf16 v[68:71], a[76:79], a[52:55], v[68:71]
    ds_read_b64_tr_b16 a[70:71], v3 offset:25184
    v_mfma_f32_16x16x32_bf16 v[72:75], a[76:79], a[56:59], v[72:75]
    buffer_store_dwordx4 v[32:35], v13, s[4:7], 0 offen offset:0 sc1
    v_mul_f32 v52, v52, v164
    v_mfma_f32_16x16x32_bf16 v[76:79], a[76:79], a[60:63], v[76:79]
    s_waitcnt lgkmcnt(8)
    v_mul_f32 v53, v53, v165
    v_mul_f32 v54, v54, v166
    v_mfma_f32_16x16x32_bf16 v[188:191], a[80:83], a[60:63], v[188:191]
    ds_read_b64_tr_b16 a[72:73], v3 offset:128
    v_mul_f32 v55, v55, v167
    v_mfma_f32_16x16x32_bf16 v[184:187], a[80:83], a[56:59], v[184:187]
    ds_read_b64_tr_b16 a[74:75], v3 offset:3712
    v_cvt_pk_bf16_f32 v38, v52, v53
    v_mfma_f32_16x16x32_bf16 v[180:183], a[80:83], a[52:55], v[180:183]
    v_cvt_pk_bf16_f32 v39, v54, v55
    buffer_store_dwordx4 v[36:39], v14, s[4:7], 0 offen offset:0 sc1
    v_mfma_f32_16x16x32_bf16 v[176:179], a[80:83], a[48:51], v[176:179]
    s_waitcnt lgkmcnt(8)
    v_mul_f32 v56, v56, v168
    v_mul_f32 v57, v57, v169
    v_mfma_f32_16x16x32_bf16 v[80:83], a[84:87], a[32:35], v[80:83]
    ds_read_b64_tr_b16 a[76:77], v3 offset:14464
    v_mul_f32 v58, v58, v170
    v_mfma_f32_16x16x32_bf16 v[84:87], a[84:87], a[36:39], v[84:87]
    ds_read_b64_tr_b16 a[78:79], v3 offset:18048
    v_mul_f32 v59, v59, v171
    v_mfma_f32_16x16x32_bf16 v[88:91], a[84:87], a[40:43], v[88:91]
    v_cvt_pk_bf16_f32 v42, v56, v57
    v_cvt_pk_bf16_f32 v43, v58, v59
    v_mfma_f32_16x16x32_bf16 v[92:95], a[84:87], a[44:47], v[92:95]
    s_waitcnt lgkmcnt(8)
    buffer_store_dwordx4 v[40:43], v15, s[4:7], 0 offen offset:0 sc1
    v_mul_f32 v60, v60, v172
    v_mfma_f32_16x16x32_bf16 v[204:207], a[88:91], a[44:47], v[204:207]
    ds_read_b64_tr_b16 a[80:81], v3 offset:7296
    v_mul_f32 v61, v61, v173
    v_mfma_f32_16x16x32_bf16 v[200:203], a[88:91], a[40:43], v[200:203]
    ds_read_b64_tr_b16 a[82:83], v3 offset:10880
    v_mul_f32 v62, v62, v174
    v_mfma_f32_16x16x32_bf16 v[196:199], a[88:91], a[36:39], v[196:199]
    v_mul_f32 v63, v63, v175
    v_cvt_pk_bf16_f32 v46, v60, v61
    v_mfma_f32_16x16x32_bf16 v[192:195], a[88:91], a[32:35], v[192:195]
    s_waitcnt lgkmcnt(8)
    v_cvt_pk_bf16_f32 v47, v62, v63
    buffer_store_dwordx4 v[44:47], v16, s[4:7], 0 offen offset:0 sc1
    v_mfma_f32_16x16x32_bf16 v[80:83], a[64:67], a[48:51], v[80:83]
    ds_read_b64_tr_b16 a[84:85], v3 offset:21632
    v_mul_f32 v64, v64, v176
    v_mfma_f32_16x16x32_bf16 v[84:87], a[64:67], a[52:55], v[84:87]
    ds_read_b64_tr_b16 a[86:87], v3 offset:25216
    v_mul_f32 v65, v65, v177
    v_mfma_f32_16x16x32_bf16 v[88:91], a[64:67], a[56:59], v[88:91]
    v_mul_f32 v66, v66, v178
    v_mul_f32 v67, v67, v179
    v_mfma_f32_16x16x32_bf16 v[92:95], a[64:67], a[60:63], v[92:95]
    s_waitcnt lgkmcnt(8)
    v_cvt_pk_bf16_f32 v64, v64, v65
    v_cvt_pk_bf16_f32 v65, v66, v67
    v_mfma_f32_16x16x32_bf16 v[204:207], a[68:71], a[60:63], v[204:207]
    ds_read_b64_tr_b16 a[88:89], v3 offset:160
    v_mul_f32 v68, v68, v180
    v_mfma_f32_16x16x32_bf16 v[200:203], a[68:71], a[56:59], v[200:203]
    ds_read_b64_tr_b16 a[90:91], v3 offset:3744
    v_mul_f32 v69, v69, v181
    v_mfma_f32_16x16x32_bf16 v[196:199], a[68:71], a[52:55], v[196:199]
    v_mul_f32 v70, v70, v182
    v_mul_f32 v71, v71, v183
    v_mfma_f32_16x16x32_bf16 v[192:195], a[68:71], a[48:51], v[192:195]
    s_waitcnt lgkmcnt(8)
    v_cvt_pk_bf16_f32 v68, v68, v69
    v_cvt_pk_bf16_f32 v69, v70, v71
    v_mfma_f32_16x16x32_bf16 v[96:99], a[72:75], a[32:35], v[96:99]
    ds_read_b64_tr_b16 a[64:65], v3 offset:14496
    v_mul_f32 v72, v72, v184
    v_mfma_f32_16x16x32_bf16 v[100:103], a[72:75], a[36:39], v[100:103]
    ds_read_b64_tr_b16 a[66:67], v3 offset:18080
    v_mul_f32 v73, v73, v185
    v_mfma_f32_16x16x32_bf16 v[104:107], a[72:75], a[40:43], v[104:107]
    v_mul_f32 v74, v74, v186
    v_mul_f32 v75, v75, v187
    v_mfma_f32_16x16x32_bf16 v[108:111], a[72:75], a[44:47], v[108:111]
    s_waitcnt lgkmcnt(8)
    v_cvt_pk_bf16_f32 v72, v72, v73
    v_cvt_pk_bf16_f32 v73, v74, v75
    v_mfma_f32_16x16x32_bf16 v[220:223], a[76:79], a[44:47], v[220:223]
    ds_read_b64_tr_b16 a[68:69], v3 offset:7328
    v_mul_f32 v76, v76, v188
    v_mfma_f32_16x16x32_bf16 v[216:219], a[76:79], a[40:43], v[216:219]
    ds_read_b64_tr_b16 a[70:71], v3 offset:10912
    v_mul_f32 v77, v77, v189
    v_mfma_f32_16x16x32_bf16 v[212:215], a[76:79], a[36:39], v[212:215]
    v_mul_f32 v78, v78, v190
    v_mul_f32 v79, v79, v191
    v_mfma_f32_16x16x32_bf16 v[208:211], a[76:79], a[32:35], v[208:211]
    s_waitcnt lgkmcnt(8)
    v_cvt_pk_bf16_f32 v76, v76, v77
    v_cvt_pk_bf16_f32 v77, v78, v79
    v_mfma_f32_16x16x32_bf16 v[96:99], a[80:83], a[48:51], v[96:99]
    ds_read_b64_tr_b16 a[72:73], v3 offset:21664
    v_mul_f32 v80, v80, v192
    v_mfma_f32_16x16x32_bf16 v[100:103], a[80:83], a[52:55], v[100:103]
    ds_read_b64_tr_b16 a[74:75], v3 offset:25248
    v_mul_f32 v81, v81, v193
    v_mfma_f32_16x16x32_bf16 v[104:107], a[80:83], a[56:59], v[104:107]
    v_mul_f32 v82, v82, v194
    v_mul_f32 v83, v83, v195
    v_mfma_f32_16x16x32_bf16 v[108:111], a[80:83], a[60:63], v[108:111]
    s_waitcnt lgkmcnt(8)
    v_cvt_pk_bf16_f32 v66, v80, v81
    v_cvt_pk_bf16_f32 v67, v82, v83
    v_mfma_f32_16x16x32_bf16 v[220:223], a[84:87], a[60:63], v[220:223]
    ds_read_b64_tr_b16 a[76:77], v3 offset:192
    v_mfma_f32_16x16x32_bf16 v[216:219], a[84:87], a[56:59], v[216:219]
    ds_read_b64_tr_b16 a[78:79], v3 offset:3776
    v_mfma_f32_16x16x32_bf16 v[212:215], a[84:87], a[52:55], v[212:215]
    buffer_store_dwordx4 v[64:67], v13, s[4:7], 0 offen offset:1024 sc1
    v_mul_f32 v84, v84, v196
    v_mfma_f32_16x16x32_bf16 v[208:211], a[84:87], a[48:51], v[208:211]
    s_waitcnt lgkmcnt(8)
    v_mul_f32 v85, v85, v197
    v_mul_f32 v86, v86, v198
    v_mfma_f32_16x16x32_bf16 v[112:115], a[88:91], a[32:35], v[112:115]
    ds_read_b64_tr_b16 a[80:81], v3 offset:14528
    v_mul_f32 v87, v87, v199
    v_mfma_f32_16x16x32_bf16 v[116:119], a[88:91], a[36:39], v[116:119]
    ds_read_b64_tr_b16 a[82:83], v3 offset:18112
    v_cvt_pk_bf16_f32 v70, v84, v85
    v_mfma_f32_16x16x32_bf16 v[120:123], a[88:91], a[40:43], v[120:123]
    v_cvt_pk_bf16_f32 v71, v86, v87
    buffer_store_dwordx4 v[68:71], v14, s[4:7], 0 offen offset:1024 sc1
    v_mfma_f32_16x16x32_bf16 v[124:127], a[88:91], a[44:47], v[124:127]
    s_waitcnt lgkmcnt(8)
    v_mul_f32 v88, v88, v200
    v_mul_f32 v89, v89, v201
    v_mfma_f32_16x16x32_bf16 v[236:239], a[64:67], a[44:47], v[236:239]
    ds_read_b64_tr_b16 a[84:85], v3 offset:7360
    v_mul_f32 v90, v90, v202
    v_mfma_f32_16x16x32_bf16 v[232:235], a[64:67], a[40:43], v[232:235]
    ds_read_b64_tr_b16 a[86:87], v3 offset:10944
    v_mul_f32 v91, v91, v203
    v_mfma_f32_16x16x32_bf16 v[228:231], a[64:67], a[36:39], v[228:231]
    v_cvt_pk_bf16_f32 v74, v88, v89
    v_cvt_pk_bf16_f32 v75, v90, v91
    v_mfma_f32_16x16x32_bf16 v[224:227], a[64:67], a[32:35], v[224:227]
    s_waitcnt lgkmcnt(8)
    buffer_store_dwordx4 v[72:75], v15, s[4:7], 0 offen offset:1024 sc1
    v_mul_f32 v92, v92, v204
    v_mfma_f32_16x16x32_bf16 v[112:115], a[68:71], a[48:51], v[112:115]
    ds_read_b64_tr_b16 a[88:89], v3 offset:21696
    v_mul_f32 v93, v93, v205
    v_mfma_f32_16x16x32_bf16 v[116:119], a[68:71], a[52:55], v[116:119]
    ds_read_b64_tr_b16 a[90:91], v3 offset:25280
    v_mul_f32 v94, v94, v206
    v_mfma_f32_16x16x32_bf16 v[120:123], a[68:71], a[56:59], v[120:123]
    v_mul_f32 v95, v95, v207
    v_cvt_pk_bf16_f32 v78, v92, v93
    v_mfma_f32_16x16x32_bf16 v[124:127], a[68:71], a[60:63], v[124:127]
    s_waitcnt lgkmcnt(8)
    v_cvt_pk_bf16_f32 v79, v94, v95
    buffer_store_dwordx4 v[76:79], v16, s[4:7], 0 offen offset:1024 sc1
    v_mfma_f32_16x16x32_bf16 v[236:239], a[72:75], a[60:63], v[236:239]
    v_mul_f32 v96, v96, v208
    v_mul_f32 v97, v97, v209
    v_mfma_f32_16x16x32_bf16 v[232:235], a[72:75], a[56:59], v[232:235]
    v_mul_f32 v98, v98, v210
    v_mul_f32 v99, v99, v211
    v_mfma_f32_16x16x32_bf16 v[228:231], a[72:75], a[52:55], v[228:231]
    v_cvt_pk_bf16_f32 v96, v96, v97
    v_cvt_pk_bf16_f32 v97, v98, v99
    v_mfma_f32_16x16x32_bf16 v[224:227], a[72:75], a[48:51], v[224:227]
    s_waitcnt lgkmcnt(6)
    v_mul_f32 v100, v100, v212
    v_mul_f32 v101, v101, v213
    v_mfma_f32_16x16x32_bf16 v[128:131], a[76:79], a[32:35], v[128:131]
    v_mul_f32 v102, v102, v214
    v_mul_f32 v103, v103, v215
    v_mfma_f32_16x16x32_bf16 v[132:135], a[76:79], a[36:39], v[132:135]
    v_cvt_pk_bf16_f32 v100, v100, v101
    v_cvt_pk_bf16_f32 v101, v102, v103
    v_mfma_f32_16x16x32_bf16 v[136:139], a[76:79], a[40:43], v[136:139]
    v_mul_f32 v104, v104, v216
    v_mul_f32 v105, v105, v217
    v_mfma_f32_16x16x32_bf16 v[140:143], a[76:79], a[44:47], v[140:143]
    s_waitcnt lgkmcnt(4)
    v_mul_f32 v106, v106, v218
    v_mul_f32 v107, v107, v219
    v_mfma_f32_16x16x32_bf16 v[252:255], a[80:83], a[44:47], v[252:255]
    v_cvt_pk_bf16_f32 v104, v104, v105
    v_cvt_pk_bf16_f32 v105, v106, v107
    v_mfma_f32_16x16x32_bf16 v[248:251], a[80:83], a[40:43], v[248:251]
    v_mul_f32 v108, v108, v220
    v_mul_f32 v109, v109, v221
    v_mfma_f32_16x16x32_bf16 v[244:247], a[80:83], a[36:39], v[244:247]
    v_mul_f32 v110, v110, v222
    v_mul_f32 v111, v111, v223
    v_mfma_f32_16x16x32_bf16 v[240:243], a[80:83], a[32:35], v[240:243]
    s_waitcnt lgkmcnt(2)
    v_cvt_pk_bf16_f32 v108, v108, v109
    v_cvt_pk_bf16_f32 v109, v110, v111
    v_mfma_f32_16x16x32_bf16 v[128:131], a[84:87], a[48:51], v[128:131]
    v_mul_f32 v112, v112, v224
    v_mul_f32 v113, v113, v225
    v_mfma_f32_16x16x32_bf16 v[132:135], a[84:87], a[52:55], v[132:135]
    v_mul_f32 v114, v114, v226
    v_mul_f32 v115, v115, v227
    v_mfma_f32_16x16x32_bf16 v[136:139], a[84:87], a[56:59], v[136:139]
    v_cvt_pk_bf16_f32 v98, v112, v113
    v_cvt_pk_bf16_f32 v99, v114, v115
    v_mfma_f32_16x16x32_bf16 v[140:143], a[84:87], a[60:63], v[140:143]
    s_waitcnt lgkmcnt(0)
    buffer_store_dwordx4 v[96:99], v13, s[4:7], 0 offen offset:2048 sc1
    v_mul_f32 v116, v116, v228
    v_mfma_f32_16x16x32_bf16 v[252:255], a[88:91], a[60:63], v[252:255]
    v_mul_f32 v117, v117, v229
    v_mul_f32 v118, v118, v230
    v_mfma_f32_16x16x32_bf16 v[248:251], a[88:91], a[56:59], v[248:251]
    v_mul_f32 v119, v119, v231
    v_cvt_pk_bf16_f32 v102, v116, v117
    v_mfma_f32_16x16x32_bf16 v[244:247], a[88:91], a[52:55], v[244:247]
    v_cvt_pk_bf16_f32 v103, v118, v119
    buffer_store_dwordx4 v[100:103], v14, s[4:7], 0 offen offset:2048 sc1
    v_mfma_f32_16x16x32_bf16 v[240:243], a[88:91], a[48:51], v[240:243]
    s_nop 7
    v_mul_f32 v120, v120, v232
    v_mul_f32 v121, v121, v233
    v_mul_f32 v122, v122, v234
    v_mul_f32 v123, v123, v235
    v_cvt_pk_bf16_f32 v106, v120, v121
    v_cvt_pk_bf16_f32 v107, v122, v123
    buffer_store_dwordx4 v[104:107], v15, s[4:7], 0 offen offset:2048 sc1
    v_mul_f32 v124, v124, v236
    v_mul_f32 v125, v125, v237
    v_mul_f32 v126, v126, v238
    v_mul_f32 v127, v127, v239
    v_cvt_pk_bf16_f32 v110, v124, v125
    v_cvt_pk_bf16_f32 v111, v126, v127
    buffer_store_dwordx4 v[108:111], v16, s[4:7], 0 offen offset:2048 sc1
    v_mul_f32 v128, v128, v240
    v_mul_f32 v129, v129, v241
    v_mul_f32 v130, v130, v242
    v_mul_f32 v131, v131, v243
    v_cvt_pk_bf16_f32 v128, v128, v129
    v_cvt_pk_bf16_f32 v129, v130, v131
    buffer_store_dwordx2 v[128:129], v13, s[4:7], 0 offen offset:3072 sc1
    v_mul_f32 v132, v132, v244
    v_mul_f32 v133, v133, v245
    v_mul_f32 v134, v134, v246
    v_mul_f32 v135, v135, v247
    v_cvt_pk_bf16_f32 v132, v132, v133
    v_cvt_pk_bf16_f32 v133, v134, v135
    buffer_store_dwordx2 v[132:133], v14, s[4:7], 0 offen offset:3072 sc1
    v_mul_f32 v136, v136, v248
    v_mul_f32 v137, v137, v249
    v_mul_f32 v138, v138, v250
    v_mul_f32 v139, v139, v251
    v_cvt_pk_bf16_f32 v136, v136, v137
    v_cvt_pk_bf16_f32 v137, v138, v139
    buffer_store_dwordx2 v[136:137], v15, s[4:7], 0 offen offset:3072 sc1
    v_mul_f32 v140, v140, v252
    v_mul_f32 v141, v141, v253
    v_mul_f32 v142, v142, v254
    v_mul_f32 v143, v143, v255
    v_cvt_pk_bf16_f32 v140, v140, v141
    v_cvt_pk_bf16_f32 v141, v142, v143
    buffer_store_dwordx2 v[140:141], v16, s[4:7], 0 offen offset:3072 sc1
    s_branch L4_fin
L4_epi1:
    s_waitcnt vmcnt(8)
    s_waitcnt lgkmcnt(8)
    v_mfma_f32_16x16x32_bf16 v[32:35], a[64:67], a[32:35], v[32:35]
    ds_read_b64_tr_b16 a[84:85], v3 offset:14368
    v_mfma_f32_16x16x32_bf16 v[36:39], a[64:67], a[36:39], v[36:39]
    ds_read_b64_tr_b16 a[86:87], v3 offset:17952
    v_mfma_f32_16x16x32_bf16 v[40:43], a[64:67], a[40:43], v[40:43]
    v_mfma_f32_16x16x32_bf16 v[44:47], a[64:67], a[44:47], v[44:47]
    s_waitcnt lgkmcnt(8)
    v_mfma_f32_16x16x32_bf16 v[156:159], a[68:71], a[44:47], v[156:159]
    ds_read_b64_tr_b16 a[88:89], v3 offset:7200
    v_mfma_f32_16x16x32_bf16 v[152:155], a[68:71], a[40:43], v[152:155]
    ds_read_b64_tr_b16 a[90:91], v3 offset:10784
    v_mfma_f32_16x16x32_bf16 v[148:151], a[68:71], a[36:39], v[148:151]
    v_mfma_f32_16x16x32_bf16 v[144:147], a[68:71], a[32:35], v[144:147]
    s_waitcnt vmcnt(0)
    s_waitcnt lgkmcnt(8)
    v_mfma_f32_16x16x32_bf16 v[32:35], a[72:75], a[48:51], v[32:35]
    ds_read_b64_tr_b16 a[64:65], v3 offset:21536
    v_mfma_f32_16x16x32_bf16 v[36:39], a[72:75], a[52:55], v[36:39]
    ds_read_b64_tr_b16 a[66:67], v3 offset:25120
    v_mfma_f32_16x16x32_bf16 v[40:43], a[72:75], a[56:59], v[40:43]
    v_mfma_f32_16x16x32_bf16 v[44:47], a[72:75], a[60:63], v[44:47]
    s_waitcnt lgkmcnt(8)
    v_mfma_f32_16x16x32_bf16 v[156:159], a[76:79], a[60:63], v[156:159]
    ds_read_b64_tr_b16 a[68:69], v3 offset:64
    v_mfma_f32_16x16x32_bf16 v[152:155], a[76:79], a[56:59], v[152:155]
    ds_read_b64_tr_b16 a[70:71], v3 offset:3648
    v_mfma_f32_16x16x32_bf16 v[148:151], a[76:79], a[52:55], v[148:151]
    v_mfma_f32_16x16x32_bf16 v[144:147], a[76:79], a[48:51], v[144:147]
    s_waitcnt lgkmcnt(8)
    v_mfma_f32_16x16x32_bf16 v[48:51], a[80:83], a[32:35], v[48:51]
    ds_read_b64_tr_b16 a[72:73], v3 offset:14400
    v_mfma_f32_16x16x32_bf16 v[52:55], a[80:83], a[36:39], v[52:55]
    ds_read_b64_tr_b16 a[74:75], v3 offset:17984
    v_mfma_f32_16x16x32_bf16 v[56:59], a[80:83], a[40:43], v[56:59]
    v_mfma_f32_16x16x32_bf16 v[60:63], a[80:83], a[44:47], v[60:63]
    s_waitcnt lgkmcnt(8)
    v_mfma_f32_16x16x32_bf16 v[172:175], a[84:87], a[44:47], v[172:175]
    ds_read_b64_tr_b16 a[76:77], v3 offset:7232
    v_mfma_f32_16x16x32_bf16 v[168:171], a[84:87], a[40:43], v[168:171]
    ds_read_b64_tr_b16 a[78:79], v3 offset:10816
    v_mul_f32 v32, v32, v144
    v_mfma_f32_16x16x32_bf16 v[164:167], a[84:87], a[36:39], v[164:167]
    v_mul_f32 v33, v33, v145
    v_mul_f32 v34, v34, v146
    v_mfma_f32_16x16x32_bf16 v[160:163], a[84:87], a[32:35], v[160:163]
    s_waitcnt lgkmcnt(8)
    v_mul_f32 v35, v35, v147
    v_cvt_pk_bf16_f32 v32, v32, v33
    v_mfma_f32_16x16x32_bf16 v[48:51], a[88:91], a[48:51], v[48:51]
    ds_read_b64_tr_b16 a[80:81], v3 offset:21568
    v_cvt_pk_bf16_f32 v33, v34, v35
    v_mfma_f32_16x16x32_bf16 v[52:55], a[88:91], a[52:55], v[52:55]
    ds_read_b64_tr_b16 a[82:83], v3 offset:25152
    v_mfma_f32_16x16x32_bf16 v[56:59], a[88:91], a[56:59], v[56:59]
    buffer_store_dwordx2 v[32:33], v13, s[4:7], 0 offen offset:8 sc1
    v_mul_f32 v36, v36, v148
    v_mfma_f32_16x16x32_bf16 v[60:63], a[88:91], a[60:63], v[60:63]
    s_waitcnt lgkmcnt(8)
    v_mul_f32 v37, v37, v149
    v_mul_f32 v38, v38, v150
    v_mfma_f32_16x16x32_bf16 v[172:175], a[64:67], a[60:63], v[172:175]
    ds_read_b64_tr_b16 a[84:85], v3 offset:96
    v_mul_f32 v39, v39, v151
    v_mfma_f32_16x16x32_bf16 v[168:171], a[64:67], a[56:59], v[168:171]
    ds_read_b64_tr_b16 a[86:87], v3 offset:3680
    v_cvt_pk_bf16_f32 v36, v36, v37
    v_mfma_f32_16x16x32_bf16 v[164:167], a[64:67], a[52:55], v[164:167]
    v_cvt_pk_bf16_f32 v37, v38, v39
    buffer_store_dwordx2 v[36:37], v14, s[4:7], 0 offen offset:8 sc1
    v_mfma_f32_16x16x32_bf16 v[160:163], a[64:67], a[48:51], v[160:163]
    s_waitcnt lgkmcnt(8)
    v_mul_f32 v40, v40, v152
    v_mul_f32 v41, v41, v153
    v_mfma_f32_16x16x32_bf16 v[64:67], a[68:71], a[32:35], v[64:67]
    ds_read_b64_tr_b16 a[88:89], v3 offset:14432
    v_mul_f32 v42, v42, v154
    v_mfma_f32_16x16x32_bf16 v[68:71], a[68:71], a[36:39], v[68:71]
    ds_read_b64_tr_b16 a[90:91], v3 offset:18016
    v_mul_f32 v43, v43, v155
    v_mfma_f32_16x16x32_bf16 v[72:75], a[68:71], a[40:43], v[72:75]
    v_cvt_pk_bf16_f32 v40, v40, v41
    v_cvt_pk_bf16_f32 v41, v42, v43
    v_mfma_f32_16x16x32_bf16 v[76:79], a[68:71], a[44:47], v[76:79]
    s_waitcnt lgkmcnt(8)
    buffer_store_dwordx2 v[40:41], v15, s[4:7], 0 offen offset:8 sc1
    v_mul_f32 v44, v44, v156
    v_mfma_f32_16x16x32_bf16 v[188:191], a[72:75], a[44:47], v[188:191]
    ds_read_b64_tr_b16 a[64:65], v3 offset:7264
    v_mul_f32 v45, v45, v157
    v_mfma_f32_16x16x32_bf16 v[184:187], a[72:75], a[40:43], v[184:187]
    ds_read_b64_tr_b16 a[66:67], v3 offset:10848
    v_mul_f32 v46, v46, v158
    v_mfma_f32_16x16x32_bf16 v[180:183], a[72:75], a[36:39], v[180:183]
    v_mul_f32 v47, v47, v159
    v_cvt_pk_bf16_f32 v44, v44, v45
    v_mfma_f32_16x16x32_bf16 v[176:179], a[72:75], a[32:35], v[176:179]
    s_waitcnt lgkmcnt(8)
    v_cvt_pk_bf16_f32 v45, v46, v47
    buffer_store_dwordx2 v[44:45], v16, s[4:7], 0 offen offset:8 sc1
    v_mfma_f32_16x16x32_bf16 v[64:67], a[76:79], a[48:51], v[64:67]
    ds_read_b64_tr_b16 a[68:69], v3 offset:21600
    v_mul_f32 v48, v48, v160
    v_mfma_f32_16x16x32_bf16 v[68:71], a[76:79], a[52:55], v[68:71]
    ds_read_b64_tr_b16 a[70:71], v3 offset:25184
    v_mul_f32 v49, v49, v161
    v_mfma_f32_16x16x32_bf16 v[72:75], a[76:79], a[56:59], v[72:75]
    v_mul_f32 v50, v50, v162
    v_mul_f32 v51, v51, v163
    v_mfma_f32_16x16x32_bf16 v[76:79], a[76:79], a[60:63], v[76:79]
    s_waitcnt lgkmcnt(8)
    v_cvt_pk_bf16_f32 v48, v48, v49
    v_cvt_pk_bf16_f32 v49, v50, v51
    v_mfma_f32_16x16x32_bf16 v[188:191], a[80:83], a[60:63], v[188:191]
    ds_read_b64_tr_b16 a[72:73], v3 offset:128
    v_mul_f32 v52, v52, v164
    v_mfma_f32_16x16x32_bf16 v[184:187], a[80:83], a[56:59], v[184:187]
    ds_read_b64_tr_b16 a[74:75], v3 offset:3712
    v_mul_f32 v53, v53, v165
    v_mfma_f32_16x16x32_bf16 v[180:183], a[80:83], a[52:55], v[180:183]
    v_mul_f32 v54, v54, v166
    v_mul_f32 v55, v55, v167
    v_mfma_f32_16x16x32_bf16 v[176:179], a[80:83], a[48:51], v[176:179]
    s_waitcnt lgkmcnt(8)
    v_cvt_pk_bf16_f32 v52, v52, v53
    v_cvt_pk_bf16_f32 v53, v54, v55
    v_mfma_f32_16x16x32_bf16 v[80:83], a[84:87], a[32:35], v[80:83]
    ds_read_b64_tr_b16 a[76:77], v3 offset:14464
    v_mul_f32 v56, v56, v168
    v_mfma_f32_16x16x32_bf16 v[84:87], a[84:87], a[36:39], v[84:87]
    ds_read_b64_tr_b16 a[78:79], v3 offset:18048
    v_mul_f32 v57, v57, v169
    v_mfma_f32_16x16x32_bf16 v[88:91], a[84:87], a[40:43], v[88:91]
    v_mul_f32 v58, v58, v170
    v_mul_f32 v59, v59, v171
    v_mfma_f32_16x16x32_bf16 v[92:95], a[84:87], a[44:47], v[92:95]
    s_waitcnt lgkmcnt(8)
    v_cvt_pk_bf16_f32 v56, v56, v57
    v_cvt_pk_bf16_f32 v57, v58, v59
    v_mfma_f32_16x16x32_bf16 v[204:207], a[88:91], a[44:47], v[204:207]
    ds_read_b64_tr_b16 a[80:81], v3 offset:7296
    v_mul_f32 v60, v60, v172
    v_mfma_f32_16x16x32_bf16 v[200:203], a[88:91], a[40:43], v[200:203]
    ds_read_b64_tr_b16 a[82:83], v3 offset:10880
    v_mul_f32 v61, v61, v173
    v_mfma_f32_16x16x32_bf16 v[196:199], a[88:91], a[36:39], v[196:199]
    v_mul_f32 v62, v62, v174
    v_mul_f32 v63, v63, v175
    v_mfma_f32_16x16x32_bf16 v[192:195], a[88:91], a[32:35], v[192:195]
    s_waitcnt lgkmcnt(8)
    v_cvt_pk_bf16_f32 v60, v60, v61
    v_cvt_pk_bf16_f32 v61, v62, v63
    v_mfma_f32_16x16x32_bf16 v[80:83], a[64:67], a[48:51], v[80:83]
    ds_read_b64_tr_b16 a[84:85], v3 offset:21632
    v_mul_f32 v64, v64, v176
    v_mfma_f32_16x16x32_bf16 v[84:87], a[64:67], a[52:55], v[84:87]
    ds_read_b64_tr_b16 a[86:87], v3 offset:25216
    v_mul_f32 v65, v65, v177
    v_mfma_f32_16x16x32_bf16 v[88:91], a[64:67], a[56:59], v[88:91]
    v_mul_f32 v66, v66, v178
    v_mul_f32 v67, v67, v179
    v_mfma_f32_16x16x32_bf16 v[92:95], a[64:67], a[60:63], v[92:95]
    s_waitcnt lgkmcnt(8)
    v_cvt_pk_bf16_f32 v50, v64, v65
    v_cvt_pk_bf16_f32 v51, v66, v67
    v_mfma_f32_16x16x32_bf16 v[204:207], a[68:71], a[60:63], v[204:207]
    ds_read_b64_tr_b16 a[88:89], v3 offset:160
    v_mfma_f32_16x16x32_bf16 v[200:203], a[68:71], a[56:59], v[200:203]
    ds_read_b64_tr_b16 a[90:91], v3 offset:3744
    v_mfma_f32_16x16x32_bf16 v[196:199], a[68:71], a[52:55], v[196:199]
    buffer_store_dwordx4 v[48:51], v13, s[4:7], 0 offen offset:1024 sc1
    v_mul_f32 v68, v68, v180
    v_mfma_f32_16x16x32_bf16 v[192:195], a[68:71], a[48:51], v[192:195]
    s_waitcnt lgkmcnt(8)
    v_mul_f32 v69, v69, v181
    v_mul_f32 v70, v70, v182
    v_mfma_f32_16x16x32_bf16 v[96:99], a[72:75], a[32:35], v[96:99]
    ds_read_b64_tr_b16 a[64:65], v3 offset:14496
    v_mul_f32 v71, v71, v183
    v_mfma_f32_16x16x32_bf16 v[100:103], a[72:75], a[36:39], v[100:103]
    ds_read_b64_tr_b16 a[66:67], v3 offset:18080
    v_cvt_pk_bf16_f32 v54, v68, v69
    v_mfma_f32_16x16x32_bf16 v[104:107], a[72:75], a[40:43], v[104:107]
    v_cvt_pk_bf16_f32 v55, v70, v71
    buffer_store_dwordx4 v[52:55], v14, s[4:7], 0 offen offset:1024 sc1
    v_mfma_f32_16x16x32_bf16 v[108:111], a[72:75], a[44:47], v[108:111]
    s_waitcnt lgkmcnt(8)
    v_mul_f32 v72, v72, v184
    v_mul_f32 v73, v73, v185
    v_mfma_f32_16x16x32_bf16 v[220:223], a[76:79], a[44:47], v[220:223]
    ds_read_b64_tr_b16 a[68:69], v3 offset:7328
    v_mul_f32 v74, v74, v186
    v_mfma_f32_16x16x32_bf16 v[216:219], a[76:79], a[40:43], v[216:219]
    ds_read_b64_tr_b16 a[70:71], v3 offset:10912
    v_mul_f32 v75, v75, v187
    v_mfma_f32_16x16x32_bf16 v[212:215], a[76:79], a[36:39], v[212:215]
    v_cvt_pk_bf16_f32 v58, v72, v73
    v_cvt_pk_bf16_f32 v59, v74, v75
    v_mfma_f32_16x16x32_bf16 v[208:211], a[76:79], a[32:35], v[208:211]
    s_waitcnt lgkmcnt(8)
    buffer_store_dwordx4 v[56:59], v15, s[4:7], 0 offen offset:1024 sc1
    v_mul_f32 v76, v76, v188
    v_mfma_f32_16x16x32_bf16 v[96:99], a[80:83], a[48:51], v[96:99]
    ds_read_b64_tr_b16 a[72:73], v3 offset:21664
    v_mul_f32 v77, v77, v189
    v_mfma_f32_16x16x32_bf16 v[100:103], a[80:83], a[52:55], v[100:103]
    ds_read_b64_tr_b16 a[74:75], v3 offset:25248
    v_mul_f32 v78, v78, v190
    v_mfma_f32_16x16x32_bf16 v[104:107], a[80:83], a[56:59], v[104:107]
    v_mul_f32 v79, v79, v191
    v_cvt_pk_bf16_f32 v62, v76, v77
    v_mfma_f32_16x16x32_bf16 v[108:111], a[80:83], a[60:63], v[108:111]
    s_waitcnt lgkmcnt(8)
    v_cvt_pk_bf16_f32 v63, v78, v79
    buffer_store_dwordx4 v[60:63], v16, s[4:7], 0 offen offset:1024 sc1
    v_mfma_f32_16x16x32_bf16 v[220:223], a[84:87], a[60:63], v[220:223]
    ds_read_b64_tr_b16 a[76:77], v3 offset:192
    v_mul_f32 v80, v80, v192
    v_mfma_f32_16x16x32_bf16 v[216:219], a[84:87], a[56:59], v[216:219]
    ds_read_b64_tr_b16 a[78:79], v3 offset:3776
    v_mul_f32 v81, v81, v193
    v_mfma_f32_16x16x32_bf16 v[212:215], a[84:87], a[52:55], v[212:215]
    v_mul_f32 v82, v82, v194
    v_mul_f32 v83, v83, v195
    v_mfma_f32_16x16x32_bf16 v[208:211], a[84:87], a[48:51], v[208:211]
    s_waitcnt lgkmcnt(8)
    v_cvt_pk_bf16_f32 v80, v80, v81
    v_cvt_pk_bf16_f32 v81, v82, v83
    v_mfma_f32_16x16x32_bf16 v[112:115], a[88:91], a[32:35], v[112:115]
    ds_read_b64_tr_b16 a[80:81], v3 offset:14528
    v_mul_f32 v84, v84, v196
    v_mfma_f32_16x16x32_bf16 v[116:119], a[88:91], a[36:39], v[116:119]
    ds_read_b64_tr_b16 a[82:83], v3 offset:18112
    v_mul_f32 v85, v85, v197
    v_mfma_f32_16x16x32_bf16 v[120:123], a[88:91], a[40:43], v[120:123]
    v_mul_f32 v86, v86, v198
    v_mul_f32 v87, v87, v199
    v_mfma_f32_16x16x32_bf16 v[124:127], a[88:91], a[44:47], v[124:127]
    s_waitcnt lgkmcnt(8)
    v_cvt_pk_bf16_f32 v84, v84, v85
    v_cvt_pk_bf16_f32 v85, v86, v87
    v_mfma_f32_16x16x32_bf16 v[236:239], a[64:67], a[44:47], v[236:239]
    ds_read_b64_tr_b16 a[84:85], v3 offset:7360
    v_mul_f32 v88, v88, v200
    v_mfma_f32_16x16x32_bf16 v[232:235], a[64:67], a[40:43], v[232:235]
    ds_read_b64_tr_b16 a[86:87], v3 offset:10944
    v_mul_f32 v89, v89, v201
    v_mfma_f32_16x16x32_bf16 v[228:231], a[64:67], a[36:39], v[228:231]
    v_mul_f32 v90, v90, v202
    v_mul_f32 v91, v91, v203
    v_mfma_f32_16x16x32_bf16 v[224:227], a[64:67], a[32:35], v[224:227]
    s_waitcnt lgkmcnt(8)
    v_cvt_pk_bf16_f32 v88, v88, v89
    v_cvt_pk_bf16_f32 v89, v90, v91
    v_mfma_f32_16x16x32_bf16 v[112:115], a[68:71], a[48:51], v[112:115]
    ds_read_b64_tr_b16 a[88:89], v3 offset:21696
    v_mul_f32 v92, v92, v204
    v_mfma_f32_16x16x32_bf16 v[116:119], a[68:71], a[52:55], v[116:119]
    ds_read_b64_tr_b16 a[90:91], v3 offset:25280
    v_mul_f32 v93, v93, v205
    v_mfma_f32_16x16x32_bf16 v[120:123], a[68:71], a[56:59], v[120:123]
    v_mul_f32 v94, v94, v206
    v_mul_f32 v95, v95, v207
    v_mfma_f32_16x16x32_bf16 v[124:127], a[68:71], a[60:63], v[124:127]
    s_waitcnt lgkmcnt(8)
    v_cvt_pk_bf16_f32 v92, v92, v93
    v_cvt_pk_bf16_f32 v93, v94, v95
    v_mfma_f32_16x16x32_bf16 v[236:239], a[72:75], a[60:63], v[236:239]
    v_mul_f32 v96, v96, v208
    v_mul_f32 v97, v97, v209
    v_mfma_f32_16x16x32_bf16 v[232:235], a[72:75], a[56:59], v[232:235]
    v_mul_f32 v98, v98, v210
    v_mul_f32 v99, v99, v211
    v_mfma_f32_16x16x32_bf16 v[228:231], a[72:75], a[52:55], v[228:231]
    v_cvt_pk_bf16_f32 v82, v96, v97
    v_cvt_pk_bf16_f32 v83, v98, v99
    v_mfma_f32_16x16x32_bf16 v[224:227], a[72:75], a[48:51], v[224:227]
    s_waitcnt lgkmcnt(6)
    buffer_store_dwordx4 v[80:83], v13, s[4:7], 0 offen offset:2048 sc1
    v_mul_f32 v100, v100, v212
    v_mfma_f32_16x16x32_bf16 v[128:131], a[76:79], a[32:35], v[128:131]
    v_mul_f32 v101, v101, v213
    v_mul_f32 v102, v102, v214
    v_mfma_f32_16x16x32_bf16 v[132:135], a[76:79], a[36:39], v[132:135]
    v_mul_f32 v103, v103, v215
    v_cvt_pk_bf16_f32 v86, v100, v101
    v_mfma_f32_16x16x32_bf16 v[136:139], a[76:79], a[40:43], v[136:139]
    v_cvt_pk_bf16_f32 v87, v102, v103
    buffer_store_dwordx4 v[84:87], v14, s[4:7], 0 offen offset:2048 sc1
    v_mfma_f32_16x16x32_bf16 v[140:143], a[76:79], a[44:47], v[140:143]
    s_waitcnt lgkmcnt(4)
    v_mul_f32 v104, v104, v216
    v_mul_f32 v105, v105, v217
    v_mfma_f32_16x16x32_bf16 v[252:255], a[80:83], a[44:47], v[252:255]
    v_mul_f32 v106, v106, v218
    v_mul_f32 v107, v107, v219
    v_mfma_f32_16x16x32_bf16 v[248:251], a[80:83], a[40:43], v[248:251]
    v_cvt_pk_bf16_f32 v90, v104, v105
    v_cvt_pk_bf16_f32 v91, v106, v107
    v_mfma_f32_16x16x32_bf16 v[244:247], a[80:83], a[36:39], v[244:247]
    buffer_store_dwordx4 v[88:91], v15, s[4:7], 0 offen offset:2048 sc1
    v_mul_f32 v108, v108, v220
    v_mfma_f32_16x16x32_bf16 v[240:243], a[80:83], a[32:35], v[240:243]
    s_waitcnt lgkmcnt(2)
    v_mul_f32 v109, v109, v221
    v_mul_f32 v110, v110, v222
    v_mfma_f32_16x16x32_bf16 v[128:131], a[84:87], a[48:51], v[128:131]
    v_mul_f32 v111, v111, v223
    v_cvt_pk_bf16_f32 v94, v108, v109
    v_mfma_f32_16x16x32_bf16 v[132:135], a[84:87], a[52:55], v[132:135]
    v_cvt_pk_bf16_f32 v95, v110, v111
    buffer_store_dwordx4 v[92:95], v16, s[4:7], 0 offen offset:2048 sc1
    v_mfma_f32_16x16x32_bf16 v[136:139], a[84:87], a[56:59], v[136:139]
    v_mul_f32 v112, v112, v224
    v_mul_f32 v113, v113, v225
    v_mfma_f32_16x16x32_bf16 v[140:143], a[84:87], a[60:63], v[140:143]
    s_waitcnt lgkmcnt(0)
    v_mul_f32 v114, v114, v226
    v_mul_f32 v115, v115, v227
    v_mfma_f32_16x16x32_bf16 v[252:255], a[88:91], a[60:63], v[252:255]
    v_cvt_pk_bf16_f32 v112, v112, v113
    v_cvt_pk_bf16_f32 v113, v114, v115
    v_mfma_f32_16x16x32_bf16 v[248:251], a[88:91], a[56:59], v[248:251]
    v_mul_f32 v116, v116, v228
    v_mul_f32 v117, v117, v229
    v_mfma_f32_16x16x32_bf16 v[244:247], a[88:91], a[52:55], v[244:247]
    v_mul_f32 v118, v118, v230
    v_mul_f32 v119, v119, v231
    v_mfma_f32_16x16x32_bf16 v[240:243], a[88:91], a[48:51], v[240:243]
    s_nop 7
    v_cvt_pk_bf16_f32 v116, v116, v117
    v_cvt_pk_bf16_f32 v117, v118, v119
    v_mul_f32 v120, v120, v232
    v_mul_f32 v121, v121, v233
    v_mul_f32 v122, v122, v234
    v_mul_f32 v123, v123, v235
    v_cvt_pk_bf16_f32 v120, v120, v121
    v_cvt_pk_bf16_f32 v121, v122, v123
    v_mul_f32 v124, v124, v236
    v_mul_f32 v125, v125, v237
    v_mul_f32 v126, v126, v238
    v_mul_f32 v127, v127, v239
    v_cvt_pk_bf16_f32 v124, v124, v125
    v_cvt_pk_bf16_f32 v125, v126, v127
    v_mul_f32 v128, v128, v240
    v_mul_f32 v129, v129, v241
    v_mul_f32 v130, v130, v242
    v_mul_f32 v131, v131, v243
    v_cvt_pk_bf16_f32 v114, v128, v129
    v_cvt_pk_bf16_f32 v115, v130, v131
    buffer_store_dwordx4 v[112:115], v13, s[4:7], 0 offen offset:3072 sc1
    v_mul_f32 v132, v132, v244
    v_mul_f32 v133, v133, v245
    v_mul_f32 v134, v134, v246
    v_mul_f32 v135, v135, v247
    v_cvt_pk_bf16_f32 v118, v132, v133
    v_cvt_pk_bf16_f32 v119, v134, v135
    buffer_store_dwordx4 v[116:119], v14, s[4:7], 0 offen offset:3072 sc1
    v_mul_f32 v136, v136, v248
    v_mul_f32 v137, v137, v249
    v_mul_f32 v138, v138, v250
    v_mul_f32 v139, v139, v251
    v_cvt_pk_bf16_f32 v122, v136, v137
    v_cvt_pk_bf16_f32 v123, v138, v139
    buffer_store_dwordx4 v[120:123], v15, s[4:7], 0 offen offset:3072 sc1
    v_mul_f32 v140, v140, v252
    v_mul_f32 v141, v141, v253
    v_mul_f32 v142, v142, v254
    v_mul_f32 v143, v143, v255
    v_cvt_pk_bf16_f32 v126, v140, v141
    v_cvt_pk_bf16_f32 v127, v142, v143
    buffer_store_dwordx4 v[124:127], v16, s[4:7], 0 offen offset:3072 sc1
L4_fin:

    v_lshrrev_b32 v28, 2, v1
    v_lshlrev_b32 v29, 8, v28
    v_and_b32 v31, 7, v28
    v_lshlrev_b32 v31, 5, v31
    v_add_u32 v29, v29, v31
    v_and_b32 v31, 3, v1
    v_lshlrev_b32 v31, 3, v31
    v_add_u32 v29, v29, v31
    s_lshl_b32 s16, s70, 7
    s_xor_b32 s17, s16, 0
    v_xor_b32 v2, s17, v29
    s_xor_b32 s17, s16, 32
    v_xor_b32 v3, s17, v29
    s_xor_b32 s17, s16, 64
    v_xor_b32 v4, s17, v29
    s_xor_b32 s17, s16, 96
    v_xor_b32 v5, s17, v29
    s_xor_b32 s17, s16, 128
    v_xor_b32 v6, s17, v29
    s_xor_b32 s17, s16, 160
    v_xor_b32 v7, s17, v29
    s_xor_b32 s17, s16, 192
    v_xor_b32 v8, s17, v29
    s_xor_b32 s17, s16, 224
    v_xor_b32 v9, s17, v29
    s_lshl_b32 s16, s68, 2
    s_add_u32 s16, s16, s20
    s_mul_i32 s16, s16, 229376
    s_mul_i32 s17, s70, 57344
    s_add_u32 s16, s16, s17
    s_add_u32 s16, s16, 20971520
    v_lshlrev_b32 v28, 4, v1
    v_add_u32 v26, s16, v28
    v_add_u32 v27, 114688, v26
    s_mov_b32 s24, 0
    s_mov_b32 s29, 57344
    v_mov_b32 v32, 0
    v_mov_b32 v33, 0
    v_mov_b32 v34, 0
    v_mov_b32 v35, 0
    v_mov_b32 v36, 0
    v_mov_b32 v37, 0
    v_mov_b32 v38, 0
    v_mov_b32 v39, 0
    v_mov_b32 v40, 0
    v_mov_b32 v41, 0
    v_mov_b32 v42, 0
    v_mov_b32 v43, 0
    v_mov_b32 v44, 0
    v_mov_b32 v45, 0
    v_mov_b32 v46, 0
    v_mov_b32 v47, 0
    v_mov_b32 v48, 0
    v_mov_b32 v49, 0
    v_mov_b32 v50, 0
    v_mov_b32 v51, 0
    v_mov_b32 v52, 0
    v_mov_b32 v53, 0
    v_mov_b32 v54, 0
    v_mov_b32 v55, 0
    v_mov_b32 v56, 0
    v_mov_b32 v57, 0
    v_mov_b32 v58, 0
    v_mov_b32 v59, 0
    v_mov_b32 v60, 0
    v_mov_b32 v61, 0
    v_mov_b32 v62, 0
    v_mov_b32 v63, 0
    v_mov_b32 v64, 0
    v_mov_b32 v65, 0
    v_mov_b32 v66, 0
    v_mov_b32 v67, 0
    v_mov_b32 v68, 0
    v_mov_b32 v69, 0
    v_mov_b32 v70, 0
    v_mov_b32 v71, 0
    v_mov_b32 v72, 0
    v_mov_b32 v73, 0
    v_mov_b32 v74, 0
    v_mov_b32 v75, 0
    v_mov_b32 v76, 0
    v_mov_b32 v77, 0
    v_mov_b32 v78, 0
    v_mov_b32 v79, 0
    v_mov_b32 v80, 0
    v_mov_b32 v81, 0
    v_mov_b32 v82, 0
    v_mov_b32 v83, 0
    v_mov_b32 v84, 0
    v_mov_b32 v85, 0
    v_mov_b32 v86, 0
    v_mov_b32 v87, 0
    v_mov_b32 v88, 0
    v_mov_b32 v89, 0
    v_mov_b32 v90, 0
    v_mov_b32 v91, 0
    v_mov_b32 v92, 0
    v_mov_b32 v93, 0
    v_mov_b32 v94, 0
    v_mov_b32 v95, 0
    s_lshl_b32 s26, s20, 13
    s_mov_b32 s25, 0
    s_waitcnt vmcnt(0)
    s_barrier
    s_cmp_eq_u32 s20, 1
    s_cbranch_scc0 Lh0_16
    s_lshr_b32 s16, s34, 4
    s_lshl_b32 s17, s35, 1
    s_add_u32 s16, s16, s17
    s_lshl_b32 s16, s16, 3
    s_lshl_b32 s16, s16, 8
    s_add_u32 s16, s16, 42123264
    v_lshlrev_b32 v28, 8, v1
    v_mov_b32 v31, 0x10000000
    v_cmp_gt_u32 vcc, 8, v1
    s_nop 1
    v_cndmask_b32 v28, v31, v28, vcc
    v_mov_b32 v31, 1
    buffer_atomic_add v31, v28, s[4:7], s16 offen sc1
Lh0_16:
    s_cmp_eq_u32 s20, 0
    s_cbranch_scc0 Lh1_17
    s_lshr_b32 s16, s68, 1
    s_lshl_b32 s16, s16, 1
    s_add_u32 s16, s16, s70
    s_lshl_b32 s16, s16, 3
    s_add_u32 s16, s16, s69
    s_lshl_b32 s16, s16, 8
    s_add_u32 s16, s16, 42123264
    s_mov_b32 s74, s16
    buffer_load_dword v31, v30, s[4:7], s74 offen sc1
Lh1_17:
    s_cmp_lg_u32 s20, 0
    s_cbranch_scc1 Lf5w_15
    s_waitcnt vmcnt(0)
    s_branch Lf5_14
Lf5w_15:
    s_add_u32 s18, s25, 0
    s_add_u32 m0, s26, 0
    s_nop 0
    buffer_load_dwordx4 v18, s[12:15], s18 offen offset:0 lds
    buffer_load_dwordx4 v19, s[12:15], s18 offen offset:1024 lds
    buffer_load_dwordx4 v20, s[12:15], s18 offen offset:2048 lds
    buffer_load_dwordx4 v21, s[12:15], s18 offen offset:3072 lds
    s_add_u32 m0, s26, 4096
    s_nop 0
    buffer_load_dwordx4 v22, s[12:15], s18 offen offset:0 lds
    buffer_load_dwordx4 v23, s[12:15], s18 offen offset:1024 lds
    buffer_load_dwordx4 v24, s[12:15], s18 offen offset:2048 lds
    buffer_load_dwordx4 v25, s[12:15], s18 offen offset:3072 lds
    s_add_u32 s18, s25, 262144
    s_add_u32 m0, s26, 32768
    s_nop 0
    buffer_load_dwordx4 v18, s[12:15], s18 offen offset:0 lds
    buffer_load_dwordx4 v19, s[12:15], s18 offen offset:1024 lds
    buffer_load_dwordx4 v20, s[12:15], s18 offen offset:2048 lds
    buffer_load_dwordx4 v21, s[12:15], s18 offen offset:3072 lds
    s_add_u32 m0, s26, 36864
    s_nop 0
    buffer_load_dwordx4 v22, s[12:15], s18 offen offset:0 lds
    buffer_load_dwordx4 v23, s[12:15], s18 offen offset:1024 lds
    buffer_load_dwordx4 v24, s[12:15], s18 offen offset:2048 lds
    buffer_load_dwordx4 v25, s[12:15], s18 offen offset:3072 lds
    s_add_u32 s18, s25, 524288
    s_add_u32 m0, s26, 65536
    s_nop 0
    buffer_load_dwordx4 v18, s[12:15], s18 offen offset:0 lds
    buffer_load_dwordx4 v19, s[12:15], s18 offen offset:1024 lds
    s_cmp_eq_u32 s20, 1
    s_cbranch_scc0 Lf5_14
    v_subrev_u32 v116, 65536, v18
    v_subrev_u32 v117, 65536, v19
    v_subrev_u32 v118, 65536, v20
    v_subrev_u32 v119, 65536, v21
    v_subrev_u32 v120, 65536, v22
    v_subrev_u32 v121, 65536, v23
    v_subrev_u32 v122, 65536, v24
    v_subrev_u32 v123, 65536, v25
    s_sub_u32 s17, s26, 8192
    s_add_u32 s18, s25, 0
    s_add_u32 m0, s17, 0
    s_nop 0
    buffer_load_dwordx4 v116, s[12:15], s18 offen offset:0 lds
    buffer_load_dwordx4 v117, s[12:15], s18 offen offset:1024 lds
    buffer_load_dwordx4 v118, s[12:15], s18 offen offset:2048 lds
    buffer_load_dwordx4 v119, s[12:15], s18 offen offset:3072 lds
    s_add_u32 m0, s17, 4096
    s_nop 0
    buffer_load_dwordx4 v120, s[12:15], s18 offen offset:0 lds
    buffer_load_dwordx4 v121, s[12:15], s18 offen offset:1024 lds
    buffer_load_dwordx4 v122, s[12:15], s18 offen offset:2048 lds
    buffer_load_dwordx4 v123, s[12:15], s18 offen offset:3072 lds
    s_add_u32 s18, s25, 262144
    s_add_u32 m0, s17, 32768
    s_nop 0
    buffer_load_dwordx4 v116, s[12:15], s18 offen offset:0 lds
    buffer_load_dwordx4 v117, s[12:15], s18 offen offset:1024 lds
    buffer_load_dwordx4 v118, s[12:15], s18 offen offset:2048 lds
    buffer_load_dwordx4 v119, s[12:15], s18 offen offset:3072 lds
    s_add_u32 m0, s17, 36864
    s_nop 0
    buffer_load_dwordx4 v120, s[12:15], s18 offen offset:0 lds
    buffer_load_dwordx4 v121, s[12:15], s18 offen offset:1024 lds
    buffer_load_dwordx4 v122, s[12:15], s18 offen offset:2048 lds
    buffer_load_dwordx4 v123, s[12:15], s18 offen offset:3072 lds
    s_add_u32 s18, s25, 524288
    s_add_u32 m0, s17, 65536
    s_nop 0
    buffer_load_dwordx4 v116, s[12:15], s18 offen offset:0 lds
    buffer_load_dwordx4 v117, s[12:15], s18 offen offset:1024 lds
Lf5_14:
    s_add_u32 s25, s25, 524288
    s_add_u32 s26, s26, 65536
    s_mov_b32 m0, s26
    s_cmp_eq_u32 s20, 0
    s_cbranch_scc0 Lh2_18
    s_waitcnt vmcnt(0)
    v_readfirstlane_b32 s17, v31
    s_cmp_ge_u32 s17, 16
    s_cbranch_scc1 Lh2_18
    s_mov_b32 s19, 0
Lhp_19:
    s_add_u32 s19, s19, 1
    s_cmp_gt_u32 s19, 300000
    s_cbranch_scc1 Lh2_18
    buffer_load_dword v31, v30, s[4:7], s74 offen sc1
    s_waitcnt vmcnt(0)
    v_readfirstlane_b32 s17, v31
    s_cmp_ge_u32 s17, 16
    s_cbranch_scc0 Lhp_19
Lh2_18:
    s_barrier
    buffer_load_dwordx4 a[0:3], v26, s[4:7], s24 offen sc1
    buffer_load_dwordx4 a[4:7], v27, s[4:7], s24 offen sc1
    s_add_u32 s24, s24, 1024
    buffer_load_dwordx4 a[8:11], v26, s[4:7], s24 offen sc1
    buffer_load_dwordx4 a[12:15], v27, s[4:7], s24 offen sc1
    s_add_u32 s24, s24, 1024
    buffer_load_dwordx4 a[16:19], v26, s[4:7], s24 offen sc1
    buffer_load_dwordx4 a[20:23], v27, s[4:7], s24 offen sc1
    s_add_u32 s24, s24, 1024
    buffer_load_dwordx4 a[24:27], v26, s[4:7], s24 offen sc1
    buffer_load_dwordx4 a[28:31], v27, s[4:7], s24 offen sc1
    s_add_u32 s24, s24, 1024
    buffer_load_dwordx4 a[32:35], v26, s[4:7], s24 offen sc1
    buffer_load_dwordx4 a[36:39], v27, s[4:7], s24 offen sc1
    s_add_u32 s24, s24, 1024
    buffer_load_dwordx4 a[40:43], v26, s[4:7], s24 offen sc1
    buffer_load_dwordx4 a[44:47], v27, s[4:7], s24 offen sc1
    s_add_u32 s24, s24, 1024
    buffer_load_dwordx4 a[48:51], v26, s[4:7], s24 offen sc1
    buffer_load_dwordx4 a[52:55], v27, s[4:7], s24 offen sc1
    s_add_u32 s24, s24, 1024
    s_waitcnt vmcnt(24)
    s_barrier
    ds_read_b64_tr_b16 a[64:65], v2 offset:0
    ds_read_b64_tr_b16 a[66:67], v2 offset:4096
    ds_read_b64_tr_b16 a[68:69], v3 offset:0
    ds_read_b64_tr_b16 a[70:71], v3 offset:4096
    ds_read_b64_tr_b16 a[72:73], v4 offset:0
    ds_read_b64_tr_b16 a[74:75], v4 offset:4096
    ds_read_b64_tr_b16 a[76:77], v5 offset:0
    ds_read_b64_tr_b16 a[78:79], v5 offset:4096
    ds_read_b64_tr_b16 a[80:81], v6 offset:0
    ds_read_b64_tr_b16 a[82:83], v6 offset:4096
    ds_read_b64_tr_b16 a[84:85], v7 offset:0
    ds_read_b64_tr_b16 a[86:87], v7 offset:4096
    ds_read_b64_tr_b16 a[88:89], v8 offset:0
    ds_read_b64_tr_b16 a[90:91], v8 offset:4096
    ds_read_b64_tr_b16 a[92:93], v9 offset:0
    ds_read_b64_tr_b16 a[94:95], v9 offset:4096
    s_mov_b32 s28, 6
.p2align 6
L5_loop:
    s_waitcnt vmcnt(12)
    s_waitcnt lgkmcnt(14)
    v_mfma_f32_16x16x32_bf16 v[32:35], a[64:67], a[0:3], v[32:35]
    ds_read_b64_tr_b16 a[96:97], v2 offset:8192
    v_mfma_f32_16x16x32_bf16 v[36:39], a[64:67], a[4:7], v[36:39]
    s_waitcnt lgkmcnt(13)
    ds_read_b64_tr_b16 a[98:99], v2 offset:12288
    v_mfma_f32_16x16x32_bf16 v[44:47], a[68:71], a[4:7], v[44:47]
    ds_read_b64_tr_b16 a[100:101], v3 offset:8192
    buffer_load_dwordx4 a[56:59], v26, s[4:7], s24 offen sc1
    v_mfma_f32_16x16x32_bf16 v[40:43], a[68:71], a[0:3], v[40:43]
    s_waitcnt lgkmcnt(13)
    ds_read_b64_tr_b16 a[102:103], v3 offset:12288
    v_mfma_f32_16x16x32_bf16 v[48:51], a[72:75], a[0:3], v[48:51]
    ds_read_b64_tr_b16 a[104:105], v4 offset:8192
    v_mfma_f32_16x16x32_bf16 v[52:55], a[72:75], a[4:7], v[52:55]
    s_waitcnt lgkmcnt(13)
    ds_read_b64_tr_b16 a[106:107], v4 offset:12288
    buffer_load_dwordx4 v20, s[12:15], s25 offen offset:2048 lds
    v_mfma_f32_16x16x32_bf16 v[60:63], a[76:79], a[4:7], v[60:63]
    ds_read_b64_tr_b16 a[108:109], v5 offset:8192
    v_mfma_f32_16x16x32_bf16 v[56:59], a[76:79], a[0:3], v[56:59]
    s_waitcnt lgkmcnt(13)
    ds_read_b64_tr_b16 a[110:111], v5 offset:12288
    v_mfma_f32_16x16x32_bf16 v[64:67], a[80:83], a[0:3], v[64:67]
    ds_read_b64_tr_b16 a[112:113], v6 offset:8192
    buffer_load_dwordx4 a[60:63], v27, s[4:7], s24 offen sc1
    v_mfma_f32_16x16x32_bf16 v[68:71], a[80:83], a[4:7], v[68:71]
    s_waitcnt lgkmcnt(13)
    ds_read_b64_tr_b16 a[114:115], v6 offset:12288
    s_add_u32 s24, s24, 1024
    v_mfma_f32_16x16x32_bf16 v[76:79], a[84:87], a[4:7], v[76:79]
    ds_read_b64_tr_b16 a[116:117], v7 offset:8192
    s_cmp_ge_u32 s24, s29
    v_mfma_f32_16x16x32_bf16 v[72:75], a[84:87], a[0:3], v[72:75]
    s_waitcnt lgkmcnt(13)
    ds_read_b64_tr_b16 a[118:119], v7 offset:12288
    s_cselect_b32 s24, 0x10000000, s24
    v_mfma_f32_16x16x32_bf16 v[80:83], a[88:91], a[0:3], v[80:83]
    ds_read_b64_tr_b16 a[120:121], v8 offset:8192
    v_mfma_f32_16x16x32_bf16 v[84:87], a[88:91], a[4:7], v[84:87]
    s_waitcnt lgkmcnt(13)
    ds_read_b64_tr_b16 a[122:123], v8 offset:12288
    buffer_load_dwordx4 v21, s[12:15], s25 offen offset:3072 lds
    v_mfma_f32_16x16x32_bf16 v[92:95], a[92:95], a[4:7], v[92:95]
    ds_read_b64_tr_b16 a[124:125], v9 offset:8192
    v_mfma_f32_16x16x32_bf16 v[88:91], a[92:95], a[0:3], v[88:91]
    ds_read_b64_tr_b16 a[126:127], v9 offset:12288
    s_waitcnt vmcnt(14)
    s_waitcnt lgkmcnt(14)
    v_mfma_f32_16x16x32_bf16 v[32:35], a[96:99], a[8:11], v[32:35]
    ds_read_b64_tr_b16 a[64:65], v2 offset:16384
    v_mfma_f32_16x16x32_bf16 v[36:39], a[96:99], a[12:15], v[36:39]
    s_waitcnt lgkmcnt(13)
    ds_read_b64_tr_b16 a[66:67], v2 offset:20480
    v_mfma_f32_16x16x32_bf16 v[44:47], a[100:103], a[12:15], v[44:47]
    ds_read_b64_tr_b16 a[68:69], v3 offset:16384
    buffer_load_dwordx4 a[0:3], v26, s[4:7], s24 offen sc1
    v_mfma_f32_16x16x32_bf16 v[40:43], a[100:103], a[8:11], v[40:43]
    s_waitcnt lgkmcnt(13)
    ds_read_b64_tr_b16 a[70:71], v3 offset:20480
    v_mfma_f32_16x16x32_bf16 v[48:51], a[104:107], a[8:11], v[48:51]
    ds_read_b64_tr_b16 a[72:73], v4 offset:16384
    s_add_u32 m0, s26, 4096
    v_mfma_f32_16x16x32_bf16 v[52:55], a[104:107], a[12:15], v[52:55]
    s_waitcnt lgkmcnt(13)
    ds_read_b64_tr_b16 a[74:75], v4 offset:20480
    buffer_load_dwordx4 v22, s[12:15], s25 offen offset:0 lds
    v_mfma_f32_16x16x32_bf16 v[60:63], a[108:111], a[12:15], v[60:63]
    ds_read_b64_tr_b16 a[76:77], v5 offset:16384
    v_mfma_f32_16x16x32_bf16 v[56:59], a[108:111], a[8:11], v[56:59]
    s_waitcnt lgkmcnt(13)
    ds_read_b64_tr_b16 a[78:79], v5 offset:20480
    v_mfma_f32_16x16x32_bf16 v[64:67], a[112:115], a[8:11], v[64:67]
    ds_read_b64_tr_b16 a[80:81], v6 offset:16384
    buffer_load_dwordx4 a[4:7], v27, s[4:7], s24 offen sc1
    v_mfma_f32_16x16x32_bf16 v[68:71], a[112:115], a[12:15], v[68:71]
    s_waitcnt lgkmcnt(13)
    ds_read_b64_tr_b16 a[82:83], v6 offset:20480
    s_add_u32 s24, s24, 1024
    v_mfma_f32_16x16x32_bf16 v[76:79], a[116:119], a[12:15], v[76:79]
    ds_read_b64_tr_b16 a[84:85], v7 offset:16384
    s_cmp_ge_u32 s24, s29
    v_mfma_f32_16x16x32_bf16 v[72:75], a[116:119], a[8:11], v[72:75]
    s_waitcnt lgkmcnt(13)
    ds_read_b64_tr_b16 a[86:87], v7 offset:20480
    s_cselect_b32 s24, 0x10000000, s24
    v_mfma_f32_16x16x32_bf16 v[80:83], a[120:123], a[8:11], v[80:83]
    ds_read_b64_tr_b16 a[88:89], v8 offset:16384
    v_mfma_f32_16x16x32_bf16 v[84:87], a[120:123], a[12:15], v[84:87]
    s_waitcnt lgkmcnt(13)
    ds_read_b64_tr_b16 a[90:91], v8 offset:20480
    buffer_load_dwordx4 v23, s[12:15], s25 offen offset:1024 lds
    v_mfma_f32_16x16x32_bf16 v[92:95], a[124:127], a[12:15], v[92:95]
    ds_read_b64_tr_b16 a[92:93], v9 offset:16384
    v_mfma_f32_16x16x32_bf16 v[88:91], a[124:127], a[8:11], v[88:91]
    ds_read_b64_tr_b16 a[94:95], v9 offset:20480
    s_waitcnt vmcnt(16)
    s_waitcnt lgkmcnt(14)
    v_mfma_f32_16x16x32_bf16 v[32:35], a[64:67], a[16:19], v[32:35]
    ds_read_b64_tr_b16 a[96:97], v2 offset:24576
    v_mfma_f32_16x16x32_bf16 v[36:39], a[64:67], a[20:23], v[36:39]
    s_waitcnt lgkmcnt(13)
    ds_read_b64_tr_b16 a[98:99], v2 offset:28672
    v_mfma_f32_16x16x32_bf16 v[44:47], a[68:71], a[20:23], v[44:47]
    ds_read_b64_tr_b16 a[100:101], v3 offset:24576
    buffer_load_dwordx4 a[8:11], v26, s[4:7], s24 offen sc1
    v_mfma_f32_16x16x32_bf16 v[40:43], a[68:71], a[16:19], v[40:43]
    s_waitcnt lgkmcnt(13)
    ds_read_b64_tr_b16 a[102:103], v3 offset:28672
    v_mfma_f32_16x16x32_bf16 v[48:51], a[72:75], a[16:19], v[48:51]
    ds_read_b64_tr_b16 a[104:105], v4 offset:24576
    v_mfma_f32_16x16x32_bf16 v[52:55], a[72:75], a[20:23], v[52:55]
    s_waitcnt lgkmcnt(13)
    ds_read_b64_tr_b16 a[106:107], v4 offset:28672
    buffer_load_dwordx4 v24, s[12:15], s25 offen offset:2048 lds
    v_mfma_f32_16x16x32_bf16 v[60:63], a[76:79], a[20:23], v[60:63]
    ds_read_b64_tr_b16 a[108:109], v5 offset:24576
    v_mfma_f32_16x16x32_bf16 v[56:59], a[76:79], a[16:19], v[56:59]
    s_waitcnt lgkmcnt(13)
    ds_read_b64_tr_b16 a[110:111], v5 offset:28672
    v_mfma_f32_16x16x32_bf16 v[64:67], a[80:83], a[16:19], v[64:67]
    ds_read_b64_tr_b16 a[112:113], v6 offset:24576
    buffer_load_dwordx4 a[12:15], v27, s[4:7], s24 offen sc1
    v_mfma_f32_16x16x32_bf16 v[68:71], a[80:83], a[20:23], v[68:71]
    s_waitcnt lgkmcnt(13)
    ds_read_b64_tr_b16 a[114:115], v6 offset:28672
    s_add_u32 s24, s24, 1024
    v_mfma_f32_16x16x32_bf16 v[76:79], a[84:87], a[20:23], v[76:79]
    ds_read_b64_tr_b16 a[116:117], v7 offset:24576
    s_cmp_ge_u32 s24, s29
    v_mfma_f32_16x16x32_bf16 v[72:75], a[84:87], a[16:19], v[72:75]
    s_waitcnt lgkmcnt(13)
    ds_read_b64_tr_b16 a[118:119], v7 offset:28672
    s_cselect_b32 s24, 0x10000000, s24
    v_mfma_f32_16x16x32_bf16 v[80:83], a[88:91], a[16:19], v[80:83]
    ds_read_b64_tr_b16 a[120:121], v8 offset:24576
    v_mfma_f32_16x16x32_bf16 v[84:87], a[88:91], a[20:23], v[84:87]
    s_waitcnt lgkmcnt(13)
    ds_read_b64_tr_b16 a[122:123], v8 offset:28672
    buffer_load_dwordx4 v25, s[12:15], s25 offen offset:3072 lds
    v_mfma_f32_16x16x32_bf16 v[92:95], a[92:95], a[20:23], v[92:95]
    ds_read_b64_tr_b16 a[124:125], v9 offset:24576
    s_add_u32 s25, s25, 262144
    v_mfma_f32_16x16x32_bf16 v[88:91], a[92:95], a[16:19], v[88:91]
    ds_read_b64_tr_b16 a[126:127], v9 offset:28672
    s_add_u32 s26, s26, 32768
    s_and_b32 s26, s26, 131071
    s_waitcnt vmcnt(18)
    s_waitcnt lgkmcnt(14)
    v_mfma_f32_16x16x32_bf16 v[32:35], a[96:99], a[24:27], v[32:35]
    s_waitcnt vmcnt(16)
    s_barrier
    ds_read_b64_tr_b16 a[64:65], v2 offset:32768
    v_mfma_f32_16x16x32_bf16 v[36:39], a[96:99], a[28:31], v[36:39]
    s_waitcnt lgkmcnt(13)
    ds_read_b64_tr_b16 a[66:67], v2 offset:36864
    v_mfma_f32_16x16x32_bf16 v[44:47], a[100:103], a[28:31], v[44:47]
    ds_read_b64_tr_b16 a[68:69], v3 offset:32768
    buffer_load_dwordx4 a[16:19], v26, s[4:7], s24 offen sc1
    v_mfma_f32_16x16x32_bf16 v[40:43], a[100:103], a[24:27], v[40:43]
    s_waitcnt lgkmcnt(13)
    ds_read_b64_tr_b16 a[70:71], v3 offset:36864
    v_mfma_f32_16x16x32_bf16 v[48:51], a[104:107], a[24:27], v[48:51]
    ds_read_b64_tr_b16 a[72:73], v4 offset:32768
    s_add_u32 m0, s26, 0
    v_mfma_f32_16x16x32_bf16 v[52:55], a[104:107], a[28:31], v[52:55]
    s_waitcnt lgkmcnt(13)
    ds_read_b64_tr_b16 a[74:75], v4 offset:36864
    buffer_load_dwordx4 v18, s[12:15], s25 offen offset:0 lds
    v_mfma_f32_16x16x32_bf16 v[60:63], a[108:111], a[28:31], v[60:63]
    ds_read_b64_tr_b16 a[76:77], v5 offset:32768
    v_mfma_f32_16x16x32_bf16 v[56:59], a[108:111], a[24:27], v[56:59]
    s_waitcnt lgkmcnt(13)
    ds_read_b64_tr_b16 a[78:79], v5 offset:36864
    v_mfma_f32_16x16x32_bf16 v[64:67], a[112:115], a[24:27], v[64:67]
    ds_read_b64_tr_b16 a[80:81], v6 offset:32768
    buffer_load_dwordx4 a[20:23], v27, s[4:7], s24 offen sc1
    v_mfma_f32_16x16x32_bf16 v[68:71], a[112:115], a[28:31], v[68:71]
    s_waitcnt lgkmcnt(13)
    ds_read_b64_tr_b16 a[82:83], v6 offset:36864
    s_add_u32 s24, s24, 1024
    v_mfma_f32_16x16x32_bf16 v[76:79], a[116:119], a[28:31], v[76:79]
    ds_read_b64_tr_b16 a[84:85], v7 offset:32768
    s_cmp_ge_u32 s24, s29
    v_mfma_f32_16x16x32_bf16 v[72:75], a[116:119], a[24:27], v[72:75]
    s_waitcnt lgkmcnt(13)
    ds_read_b64_tr_b16 a[86:87], v7 offset:36864
    s_cselect_b32 s24, 0x10000000, s24
    v_mfma_f32_16x16x32_bf16 v[80:83], a[120:123], a[24:27], v[80:83]
    ds_read_b64_tr_b16 a[88:89], v8 offset:32768
    v_mfma_f32_16x16x32_bf16 v[84:87], a[120:123], a[28:31], v[84:87]
    s_waitcnt lgkmcnt(13)
    ds_read_b64_tr_b16 a[90:91], v8 offset:36864
    buffer_load_dwordx4 v19, s[12:15], s25 offen offset:1024 lds
    v_mfma_f32_16x16x32_bf16 v[92:95], a[124:127], a[28:31], v[92:95]
    ds_read_b64_tr_b16 a[92:93], v9 offset:32768
    v_mfma_f32_16x16x32_bf16 v[88:91], a[124:127], a[24:27], v[88:91]
    ds_read_b64_tr_b16 a[94:95], v9 offset:36864
    s_waitcnt vmcnt(20)
    s_waitcnt lgkmcnt(14)
    v_mfma_f32_16x16x32_bf16 v[32:35], a[64:67], a[32:35], v[32:35]
    ds_read_b64_tr_b16 a[96:97], v2 offset:40960
    v_mfma_f32_16x16x32_bf16 v[36:39], a[64:67], a[36:39], v[36:39]
    s_waitcnt lgkmcnt(13)
    ds_read_b64_tr_b16 a[98:99], v2 offset:45056
    v_mfma_f32_16x16x32_bf16 v[44:47], a[68:71], a[36:39], v[44:47]
    ds_read_b64_tr_b16 a[100:101], v3 offset:40960
    buffer_load_dwordx4 a[24:27], v26, s[4:7], s24 offen sc1
    v_mfma_f32_16x16x32_bf16 v[40:43], a[68:71], a[32:35], v[40:43]
    s_waitcnt lgkmcnt(13)
    ds_read_b64_tr_b16 a[102:103], v3 offset:45056
    v_mfma_f32_16x16x32_bf16 v[48:51], a[72:75], a[32:35], v[48:51]
    ds_read_b64_tr_b16 a[104:105], v4 offset:40960
    v_mfma_f32_16x16x32_bf16 v[52:55], a[72:75], a[36:39], v[52:55]
    s_waitcnt lgkmcnt(13)
    ds_read_b64_tr_b16 a[106:107], v4 offset:45056
    buffer_load_dwordx4 v20, s[12:15], s25 offen offset:2048 lds
    v_mfma_f32_16x16x32_bf16 v[60:63], a[76:79], a[36:39], v[60:63]
    ds_read_b64_tr_b16 a[108:109], v5 offset:40960
    v_mfma_f32_16x16x32_bf16 v[56:59], a[76:79], a[32:35], v[56:59]
    s_waitcnt lgkmcnt(13)
    ds_read_b64_tr_b16 a[110:111], v5 offset:45056
    v_mfma_f32_16x16x32_bf16 v[64:67], a[80:83], a[32:35], v[64:67]
    ds_read_b64_tr_b16 a[112:113], v6 offset:40960
    buffer_load_dwordx4 a[28:31], v27, s[4:7], s24 offen sc1
    v_mfma_f32_16x16x32_bf16 v[68:71], a[80:83], a[36:39], v[68:71]
    s_waitcnt lgkmcnt(13)
    ds_read_b64_tr_b16 a[114:115], v6 offset:45056
    s_add_u32 s24, s24, 1024
    v_mfma_f32_16x16x32_bf16 v[76:79], a[84:87], a[36:39], v[76:79]
    ds_read_b64_tr_b16 a[116:117], v7 offset:40960
    s_cmp_ge_u32 s24, s29
    v_mfma_f32_16x16x32_bf16 v[72:75], a[84:87], a[32:35], v[72:75]
    s_waitcnt lgkmcnt(13)
    ds_read_b64_tr_b16 a[118:119], v7 offset:45056
    s_cselect_b32 s24, 0x10000000, s24
    v_mfma_f32_16x16x32_bf16 v[80:83], a[88:91], a[32:35], v[80:83]
    ds_read_b64_tr_b16 a[120:121], v8 offset:40960
    v_mfma_f32_16x16x32_bf16 v[84:87], a[88:91], a[36:39], v[84:87]
    s_waitcnt lgkmcnt(13)
    ds_read_b64_tr_b16 a[122:123], v8 offset:45056
    buffer_load_dwordx4 v21, s[12:15], s25 offen offset:3072 lds
    v_mfma_f32_16x16x32_bf16 v[92:95], a[92:95], a[36:39], v[92:95]
    ds_read_b64_tr_b16 a[124:125], v9 offset:40960
    v_mfma_f32_16x16x32_bf16 v[88:91], a[92:95], a[32:35], v[88:91]
    ds_read_b64_tr_b16 a[126:127], v9 offset:45056
    s_waitcnt vmcnt(22)
    s_waitcnt lgkmcnt(14)
    v_mfma_f32_16x16x32_bf16 v[32:35], a[96:99], a[40:43], v[32:35]
    ds_read_b64_tr_b16 a[64:65], v2 offset:49152
    v_mfma_f32_16x16x32_bf16 v[36:39], a[96:99], a[44:47], v[36:39]
    s_waitcnt lgkmcnt(13)
    ds_read_b64_tr_b16 a[66:67], v2 offset:53248
    v_mfma_f32_16x16x32_bf16 v[44:47], a[100:103], a[44:47], v[44:47]
    ds_read_b64_tr_b16 a[68:69], v3 offset:49152
    buffer_load_dwordx4 a[32:35], v26, s[4:7], s24 offen sc1
    v_mfma_f32_16x16x32_bf16 v[40:43], a[100:103], a[40:43], v[40:43]
    s_waitcnt lgkmcnt(13)
    ds_read_b64_tr_b16 a[70:71], v3 offset:53248
    v_mfma_f32_16x16x32_bf16 v[48:51], a[104:107], a[40:43], v[48:51]
    ds_read_b64_tr_b16 a[72:73], v4 offset:49152
    s_add_u32 m0, s26, 4096
    v_mfma_f32_16x16x32_bf16 v[52:55], a[104:107], a[44:47], v[52:55]
    s_waitcnt lgkmcnt(13)
    ds_read_b64_tr_b16 a[74:75], v4 offset:53248
    buffer_load_dwordx4 v22, s[12:15], s25 offen offset:0 lds
    v_mfma_f32_16x16x32_bf16 v[60:63], a[108:111], a[44:47], v[60:63]
    ds_read_b64_tr_b16 a[76:77], v5 offset:49152
    v_mfma_f32_16x16x32_bf16 v[56:59], a[108:111], a[40:43], v[56:59]
    s_waitcnt lgkmcnt(13)
    ds_read_b64_tr_b16 a[78:79], v5 offset:53248
    v_mfma_f32_16x16x32_bf16 v[64:67], a[112:115], a[40:43], v[64:67]
    ds_read_b64_tr_b16 a[80:81], v6 offset:49152
    buffer_load_dwordx4 a[36:39], v27, s[4:7], s24 offen sc1
    v_mfma_f32_16x16x32_bf16 v[68:71], a[112:115], a[44:47], v[68:71]
    s_waitcnt lgkmcnt(13)
    ds_read_b64_tr_b16 a[82:83], v6 offset:53248
    s_add_u32 s24, s24, 1024
    v_mfma_f32_16x16x32_bf16 v[76:79], a[116:119], a[44:47], v[76:79]
    ds_read_b64_tr_b16 a[84:85], v7 offset:49152
    s_cmp_ge_u32 s24, s29
    v_mfma_f32_16x16x32_bf16 v[72:75], a[116:119], a[40:43], v[72:75]
    s_waitcnt lgkmcnt(13)
    ds_read_b64_tr_b16 a[86:87], v7 offset:53248
    s_cselect_b32 s24, 0x10000000, s24
    v_mfma_f32_16x16x32_bf16 v[80:83], a[120:123], a[40:43], v[80:83]
    ds_read_b64_tr_b16 a[88:89], v8 offset:49152
    v_mfma_f32_16x16x32_bf16 v[84:87], a[120:123], a[44:47], v[84:87]
    s_waitcnt lgkmcnt(13)
    ds_read_b64_tr_b16 a[90:91], v8 offset:53248
    buffer_load_dwordx4 v23, s[12:15], s25 offen offset:1024 lds
    v_mfma_f32_16x16x32_bf16 v[92:95], a[124:127], a[44:47], v[92:95]
    ds_read_b64_tr_b16 a[92:93], v9 offset:49152
    v_mfma_f32_16x16x32_bf16 v[88:91], a[124:127], a[40:43], v[88:91]
    ds_read_b64_tr_b16 a[94:95], v9 offset:53248
    s_waitcnt vmcnt(24)
    s_waitcnt lgkmcnt(14)
    v_mfma_f32_16x16x32_bf16 v[32:35], a[64:67], a[48:51], v[32:35]
    ds_read_b64_tr_b16 a[96:97], v2 offset:57344
    v_mfma_f32_16x16x32_bf16 v[36:39], a[64:67], a[52:55], v[36:39]
    s_waitcnt lgkmcnt(13)
    ds_read_b64_tr_b16 a[98:99], v2 offset:61440
    v_mfma_f32_16x16x32_bf16 v[44:47], a[68:71], a[52:55], v[44:47]
    ds_read_b64_tr_b16 a[100:101], v3 offset:57344
    buffer_load_dwordx4 a[40:43], v26, s[4:7], s24 offen sc1
    v_mfma_f32_16x16x32_bf16 v[40:43], a[68:71], a[48:51], v[40:43]
    s_waitcnt lgkmcnt(13)
    ds_read_b64_tr_b16 a[102:103], v3 offset:61440
    v_mfma_f32_16x16x32_bf16 v[48:51], a[72:75], a[48:51], v[48:51]
    ds_read_b64_tr_b16 a[104:105], v4 offset:57344
    v_mfma_f32_16x16x32_bf16 v[52:55], a[72:75], a[52:55], v[52:55]
    s_waitcnt lgkmcnt(13)
    ds_read_b64_tr_b16 a[106:107], v4 offset:61440
    buffer_load_dwordx4 v24, s[12:15], s25 offen offset:2048 lds
    v_mfma_f32_16x16x32_bf16 v[60:63], a[76:79], a[52:55], v[60:63]
    ds_read_b64_tr_b16 a[108:109], v5 offset:57344
    v_mfma_f32_16x16x32_bf16 v[56:59], a[76:79], a[48:51], v[56:59]
    s_waitcnt lgkmcnt(13)
    ds_read_b64_tr_b16 a[110:111], v5 offset:61440
    v_mfma_f32_16x16x32_bf16 v[64:67], a[80:83], a[48:51], v[64:67]
    ds_read_b64_tr_b16 a[112:113], v6 offset:57344
    buffer_load_dwordx4 a[44:47], v27, s[4:7], s24 offen sc1
    v_mfma_f32_16x16x32_bf16 v[68:71], a[80:83], a[52:55], v[68:71]
    s_waitcnt lgkmcnt(13)
    ds_read_b64_tr_b16 a[114:115], v6 offset:61440
    s_add_u32 s24, s24, 1024
    v_mfma_f32_16x16x32_bf16 v[76:79], a[84:87], a[52:55], v[76:79]
    ds_read_b64_tr_b16 a[116:117], v7 offset:57344
    s_cmp_ge_u32 s24, s29
    v_mfma_f32_16x16x32_bf16 v[72:75], a[84:87], a[48:51], v[72:75]
    s_waitcnt lgkmcnt(13)
    ds_read_b64_tr_b16 a[118:119], v7 offset:61440
    s_cselect_b32 s24, 0x10000000, s24
    v_mfma_f32_16x16x32_bf16 v[80:83], a[88:91], a[48:51], v[80:83]
    ds_read_b64_tr_b16 a[120:121], v8 offset:57344
    v_mfma_f32_16x16x32_bf16 v[84:87], a[88:91], a[52:55], v[84:87]
    s_waitcnt lgkmcnt(13)
    ds_read_b64_tr_b16 a[122:123], v8 offset:61440
    buffer_load_dwordx4 v25, s[12:15], s25 offen offset:3072 lds
    v_mfma_f32_16x16x32_bf16 v[92:95], a[92:95], a[52:55], v[92:95]
    ds_read_b64_tr_b16 a[124:125], v9 offset:57344
    s_add_u32 s25, s25, 262144
    v_mfma_f32_16x16x32_bf16 v[88:91], a[92:95], a[48:51], v[88:91]
    ds_read_b64_tr_b16 a[126:127], v9 offset:61440
    s_add_u32 s26, s26, 32768
    s_and_b32 s26, s26, 131071
    s_waitcnt vmcnt(25)
    s_waitcnt lgkmcnt(14)
    v_mfma_f32_16x16x32_bf16 v[32:35], a[96:99], a[56:59], v[32:35]
    s_waitcnt vmcnt(16)
    s_barrier
    v_xor_b32 v2, 65536, v2
    v_xor_b32 v3, 65536, v3
    v_xor_b32 v4, 65536, v4
    v_xor_b32 v5, 65536, v5
    v_xor_b32 v6, 65536, v6
    v_xor_b32 v7, 65536, v7
    v_xor_b32 v8, 65536, v8
    v_xor_b32 v9, 65536, v9
    ds_read_b64_tr_b16 a[64:65], v2 offset:0
    v_mfma_f32_16x16x32_bf16 v[36:39], a[96:99], a[60:63], v[36:39]
    s_waitcnt lgkmcnt(13)
    ds_read_b64_tr_b16 a[66:67], v2 offset:4096
    v_mfma_f32_16x16x32_bf16 v[44:47], a[100:103], a[60:63], v[44:47]
    ds_read_b64_tr_b16 a[68:69], v3 offset:0
    buffer_load_dwordx4 a[48:51], v26, s[4:7], s24 offen sc1
    v_mfma_f32_16x16x32_bf16 v[40:43], a[100:103], a[56:59], v[40:43]
    s_waitcnt lgkmcnt(13)
    ds_read_b64_tr_b16 a[70:71], v3 offset:4096
    v_mfma_f32_16x16x32_bf16 v[48:51], a[104:107], a[56:59], v[48:51]
    ds_read_b64_tr_b16 a[72:73], v4 offset:0
    s_add_u32 m0, s26, 0
    v_mfma_f32_16x16x32_bf16 v[52:55], a[104:107], a[60:63], v[52:55]
    s_waitcnt lgkmcnt(13)
    ds_read_b64_tr_b16 a[74:75], v4 offset:4096
    buffer_load_dwordx4 v18, s[12:15], s25 offen offset:0 lds
    v_mfma_f32_16x16x32_bf16 v[60:63], a[108:111], a[60:63], v[60:63]
    ds_read_b64_tr_b16 a[76:77], v5 offset:0
    v_mfma_f32_16x16x32_bf16 v[56:59], a[108:111], a[56:59], v[56:59]
    s_waitcnt lgkmcnt(13)
    ds_read_b64_tr_b16 a[78:79], v5 offset:4096
    v_mfma_f32_16x16x32_bf16 v[64:67], a[112:115], a[56:59], v[64:67]
    ds_read_b64_tr_b16 a[80:81], v6 offset:0
    buffer_load_dwordx4 a[52:55], v27, s[4:7], s24 offen sc1
    v_mfma_f32_16x16x32_bf16 v[68:71], a[112:115], a[60:63], v[68:71]
    s_waitcnt lgkmcnt(13)
    ds_read_b64_tr_b16 a[82:83], v6 offset:4096
    s_add_u32 s24, s24, 1024
    v_mfma_f32_16x16x32_bf16 v[76:79], a[116:119], a[60:63], v[76:79]
    ds_read_b64_tr_b16 a[84:85], v7 offset:0
    s_cmp_ge_u32 s24, s29
    v_mfma_f32_16x16x32_bf16 v[72:75], a[116:119], a[56:59], v[72:75]
    s_waitcnt lgkmcnt(13)
    ds_read_b64_tr_b16 a[86:87], v7 offset:4096
    s_cselect_b32 s24, 0x10000000, s24
    v_mfma_f32_16x16x32_bf16 v[80:83], a[120:123], a[56:59], v[80:83]
    ds_read_b64_tr_b16 a[88:89], v8 offset:0
    v_mfma_f32_16x16x32_bf16 v[84:87], a[120:123], a[60:63], v[84:87]
    s_waitcnt lgkmcnt(13)
    ds_read_b64_tr_b16 a[90:91], v8 offset:4096
    buffer_load_dwordx4 v19, s[12:15], s25 offen offset:1024 lds
    v_mfma_f32_16x16x32_bf16 v[92:95], a[124:127], a[60:63], v[92:95]
    ds_read_b64_tr_b16 a[92:93], v9 offset:0
    v_mfma_f32_16x16x32_bf16 v[88:91], a[124:127], a[56:59], v[88:91]
    ds_read_b64_tr_b16 a[94:95], v9 offset:4096
    s_sub_u32 s28, s28, 1
    s_cmp_lg_u32 s28, 0
    s_cbranch_scc1 L5_loop
    s_waitcnt lgkmcnt(14)
    v_mfma_f32_16x16x32_bf16 v[32:35], a[64:67], a[0:3], v[32:35]
    ds_read_b64_tr_b16 a[96:97], v2 offset:8192
    v_mfma_f32_16x16x32_bf16 v[36:39], a[64:67], a[4:7], v[36:39]
    s_waitcnt lgkmcnt(13)
    ds_read_b64_tr_b16 a[98:99], v2 offset:12288
    v_mfma_f32_16x16x32_bf16 v[44:47], a[68:71], a[4:7], v[44:47]
    ds_read_b64_tr_b16 a[100:101], v3 offset:8192
    buffer_load_dwordx4 a[56:59], v26, s[4:7], s24 offen sc1
    v_mfma_f32_16x16x32_bf16 v[40:43], a[68:71], a[0:3], v[40:43]
    s_waitcnt lgkmcnt(13)
    ds_read_b64_tr_b16 a[102:103], v3 offset:12288
    v_mfma_f32_16x16x32_bf16 v[48:51], a[72:75], a[0:3], v[48:51]
    ds_read_b64_tr_b16 a[104:105], v4 offset:8192
    v_mfma_f32_16x16x32_bf16 v[52:55], a[72:75], a[4:7], v[52:55]
    s_waitcnt lgkmcnt(13)
    ds_read_b64_tr_b16 a[106:107], v4 offset:12288
    v_mfma_f32_16x16x32_bf16 v[60:63], a[76:79], a[4:7], v[60:63]
    ds_read_b64_tr_b16 a[108:109], v5 offset:8192
    v_mfma_f32_16x16x32_bf16 v[56:59], a[76:79], a[0:3], v[56:59]
    s_waitcnt lgkmcnt(13)
    ds_read_b64_tr_b16 a[110:111], v5 offset:12288
    v_mfma_f32_16x16x32_bf16 v[64:67], a[80:83], a[0:3], v[64:67]
    ds_read_b64_tr_b16 a[112:113], v6 offset:8192
    buffer_load_dwordx4 a[60:63], v27, s[4:7], s24 offen sc1
    v_mfma_f32_16x16x32_bf16 v[68:71], a[80:83], a[4:7], v[68:71]
    s_waitcnt lgkmcnt(13)
    ds_read_b64_tr_b16 a[114:115], v6 offset:12288
    v_mfma_f32_16x16x32_bf16 v[76:79], a[84:87], a[4:7], v[76:79]
    ds_read_b64_tr_b16 a[116:117], v7 offset:8192
    v_mfma_f32_16x16x32_bf16 v[72:75], a[84:87], a[0:3], v[72:75]
    s_waitcnt lgkmcnt(13)
    ds_read_b64_tr_b16 a[118:119], v7 offset:12288
    v_mfma_f32_16x16x32_bf16 v[80:83], a[88:91], a[0:3], v[80:83]
    ds_read_b64_tr_b16 a[120:121], v8 offset:8192
    v_mfma_f32_16x16x32_bf16 v[84:87], a[88:91], a[4:7], v[84:87]
    s_waitcnt lgkmcnt(13)
    ds_read_b64_tr_b16 a[122:123], v8 offset:12288
    v_mfma_f32_16x16x32_bf16 v[92:95], a[92:95], a[4:7], v[92:95]
    ds_read_b64_tr_b16 a[124:125], v9 offset:8192
    v_mfma_f32_16x16x32_bf16 v[88:91], a[92:95], a[0:3], v[88:91]
    ds_read_b64_tr_b16 a[126:127], v9 offset:12288
    s_waitcnt lgkmcnt(14)
    v_mfma_f32_16x16x32_bf16 v[32:35], a[96:99], a[8:11], v[32:35]
    ds_read_b64_tr_b16 a[64:65], v2 offset:16384
    s_lshl_b32 s16, s68, 3
    v_mfma_f32_16x16x32_bf16 v[36:39], a[96:99], a[12:15], v[36:39]
    s_waitcnt lgkmcnt(13)
    ds_read_b64_tr_b16 a[66:67], v2 offset:20480
    s_add_u32 s16, s16, s69
    v_mfma_f32_16x16x32_bf16 v[44:47], a[100:103], a[12:15], v[44:47]
    ds_read_b64_tr_b16 a[68:69], v3 offset:16384
    s_lshl_b32 s16, s16, 1
    v_mfma_f32_16x16x32_bf16 v[40:43], a[100:103], a[8:11], v[40:43]
    s_waitcnt lgkmcnt(13)
    ds_read_b64_tr_b16 a[70:71], v3 offset:20480
    s_add_u32 s30, s16, s70
    v_mfma_f32_16x16x32_bf16 v[48:51], a[104:107], a[8:11], v[48:51]
    ds_read_b64_tr_b16 a[72:73], v4 offset:16384
    s_xor_b32 s27, s30, 1
    v_mfma_f32_16x16x32_bf16 v[52:55], a[104:107], a[12:15], v[52:55]
    s_waitcnt lgkmcnt(13)
    ds_read_b64_tr_b16 a[74:75], v4 offset:20480
    s_lshl_b32 s30, s30, 2
    v_mfma_f32_16x16x32_bf16 v[60:63], a[108:111], a[12:15], v[60:63]
    ds_read_b64_tr_b16 a[76:77], v5 offset:16384
    s_add_u32 s30, s30, s20
    v_mfma_f32_16x16x32_bf16 v[56:59], a[108:111], a[8:11], v[56:59]
    s_waitcnt lgkmcnt(13)
    ds_read_b64_tr_b16 a[78:79], v5 offset:20480
    s_lshl_b32 s30, s30, 13
    v_mfma_f32_16x16x32_bf16 v[64:67], a[112:115], a[8:11], v[64:67]
    ds_read_b64_tr_b16 a[80:81], v6 offset:16384
    s_add_u32 s30, s30, 46137344
    v_mfma_f32_16x16x32_bf16 v[68:71], a[112:115], a[12:15], v[68:71]
    s_waitcnt lgkmcnt(13)
    ds_read_b64_tr_b16 a[82:83], v6 offset:20480
    s_lshl_b32 s27, s27, 2
    v_mfma_f32_16x16x32_bf16 v[76:79], a[116:119], a[12:15], v[76:79]
    ds_read_b64_tr_b16 a[84:85], v7 offset:16384
    s_add_u32 s27, s27, s20
    v_mfma_f32_16x16x32_bf16 v[72:75], a[116:119], a[8:11], v[72:75]
    s_waitcnt lgkmcnt(13)
    ds_read_b64_tr_b16 a[86:87], v7 offset:20480
    s_lshl_b32 s27, s27, 13
    v_mfma_f32_16x16x32_bf16 v[80:83], a[120:123], a[8:11], v[80:83]
    ds_read_b64_tr_b16 a[88:89], v8 offset:16384
    s_add_u32 s27, s27, 46137344
    v_mfma_f32_16x16x32_bf16 v[84:87], a[120:123], a[12:15], v[84:87]
    s_waitcnt lgkmcnt(13)
    ds_read_b64_tr_b16 a[90:91], v8 offset:20480
    v_lshlrev_b32 v28, 4, v1
    v_mfma_f32_16x16x32_bf16 v[92:95], a[124:127], a[12:15], v[92:95]
    ds_read_b64_tr_b16 a[92:93], v9 offset:16384
    v_add_u32 v29, 4096, v28
    v_mfma_f32_16x16x32_bf16 v[88:91], a[124:127], a[8:11], v[88:91]
    ds_read_b64_tr_b16 a[94:95], v9 offset:20480
    s_waitcnt vmcnt(19)
    s_waitcnt lgkmcnt(14)
    v_mfma_f32_16x16x32_bf16 v[32:35], a[64:67], a[16:19], v[32:35]
    ds_read_b64_tr_b16 a[96:97], v2 offset:24576
    v_mfma_f32_16x16x32_bf16 v[36:39], a[64:67], a[20:23], v[36:39]
    s_waitcnt lgkmcnt(13)
    ds_read_b64_tr_b16 a[98:99], v2 offset:28672
    v_mfma_f32_16x16x32_bf16 v[44:47], a[68:71], a[20:23], v[44:47]
    ds_read_b64_tr_b16 a[100:101], v3 offset:24576
    v_mfma_f32_16x16x32_bf16 v[40:43], a[68:71], a[16:19], v[40:43]
    s_waitcnt lgkmcnt(13)
    ds_read_b64_tr_b16 a[102:103], v3 offset:28672
    v_mfma_f32_16x16x32_bf16 v[48:51], a[72:75], a[16:19], v[48:51]
    ds_read_b64_tr_b16 a[104:105], v4 offset:24576
    v_mfma_f32_16x16x32_bf16 v[52:55], a[72:75], a[20:23], v[52:55]
    s_waitcnt lgkmcnt(13)
    ds_read_b64_tr_b16 a[106:107], v4 offset:28672
    v_mfma_f32_16x16x32_bf16 v[60:63], a[76:79], a[20:23], v[60:63]
    ds_read_b64_tr_b16 a[108:109], v5 offset:24576
    v_mfma_f32_16x16x32_bf16 v[56:59], a[76:79], a[16:19], v[56:59]
    s_waitcnt lgkmcnt(13)
    ds_read_b64_tr_b16 a[110:111], v5 offset:28672
    v_mfma_f32_16x16x32_bf16 v[64:67], a[80:83], a[16:19], v[64:67]
    ds_read_b64_tr_b16 a[112:113], v6 offset:24576
    v_mfma_f32_16x16x32_bf16 v[68:71], a[80:83], a[20:23], v[68:71]
    s_waitcnt lgkmcnt(13)
    ds_read_b64_tr_b16 a[114:115], v6 offset:28672
    v_mfma_f32_16x16x32_bf16 v[76:79], a[84:87], a[20:23], v[76:79]
    ds_read_b64_tr_b16 a[116:117], v7 offset:24576
    v_mfma_f32_16x16x32_bf16 v[72:75], a[84:87], a[16:19], v[72:75]
    s_waitcnt lgkmcnt(13)
    ds_read_b64_tr_b16 a[118:119], v7 offset:28672
    v_mfma_f32_16x16x32_bf16 v[80:83], a[88:91], a[16:19], v[80:83]
    ds_read_b64_tr_b16 a[120:121], v8 offset:24576
    v_mfma_f32_16x16x32_bf16 v[84:87], a[88:91], a[20:23], v[84:87]
    s_waitcnt lgkmcnt(13)
    ds_read_b64_tr_b16 a[122:123], v8 offset:28672
    v_mfma_f32_16x16x32_bf16 v[92:95], a[92:95], a[20:23], v[92:95]
    ds_read_b64_tr_b16 a[124:125], v9 offset:24576
    v_mfma_f32_16x16x32_bf16 v[88:91], a[92:95], a[16:19], v[88:91]
    ds_read_b64_tr_b16 a[126:127], v9 offset:28672
    s_waitcnt vmcnt(15)
    s_waitcnt lgkmcnt(14)
    v_mfma_f32_16x16x32_bf16 v[32:35], a[96:99], a[24:27], v[32:35]
    s_waitcnt vmcnt(6)
    s_barrier
    ds_read_b64_tr_b16 a[64:65], v6 offset:32768
    v_mfma_f32_16x16x32_bf16 v[36:39], a[96:99], a[28:31], v[36:39]
    s_waitcnt lgkmcnt(13)
    ds_read_b64_tr_b16 a[66:67], v6 offset:36864
    v_mfma_f32_16x16x32_bf16 v[44:47], a[100:103], a[28:31], v[44:47]
    ds_read_b64_tr_b16 a[68:69], v6 offset:40960
    v_mfma_f32_16x16x32_bf16 v[40:43], a[100:103], a[24:27], v[40:43]
    s_waitcnt lgkmcnt(13)
    ds_read_b64_tr_b16 a[70:71], v6 offset:45056
    v_mfma_f32_16x16x32_bf16 v[48:51], a[104:107], a[24:27], v[48:51]
    ds_read_b64_tr_b16 a[72:73], v6 offset:49152
    v_mfma_f32_16x16x32_bf16 v[52:55], a[104:107], a[28:31], v[52:55]
    s_waitcnt lgkmcnt(13)
    ds_read_b64_tr_b16 a[74:75], v6 offset:53248
    v_mfma_f32_16x16x32_bf16 v[60:63], a[108:111], a[28:31], v[60:63]
    ds_read_b64_tr_b16 a[76:77], v6 offset:57344
    v_mfma_f32_16x16x32_bf16 v[56:59], a[108:111], a[24:27], v[56:59]
    s_waitcnt lgkmcnt(13)
    ds_read_b64_tr_b16 a[78:79], v6 offset:61440
    v_mfma_f32_16x16x32_bf16 v[64:67], a[112:115], a[24:27], v[64:67]
    ds_read_b64_tr_b16 a[80:81], v7 offset:32768
    v_mfma_f32_16x16x32_bf16 v[68:71], a[112:115], a[28:31], v[68:71]
    s_waitcnt lgkmcnt(13)
    ds_read_b64_tr_b16 a[82:83], v7 offset:36864
    v_mfma_f32_16x16x32_bf16 v[76:79], a[116:119], a[28:31], v[76:79]
    ds_read_b64_tr_b16 a[84:85], v7 offset:40960
    v_mfma_f32_16x16x32_bf16 v[72:75], a[116:119], a[24:27], v[72:75]
    s_waitcnt lgkmcnt(13)
    ds_read_b64_tr_b16 a[86:87], v7 offset:45056
    v_mfma_f32_16x16x32_bf16 v[80:83], a[120:123], a[24:27], v[80:83]
    ds_read_b64_tr_b16 a[88:89], v7 offset:49152
    v_mfma_f32_16x16x32_bf16 v[84:87], a[120:123], a[28:31], v[84:87]
    s_waitcnt lgkmcnt(13)
    ds_read_b64_tr_b16 a[90:91], v7 offset:53248
    v_mfma_f32_16x16x32_bf16 v[92:95], a[124:127], a[28:31], v[92:95]
    ds_read_b64_tr_b16 a[92:93], v7 offset:57344
    v_mfma_f32_16x16x32_bf16 v[88:91], a[124:127], a[24:27], v[88:91]
    ds_read_b64_tr_b16 a[94:95], v7 offset:61440
    s_waitcnt lgkmcnt(14)
    v_mfma_f32_16x16x32_bf16 v[64:67], a[64:67], a[32:35], v[64:67]
    ds_read_b64_tr_b16 a[96:97], v8 offset:32768
    v_mfma_f32_16x16x32_bf16 v[68:71], a[64:67], a[36:39], v[68:71]
    ds_read_b64_tr_b16 a[98:99], v8 offset:36864
    s_waitcnt lgkmcnt(14)
    v_mfma_f32_16x16x32_bf16 v[68:71], a[68:71], a[44:47], v[68:71]
    ds_read_b64_tr_b16 a[100:101], v8 offset:40960
    v_mfma_f32_16x16x32_bf16 v[64:67], a[68:71], a[40:43], v[64:67]
    ds_read_b64_tr_b16 a[102:103], v8 offset:45056
    s_waitcnt vmcnt(3)
    s_waitcnt lgkmcnt(14)
    v_mfma_f32_16x16x32_bf16 v[64:67], a[72:75], a[48:51], v[64:67]
    ds_read_b64_tr_b16 a[104:105], v8 offset:49152
    v_mfma_f32_16x16x32_bf16 v[68:71], a[72:75], a[52:55], v[68:71]
    ds_read_b64_tr_b16 a[106:107], v8 offset:53248
    s_waitcnt vmcnt(0)
    s_waitcnt lgkmcnt(14)
    v_mfma_f32_16x16x32_bf16 v[68:71], a[76:79], a[60:63], v[68:71]
    ds_read_b64_tr_b16 a[108:109], v8 offset:57344
    v_mfma_f32_16x16x32_bf16 v[64:67], a[76:79], a[56:59], v[64:67]
    ds_read_b64_tr_b16 a[110:111], v8 offset:61440
    s_waitcnt lgkmcnt(14)
    v_mfma_f32_16x16x32_bf16 v[72:75], a[80:83], a[32:35], v[72:75]
    ds_read_b64_tr_b16 a[112:113], v9 offset:32768
    v_mfma_f32_16x16x32_bf16 v[76:79], a[80:83], a[36:39], v[76:79]
    ds_read_b64_tr_b16 a[114:115], v9 offset:36864
    s_waitcnt lgkmcnt(14)
    v_mfma_f32_16x16x32_bf16 v[76:79], a[84:87], a[44:47], v[76:79]
    ds_read_b64_tr_b16 a[116:117], v9 offset:40960
    v_mfma_f32_16x16x32_bf16 v[72:75], a[84:87], a[40:43], v[72:75]
    ds_read_b64_tr_b16 a[118:119], v9 offset:45056
    s_waitcnt lgkmcnt(14)
    v_mfma_f32_16x16x32_bf16 v[72:75], a[88:91], a[48:51], v[72:75]
    ds_read_b64_tr_b16 a[120:121], v9 offset:49152
    v_mfma_f32_16x16x32_bf16 v[76:79], a[88:91], a[52:55], v[76:79]
    ds_read_b64_tr_b16 a[122:123], v9 offset:53248
    s_waitcnt lgkmcnt(14)
    v_mfma_f32_16x16x32_bf16 v[76:79], a[92:95], a[60:63], v[76:79]
    ds_read_b64_tr_b16 a[124:125], v9 offset:57344
    v_mfma_f32_16x16x32_bf16 v[72:75], a[92:95], a[56:59], v[72:75]
    ds_read_b64_tr_b16 a[126:127], v9 offset:61440
    s_waitcnt lgkmcnt(14)
    v_mfma_f32_16x16x32_bf16 v[80:83], a[96:99], a[32:35], v[80:83]
    ds_read_b64_tr_b16 a[64:65], v2 offset:32768
    v_mfma_f32_16x16x32_bf16 v[84:87], a[96:99], a[36:39], v[84:87]
    ds_read_b64_tr_b16 a[66:67], v2 offset:36864
    s_waitcnt lgkmcnt(14)
    v_mfma_f32_16x16x32_bf16 v[84:87], a[100:103], a[44:47], v[84:87]
    ds_read_b64_tr_b16 a[68:69], v2 offset:40960
    v_mfma_f32_16x16x32_bf16 v[80:83], a[100:103], a[40:43], v[80:83]
    ds_read_b64_tr_b16 a[70:71], v2 offset:45056
    s_waitcnt lgkmcnt(14)
    v_mfma_f32_16x16x32_bf16 v[80:83], a[104:107], a[48:51], v[80:83]
    ds_read_b64_tr_b16 a[72:73], v2 offset:49152
    v_mfma_f32_16x16x32_bf16 v[84:87], a[104:107], a[52:55], v[84:87]
    ds_read_b64_tr_b16 a[74:75], v2 offset:53248
    s_waitcnt lgkmcnt(14)
    v_mfma_f32_16x16x32_bf16 v[84:87], a[108:111], a[60:63], v[84:87]
    ds_read_b64_tr_b16 a[76:77], v2 offset:57344
    v_mfma_f32_16x16x32_bf16 v[80:83], a[108:111], a[56:59], v[80:83]
    ds_read_b64_tr_b16 a[78:79], v2 offset:61440
    s_waitcnt lgkmcnt(14)
    v_mfma_f32_16x16x32_bf16 v[88:91], a[112:115], a[32:35], v[88:91]
    ds_read_b64_tr_b16 a[80:81], v3 offset:32768
    v_mfma_f32_16x16x32_bf16 v[92:95], a[112:115], a[36:39], v[92:95]
    ds_read_b64_tr_b16 a[82:83], v3 offset:36864
    s_waitcnt lgkmcnt(14)
    v_mfma_f32_16x16x32_bf16 v[92:95], a[116:119], a[44:47], v[92:95]
    ds_read_b64_tr_b16 a[84:85], v3 offset:40960
    v_mfma_f32_16x16x32_bf16 v[88:91], a[116:119], a[40:43], v[88:91]
    ds_read_b64_tr_b16 a[86:87], v3 offset:45056
    s_waitcnt lgkmcnt(14)
    v_mfma_f32_16x16x32_bf16 v[88:91], a[120:123], a[48:51], v[88:91]
    ds_read_b64_tr_b16 a[88:89], v3 offset:49152
    v_mfma_f32_16x16x32_bf16 v[92:95], a[120:123], a[52:55], v[92:95]
    ds_read_b64_tr_b16 a[90:91], v3 offset:53248
    s_waitcnt lgkmcnt(14)
    v_mfma_f32_16x16x32_bf16 v[92:95], a[124:127], a[60:63], v[92:95]
    ds_read_b64_tr_b16 a[92:93], v3 offset:57344
    v_mfma_f32_16x16x32_bf16 v[88:91], a[124:127], a[56:59], v[88:91]
    ds_read_b64_tr_b16 a[94:95], v3 offset:61440
    s_waitcnt lgkmcnt(14)
    v_mfma_f32_16x16x32_bf16 v[32:35], a[64:67], a[32:35], v[32:35]
    ds_read_b64_tr_b16 a[96:97], v4 offset:32768
    v_mfma_f32_16x16x32_bf16 v[36:39], a[64:67], a[36:39], v[36:39]
    ds_read_b64_tr_b16 a[98:99], v4 offset:36864
    s_waitcnt lgkmcnt(14)
    v_mfma_f32_16x16x32_bf16 v[36:39], a[68:71], a[44:47], v[36:39]
    ds_read_b64_tr_b16 a[100:101], v4 offset:40960
    v_mfma_f32_16x16x32_bf16 v[32:35], a[68:71], a[40:43], v[32:35]
    ds_read_b64_tr_b16 a[102:103], v4 offset:45056
    s_waitcnt lgkmcnt(14)
    v_mfma_f32_16x16x32_bf16 v[32:35], a[72:75], a[48:51], v[32:35]
    ds_read_b64_tr_b16 a[104:105], v4 offset:49152
    v_mfma_f32_16x16x32_bf16 v[36:39], a[72:75], a[52:55], v[36:39]
    ds_read_b64_tr_b16 a[106:107], v4 offset:53248
    s_waitcnt lgkmcnt(14)
    buffer_store_dwordx4 v[64:67], v28, s[4:7], s30 offen offset:0 sc1
    v_mfma_f32_16x16x32_bf16 v[36:39], a[76:79], a[60:63], v[36:39]
    ds_read_b64_tr_b16 a[108:109], v4 offset:57344
    v_mfma_f32_16x16x32_bf16 v[32:35], a[76:79], a[56:59], v[32:35]
    ds_read_b64_tr_b16 a[110:111], v4 offset:61440
    s_waitcnt lgkmcnt(14)
    v_mfma_f32_16x16x32_bf16 v[40:43], a[80:83], a[32:35], v[40:43]
    ds_read_b64_tr_b16 a[112:113], v5 offset:32768
    buffer_store_dwordx4 v[68:71], v28, s[4:7], s30 offen offset:1024 sc1
    v_mfma_f32_16x16x32_bf16 v[44:47], a[80:83], a[36:39], v[44:47]
    ds_read_b64_tr_b16 a[114:115], v5 offset:36864
    s_waitcnt lgkmcnt(14)
    v_mfma_f32_16x16x32_bf16 v[44:47], a[84:87], a[44:47], v[44:47]
    ds_read_b64_tr_b16 a[116:117], v5 offset:40960
    v_mfma_f32_16x16x32_bf16 v[40:43], a[84:87], a[40:43], v[40:43]
    ds_read_b64_tr_b16 a[118:119], v5 offset:45056
    s_waitcnt lgkmcnt(14)
    buffer_store_dwordx4 v[72:75], v28, s[4:7], s30 offen offset:2048 sc1
    v_mfma_f32_16x16x32_bf16 v[40:43], a[88:91], a[48:51], v[40:43]
    ds_read_b64_tr_b16 a[120:121], v5 offset:49152
    v_mfma_f32_16x16x32_bf16 v[44:47], a[88:91], a[52:55], v[44:47]
    ds_read_b64_tr_b16 a[122:123], v5 offset:53248
    s_waitcnt lgkmcnt(14)
    v_mfma_f32_16x16x32_bf16 v[44:47], a[92:95], a[60:63], v[44:47]
    ds_read_b64_tr_b16 a[124:125], v5 offset:57344
    buffer_store_dwordx4 v[76:79], v28, s[4:7], s30 offen offset:3072 sc1
    v_mfma_f32_16x16x32_bf16 v[40:43], a[92:95], a[56:59], v[40:43]
    ds_read_b64_tr_b16 a[126:127], v5 offset:61440
    s_waitcnt lgkmcnt(14)
    v_mfma_f32_16x16x32_bf16 v[48:51], a[96:99], a[32:35], v[48:51]
    v_mfma_f32_16x16x32_bf16 v[52:55], a[96:99], a[36:39], v[52:55]
    s_waitcnt lgkmcnt(12)
    buffer_store_dwordx4 v[80:83], v29, s[4:7], s30 offen offset:0 sc1
    v_mfma_f32_16x16x32_bf16 v[52:55], a[100:103], a[44:47], v[52:55]
    v_mfma_f32_16x16x32_bf16 v[48:51], a[100:103], a[40:43], v[48:51]
    s_waitcnt lgkmcnt(10)
    v_mfma_f32_16x16x32_bf16 v[48:51], a[104:107], a[48:51], v[48:51]
    buffer_store_dwordx4 v[84:87], v29, s[4:7], s30 offen offset:1024 sc1
    v_mfma_f32_16x16x32_bf16 v[52:55], a[104:107], a[52:55], v[52:55]
    s_waitcnt lgkmcnt(8)
    v_mfma_f32_16x16x32_bf16 v[52:55], a[108:111], a[60:63], v[52:55]
    v_mfma_f32_16x16x32_bf16 v[48:51], a[108:111], a[56:59], v[48:51]
    s_waitcnt lgkmcnt(6)
    buffer_store_dwordx4 v[88:91], v29, s[4:7], s30 offen offset:2048 sc1
    v_mfma_f32_16x16x32_bf16 v[56:59], a[112:115], a[32:35], v[56:59]
    v_mfma_f32_16x16x32_bf16 v[60:63], a[112:115], a[36:39], v[60:63]
    s_waitcnt lgkmcnt(4)
    v_mfma_f32_16x16x32_bf16 v[60:63], a[116:119], a[44:47], v[60:63]
    buffer_store_dwordx4 v[92:95], v29, s[4:7], s30 offen offset:3072 sc1
    v_mfma_f32_16x16x32_bf16 v[56:59], a[116:119], a[40:43], v[56:59]
    s_waitcnt lgkmcnt(2)
    v_mfma_f32_16x16x32_bf16 v[56:59], a[120:123], a[48:51], v[56:59]
    v_mfma_f32_16x16x32_bf16 v[60:63], a[120:123], a[52:55], v[60:63]
    s_waitcnt lgkmcnt(0)
    v_mfma_f32_16x16x32_bf16 v[60:63], a[124:127], a[60:63], v[60:63]
    v_mfma_f32_16x16x32_bf16 v[56:59], a[124:127], a[56:59], v[56:59]
    s_lshl_b32 s16, s68, 2
    s_add_u32 s16, s16, s20
    s_lshl_b32 s16, s16, 16
    s_lshl_b32 s17, s71, 11
    s_add_u32 s16, s16, s17
    s_add_u32 s16, s16, 16777216
    v_lshlrev_b32 v28, 4, v1
    v_add_u32 v28, s16, v28
    v_add_u32 v29, 32768, v28
    buffer_load_dwordx4 v[96:99], v28, s[4:7], 0 offen offset:0 sc1
    buffer_load_dwordx4 v[100:103], v28, s[4:7], 0 offen offset:1024 sc1
    buffer_load_dwordx4 v[104:107], v29, s[4:7], 0 offen offset:0 sc1
    buffer_load_dwordx4 v[108:111], v29, s[4:7], 0 offen offset:1024 sc1
    s_lshl_b32 s16, s68, 9
    s_lshl_b32 s17, s20, 7
    s_add_u32 s16, s16, s17
    s_add_u32 s16, s16, 40173568
    v_and_b32 v28, 15, v1
    v_lshlrev_b32 v28, 2, v28
    buffer_load_dword v112, v28, s[4:7], s16 offen sc1
    buffer_load_dword v114, v28, s[4:7], s16 offen offset:64 sc1
    s_lshl_b32 s16, s68, 2
    s_add_u32 s16, s16, s20
    s_lshl_b32 s16, s16, 12
    s_add_u32 s16, s16, 37748736
    v_lshlrev_b32 v28, 1, v28
    v_lshrrev_b32 v29, 4, v1
    v_lshlrev_b32 v29, 9, v29
    v_add_u32 v28, v28, v29
    buffer_load_dwordx2 v[128:129], v28, s[4:7], s16 offen offset:0 sc1
    buffer_load_dwordx2 v[130:131], v28, s[4:7], s16 offen offset:128 sc1
    buffer_load_dwordx2 v[132:133], v28, s[4:7], s16 offen offset:256 sc1
    buffer_load_dwordx2 v[134:135], v28, s[4:7], s16 offen offset:384 sc1
    s_add_u32 s16, s16, 2048
    buffer_load_dwordx2 v[136:137], v28, s[4:7], s16 offen offset:0 sc1
    buffer_load_dwordx2 v[138:139], v28, s[4:7], s16 offen offset:128 sc1
    buffer_load_dwordx2 v[140:141], v28, s[4:7], s16 offen offset:256 sc1
    buffer_load_dwordx2 v[142:143], v28, s[4:7], s16 offen offset:384 sc1
    s_waitcnt vmcnt(14)
    s_barrier
    s_lshl_b32 s16, s2, 8
    s_add_u32 s16, s16, 42008576
    s_cmp_eq_u32 s20, 1
    s_cbranch_scc0 Lx_20
    s_xor_b32 s17, s16, 256
    v_mov_b32 v24, 1
    buffer_atomic_add v24, v30, s[4:7], s17 offen sc1
Lx_20:
    s_cmp_eq_u32 s20, 0
    s_cbranch_scc0 Lx_23
    s_mov_b32 s74, s16
    buffer_load_dword v31, v30, s[4:7], s74 offen sc1
Lx_23:
    s_waitcnt vmcnt(0)
    v_lshlrev_b32 v160, 16, v96
    v_and_b32 v161, 0xffff0000, v96
    v_lshlrev_b32 v162, 16, v97
    v_and_b32 v163, 0xffff0000, v97
    v_lshlrev_b32 v168, 16, v98
    v_and_b32 v169, 0xffff0000, v98
    v_lshlrev_b32 v170, 16, v99
    v_and_b32 v171, 0xffff0000, v99
    v_lshlrev_b32 v176, 16, v100
    v_and_b32 v177, 0xffff0000, v100
    v_lshlrev_b32 v178, 16, v101
    v_and_b32 v179, 0xffff0000, v101
    v_lshlrev_b32 v184, 16, v102
    v_and_b32 v185, 0xffff0000, v102
    v_lshlrev_b32 v186, 16, v103
    v_and_b32 v187, 0xffff0000, v103
    v_lshlrev_b32 v164, 16, v104
    v_and_b32 v165, 0xffff0000, v104
    v_lshlrev_b32 v166, 16, v105
    v_and_b32 v167, 0xffff0000, v105
    v_lshlrev_b32 v172, 16, v106
    v_and_b32 v173, 0xffff0000, v106
    v_lshlrev_b32 v174, 16, v107
    v_and_b32 v175, 0xffff0000, v107
    v_lshlrev_b32 v180, 16, v108
    v_and_b32 v181, 0xffff0000, v108
    v_lshlrev_b32 v182, 16, v109
    v_and_b32 v183, 0xffff0000, v109
    v_lshlrev_b32 v188, 16, v110
    v_and_b32 v189, 0xffff0000, v110
    v_lshlrev_b32 v190, 16, v111
    v_and_b32 v191, 0xffff0000, v111
    v_pk_add_f32 v[160:161], v[160:161], v[112:113] op_sel:[0,0] op_sel_hi:[1,0]
    v_pk_add_f32 v[162:163], v[162:163], v[112:113] op_sel:[0,0] op_sel_hi:[1,0]
    v_pk_add_f32 v[168:169], v[168:169], v[112:113] op_sel:[0,0] op_sel_hi:[1,0]
    v_pk_add_f32 v[170:171], v[170:171], v[112:113] op_sel:[0,0] op_sel_hi:[1,0]
    v_pk_add_f32 v[176:177], v[176:177], v[112:113] op_sel:[0,0] op_sel_hi:[1,0]
    v_pk_add_f32 v[178:179], v[178:179], v[112:113] op_sel:[0,0] op_sel_hi:[1,0]
    v_pk_add_f32 v[184:185], v[184:185], v[112:113] op_sel:[0,0] op_sel_hi:[1,0]
    v_pk_add_f32 v[186:187], v[186:187], v[112:113] op_sel:[0,0] op_sel_hi:[1,0]
    v_pk_add_f32 v[164:165], v[164:165], v[114:115] op_sel:[0,0] op_sel_hi:[1,0]
    v_pk_add_f32 v[166:167], v[166:167], v[114:115] op_sel:[0,0] op_sel_hi:[1,0]
    v_pk_add_f32 v[172:173], v[172:173], v[114:115] op_sel:[0,0] op_sel_hi:[1,0]
    v_pk_add_f32 v[174:175], v[174:175], v[114:115] op_sel:[0,0] op_sel_hi:[1,0]
    v_pk_add_f32 v[180:181], v[180:181], v[114:115] op_sel:[0,0] op_sel_hi:[1,0]
    v_pk_add_f32 v[182:183], v[182:183], v[114:115] op_sel:[0,0] op_sel_hi:[1,0]
    v_pk_add_f32 v[188:189], v[188:189], v[114:115] op_sel:[0,0] op_sel_hi:[1,0]
    v_pk_add_f32 v[190:191], v[190:191], v[114:115] op_sel:[0,0] op_sel_hi:[1,0]
    v_pk_add_f32 v[128:129], v[128:129], v[130:131]
    v_pk_add_f32 v[132:133], v[132:133], v[134:135]
    v_pk_add_f32 v[128:129], v[128:129], v[132:133]
    v_pk_add_f32 v[136:137], v[136:137], v[138:139]
    v_pk_add_f32 v[140:141], v[140:141], v[142:143]
    v_pk_add_f32 v[136:137], v[136:137], v[140:141]
    v_mov_b32 v148, v128
    v_mov_b32 v149, v129
    v_mov_b32 v150, v136
    v_mov_b32 v151, v137
    s_nop 1
    v_permlane16_swap_b32 v128, v148
    v_permlane16_swap_b32 v129, v149
    v_permlane16_swap_b32 v136, v150
    v_permlane16_swap_b32 v137, v151
    s_nop 1
    v_add_f32 v128, v128, v148
    v_add_f32 v129, v129, v149
    v_add_f32 v136, v136, v150
    v_add_f32 v137, v137, v151
    v_mov_b32 v148, v128
    v_mov_b32 v149, v129
    v_mov_b32 v150, v136
    v_mov_b32 v151, v137
    s_nop 1
    v_permlane32_swap_b32 v128, v148
    v_permlane32_swap_b32 v129, v149
    v_permlane32_swap_b32 v136, v150
    v_permlane32_swap_b32 v137, v151
    s_nop 1
    v_add_f32 v128, v128, v148
    v_add_f32 v129, v129, v149
    v_add_f32 v136, v136, v150
    v_add_f32 v137, v137, v151
    s_mov_b32 s16, 0x3a800000
    s_mov_b32 s17, 0x3727c5ac
    v_mul_f32 v128, s16, v128
    v_mul_f32 v129, s16, v129
    v_fma_f32 v129, -v128, v128, v129
    v_add_f32 v129, s17, v129
    v_rcp_f32 v144, v129
    v_mul_f32 v136, s16, v136
    v_mul_f32 v137, s16, v137
    v_fma_f32 v137, -v136, v136, v137
    v_add_f32 v137, s17, v137
    v_rcp_f32 v146, v137
    s_cmp_eq_u32 s20, 0
    s_cbranch_scc0 Lx_21
    s_waitcnt vmcnt(0)
    v_readfirstlane_b32 s17, v31
    s_cmp_ge_u32 s17, 1
    s_cbranch_scc1 Lx_21
    s_mov_b32 s16, s74
    s_mov_b32 s19, 0
Lxp_22:
    s_add_u32 s19, s19, 1
    s_cmp_gt_u32 s19, 300000
    s_cbranch_scc1 Lx_21
    buffer_load_dword v24, v30, s[4:7], s16 offen sc1
    s_waitcnt vmcnt(0)
    v_readfirstlane_b32 s17, v24
    s_cmp_ge_u32 s17, 1
    s_cbranch_scc0 Lxp_22
Lx_21:
    s_barrier
    v_lshlrev_b32 v28, 4, v1
    v_add_u32 v29, 4096, v28
    buffer_load_dwordx4 v[192:195], v28, s[4:7], s27 offen offset:0 sc1
    buffer_load_dwordx4 v[196:199], v28, s[4:7], s27 offen offset:1024 sc1
    buffer_load_dwordx4 v[200:203], v28, s[4:7], s27 offen offset:2048 sc1
    buffer_load_dwordx4 v[204:207], v28, s[4:7], s27 offen offset:3072 sc1
    buffer_load_dwordx4 v[208:211], v29, s[4:7], s27 offen offset:0 sc1
    buffer_load_dwordx4 v[212:215], v29, s[4:7], s27 offen offset:1024 sc1
    buffer_load_dwordx4 v[216:219], v29, s[4:7], s27 offen offset:2048 sc1
    buffer_load_dwordx4 v[220:223], v29, s[4:7], s27 offen offset:3072 sc1
    s_waitcnt vmcnt(7)
    v_pk_add_f32 v[32:33], v[32:33], v[192:193]
    v_pk_add_f32 v[34:35], v[34:35], v[194:195]
    v_pk_fma_f32 v[32:33], v[32:33], v[144:145], v[160:161] op_sel:[0,0,0] op_sel_hi:[1,0,1]
    v_pk_fma_f32 v[34:35], v[34:35], v[144:145], v[162:163] op_sel:[0,0,0] op_sel_hi:[1,0,1]
    s_waitcnt vmcnt(6)
    v_pk_add_f32 v[36:37], v[36:37], v[196:197]
    v_pk_add_f32 v[38:39], v[38:39], v[198:199]
    v_pk_fma_f32 v[36:37], v[36:37], v[146:147], v[164:165] op_sel:[0,0,0] op_sel_hi:[1,0,1]
    v_pk_fma_f32 v[38:39], v[38:39], v[146:147], v[166:167] op_sel:[0,0,0] op_sel_hi:[1,0,1]
    s_waitcnt vmcnt(5)
    v_pk_add_f32 v[40:41], v[40:41], v[200:201]
    v_pk_add_f32 v[42:43], v[42:43], v[202:203]
    v_pk_fma_f32 v[40:41], v[40:41], v[144:145], v[168:169] op_sel:[0,0,0] op_sel_hi:[1,0,1]
    v_pk_fma_f32 v[42:43], v[42:43], v[144:145], v[170:171] op_sel:[0,0,0] op_sel_hi:[1,0,1]
    s_waitcnt vmcnt(4)
    v_pk_add_f32 v[44:45], v[44:45], v[204:205]
    v_pk_add_f32 v[46:47], v[46:47], v[206:207]
    v_pk_fma_f32 v[44:45], v[44:45], v[146:147], v[172:173] op_sel:[0,0,0] op_sel_hi:[1,0,1]
    v_pk_fma_f32 v[46:47], v[46:47], v[146:147], v[174:175] op_sel:[0,0,0] op_sel_hi:[1,0,1]
    s_waitcnt vmcnt(3)
    v_pk_add_f32 v[48:49], v[48:49], v[208:209]
    v_pk_add_f32 v[50:51], v[50:51], v[210:211]
    v_pk_fma_f32 v[48:49], v[48:49], v[144:145], v[176:177] op_sel:[0,0,0] op_sel_hi:[1,0,1]
    v_pk_fma_f32 v[50:51], v[50:51], v[144:145], v[178:179] op_sel:[0,0,0] op_sel_hi:[1,0,1]
    s_waitcnt vmcnt(2)
    v_pk_add_f32 v[52:53], v[52:53], v[212:213]
    v_pk_add_f32 v[54:55], v[54:55], v[214:215]
    v_pk_fma_f32 v[52:53], v[52:53], v[146:147], v[180:181] op_sel:[0,0,0] op_sel_hi:[1,0,1]
    v_pk_fma_f32 v[54:55], v[54:55], v[146:147], v[182:183] op_sel:[0,0,0] op_sel_hi:[1,0,1]
    s_waitcnt vmcnt(1)
    v_pk_add_f32 v[56:57], v[56:57], v[216:217]
    v_pk_add_f32 v[58:59], v[58:59], v[218:219]
    v_pk_fma_f32 v[56:57], v[56:57], v[144:145], v[184:185] op_sel:[0,0,0] op_sel_hi:[1,0,1]
    v_pk_fma_f32 v[58:59], v[58:59], v[144:145], v[186:187] op_sel:[0,0,0] op_sel_hi:[1,0,1]
    s_waitcnt vmcnt(0)
    v_pk_add_f32 v[60:61], v[60:61], v[220:221]
    v_pk_add_f32 v[62:63], v[62:63], v[222:223]
    v_pk_fma_f32 v[60:61], v[60:61], v[146:147], v[188:189] op_sel:[0,0,0] op_sel_hi:[1,0,1]
    v_pk_fma_f32 v[62:63], v[62:63], v[146:147], v[190:191] op_sel:[0,0,0] op_sel_hi:[1,0,1]
    s_mov_b32 s12, s98
    s_mov_b32 s13, s99
    s_mov_b32 s14, 0x400000
    s_mov_b32 s15, 0x20000
    s_nop 7
    v_and_b32 v23, 15, v1
    v_mul_u32_u24 v23, 144, v23
    v_lshrrev_b32 v24, 4, v1
    v_lshlrev_b32 v24, 3, v24
    v_add_u32 v23, v23, v24
    s_mul_i32 s17, s20, 4608
    s_add_u32 s17, s17, 131072
    v_add_u32 v23, s17, v23
    v_cvt_pk_bf16_f32 v96, v32, v33
    v_cvt_pk_bf16_f32 v97, v34, v35
    ds_write_b64 v23, v[96:97] offset:0
    v_cvt_pk_bf16_f32 v98, v40, v41
    v_cvt_pk_bf16_f32 v99, v42, v43
    ds_write_b64 v23, v[98:99] offset:32
    v_cvt_pk_bf16_f32 v100, v48, v49
    v_cvt_pk_bf16_f32 v101, v50, v51
    ds_write_b64 v23, v[100:101] offset:64
    v_cvt_pk_bf16_f32 v102, v56, v57
    v_cvt_pk_bf16_f32 v103, v58, v59
    ds_write_b64 v23, v[102:103] offset:96
    v_cvt_pk_bf16_f32 v104, v36, v37
    v_cvt_pk_bf16_f32 v105, v38, v39
    ds_write_b64 v23, v[104:105] offset:2304
    v_cvt_pk_bf16_f32 v106, v44, v45
    v_cvt_pk_bf16_f32 v107, v46, v47
    ds_write_b64 v23, v[106:107] offset:2336
    v_cvt_pk_bf16_f32 v108, v52, v53
    v_cvt_pk_bf16_f32 v109, v54, v55
    ds_write_b64 v23, v[108:109] offset:2368
    v_cvt_pk_bf16_f32 v110, v60, v61
    v_cvt_pk_bf16_f32 v111, v62, v63
    ds_write_b64 v23, v[110:111] offset:2400
    v_lshrrev_b32 v24, 3, v1
    v_mul_u32_u24 v25, 144, v24
    v_and_b32 v26, 7, v1
    v_lshlrev_b32 v26, 4, v26
    v_add_u32 v25, v25, v26
    v_add_u32 v25, s17, v25
    s_lshl_b32 s16, s68, 2
    s_add_u32 s16, s16, s20
    s_lshl_b32 s16, s16, 16
    s_lshl_b32 s18, s71, 7
    s_add_u32 s16, s16, s18
    v_lshlrev_b32 v24, 11, v24
    v_add_u32 v24, v24, v26
    v_add_u32 v24, s16, v24
    s_waitcnt lgkmcnt(0)
    ds_read_b128 v[112:115], v25 offset:0
    ds_read_b128 v[116:119], v25 offset:1152
    ds_read_b128 v[120:123], v25 offset:2304
    ds_read_b128 v[124:127], v25 offset:3456
    s_waitcnt lgkmcnt(3)
    s_mov_b32 s18, 0
    buffer_store_dwordx4 v[112:115], v24, s[12:15], s18 offen
    s_waitcnt lgkmcnt(2)
    s_mov_b32 s18, 16384
    buffer_store_dwordx4 v[116:119], v24, s[12:15], s18 offen
    s_waitcnt lgkmcnt(1)
    s_mov_b32 s18, 32768
    buffer_store_dwordx4 v[120:123], v24, s[12:15], s18 offen
    s_waitcnt lgkmcnt(0)
    s_mov_b32 s18, 49152
    buffer_store_dwordx4 v[124:127], v24, s[12:15], s18 offen
L_done:
    s_endpgm
L_codeend:
.section .rodata,"a"
.p2align 6
.amdhsa_kernel sequential_preLN__sliding_block__glu_gated_bilinear__prompt_kernel
  .amdhsa_next_free_vgpr 512
  .amdhsa_next_free_sgpr 102
  .amdhsa_accum_offset 256
  .amdhsa_group_segment_fixed_size 0
  .amdhsa_kernarg_size 80
  .amdhsa_user_sgpr_count 2
  .amdhsa_user_sgpr_kernarg_segment_ptr 1
  .amdhsa_system_sgpr_workgroup_id_x 1
.end_amdhsa_kernel
```
